```python
import torch

def _softmax(x, axis=-1):
    return torch.softmax(x, dim=axis)
def _gelu(x):
    return torch.nn.functional.gelu(x, approximate="tanh")
def _silu(x):
    return torch.nn.functional.silu(x)
def _sigmoid(x):
    return torch.sigmoid(x)
def _layernorm(x, axis=-1, eps=1e-5):
    m = x.mean(dim=axis, keepdim=True)
    v = x.var(dim=axis, keepdim=True, unbiased=False)
    return (x - m) / torch.sqrt(v + eps)
def _scatter_add(tgt, idx, src, axis=0):
    return tgt.clone().index_add_(axis, idx, src)
def _segment_sum(src, seg, n):
    out = torch.zeros((n,) + src.shape[1:], dtype=src.dtype)
    return out.index_add_(0, seg, src)
def _pad(x, pw):
    flat = tuple(v for pair in reversed(pw) for v in pair)
    return torch.nn.functional.pad(x, flat)

kernel_name = 'sequential_preLN__spectral_gfnet__glu_gated_geglu__prompt'

def setup_inputs():

    _w = (lambda a: (lambda t: t.to(torch.bfloat16) if t.is_floating_point() else t)(torch.as_tensor(a)))
    def _A_setup():
        B, S, D = 1, 2048, 512
        Df = D // 2 + 1
        return {
            "x": _w((lambda *s: torch.randn(*s, dtype=torch.bfloat16) * 0.05)(B, S, D)),
            "w_r": _w((lambda *s: torch.randn(*s, dtype=torch.bfloat16) * 0.4)(S, Df) * 0.02),
            "w_i": _w((lambda *s: torch.randn(*s, dtype=torch.bfloat16) * 0.4)(S, Df) * 0.02),
        }
    _A_in = _A_setup()

    def _B_setup():
        B, S, Dm, Df = 1, 2048, 512, 1376
        return {
            "x": _w((lambda *s: torch.randn(*s, dtype=torch.bfloat16) * 0.05)(B, S, Dm)),
            "w_gate": _w((lambda *s: torch.randn(*s, dtype=torch.bfloat16) * 0.4)(Dm, Df) * (Dm ** -0.5)),
            "w_up": _w((lambda *s: torch.randn(*s, dtype=torch.bfloat16) * 0.4)(Dm, Df) * (Dm ** -0.5)),
            "w_down": _w((lambda *s: torch.randn(*s, dtype=torch.bfloat16) * 0.4)(Df, Dm) * (Df ** -0.5)),
        }
    _B_in = _B_setup()

    return {
        "A_x": _A_in["x"],
        "A_w_r": _A_in["w_r"],
        "A_w_i": _A_in["w_i"],
        "B_x": _B_in["x"],
        "B_w_gate": _B_in["w_gate"],
        "B_w_up": _B_in["w_up"],
        "B_w_down": _B_in["w_down"],
    }

def reference(A_x, A_w_r, A_w_i, B_x, B_w_gate, B_w_up, B_w_down):
    def _A_ref(x, w_r, w_i):
        B, S, D = x.shape
        X = (lambda x, axes=(-2,-1): torch.fft.rfft2(x.float(), dim=axes))(x, axes=(-2, -1))
        W = w_r + 1j * w_i
        X = X * W
        y = (lambda x, s, axes=(-2,-1): torch.fft.irfft2(x, s=s, dim=axes).to(torch.bfloat16))(X, (S, D), axes=(-2, -1))
        return y

    def _B_ref(x, w_gate, w_up, w_down):
        g = torch.einsum("bsd,df->bsf", x, w_gate)
        u = torch.einsum("bsd,df->bsf", x, w_up)
        h = _gelu(g) * u
        return torch.einsum("bsf,fd->bsd", h, w_down)

    x = A_x
    h = x + _A_ref(_layernorm(x, axis=-1), A_w_r, A_w_i)
    h2 = h + _B_ref(_layernorm(h, axis=-1), B_w_gate, B_w_up, B_w_down)
    return h2
```

```asm
; @launch grid=(256,1,1) block=(256,1,1) lds=135168
.amdgcn_target "amdgcn-amd-amdhsa--gfx950"
.text
.globl sequential_preLN__spectral_gfnet__glu_gated_geglu__prompt_kernel
.p2align 8
.type sequential_preLN__spectral_gfnet__glu_gated_geglu__prompt_kernel,@function
sequential_preLN__spectral_gfnet__glu_gated_geglu__prompt_kernel:
    s_load_dwordx16 s[4:19], s[0:1], 0
    s_load_dwordx4 s[20:23], s[0:1], 64
    s_getpc_b64 s[42:43]
L_pc:
    s_cmp_ge_u32 s2, 256
    s_cbranch_scc1 L_end
    v_lshrrev_b32 v5, 6, v0
    v_and_b32 v1, 63, v0
    v_readfirstlane_b32 s40, v5
    s_lshr_b32 s44, s2, 3
    v_lshl_add_u32 v5, v5, 5, s44
    v_lshlrev_b32 v6, 6, v1
    v_lshl_add_u32 v5, v5, 12, v6
    v_min_u32 v5, L_image_end-L_pc-4, v5
    v_mov_b32 v7, s43
    v_add_co_u32 v6, vcc, s42, v5
    s_nop 1
    v_addc_co_u32 v7, vcc, 0, v7, vcc
    global_load_dword v255, v[6:7], off
    v_bfe_u32 v2, v0, 4, 2
    v_and_b32 v3, 15, v0
    v_lshlrev_b32 v4, 4, v1
    s_add_u32 s42, s42, tables-L_pc
    s_addc_u32 s43, s43, 0
    s_cmp_ge_u32 s2, 216
    s_cbranch_scc1 L_p1c
    s_add_u32 s46, s42, 0
    s_addc_u32 s47, s43, 0
    v_mov_b32 v7, s47
    v_add_co_u32 v6, vcc, s46, v4
    s_nop 1
    v_addc_co_u32 v7, vcc, 0, v7, vcc
    global_load_dwordx4 a[200:203], v[6:7], off offset:0
    global_load_dwordx4 a[204:207], v[6:7], off offset:1024
    s_cmp_lg_u32 s40, 0
    s_cbranch_scc1 L_ow1
    s_setprio 3
    s_mov_b64 exec, -1
L_ow1:
    s_cmp_ge_u32 s2, 128
    s_cbranch_scc1 L_notz
    s_and_b32 s44, s2, 7
    s_lshr_b32 s45, s2, 4
    s_lshl_b32 s45, s45, 3
    s_add_u32 s44, s44, s45
    s_lshl_b32 s44, s44, 1
    s_bfe_u32 s45, s2, 0x10003
    s_add_u32 s60, s44, s45
    s_lshr_b32 s61, s60, 3
    s_lshl_b32 s61, s61, 7
    s_and_b32 s44, s60, 7
    s_lshl_b32 s44, s44, 2
    s_add_u32 s44, s44, s61
    s_add_u32 s44, s44, s40
    s_lshl_b32 s56, s44, 10
    s_add_u32 s57, s56, 0x8000
    s_add_u32 s58, s56, 0x10000
    s_add_u32 s59, s56, 0x18000
    s_mov_b32 s38, 2097152
    s_mov_b32 s39, 0x20000
    s_bfe_u32 s48, s2, 0x20003
    s_and_b32 s44, s2, 7
    s_lshl_b32 s44, s44, 2
    s_add_u32 s48, s48, s44
    s_and_b32 s44, s2, 0x60
    s_add_u32 s48, s48, s44
    s_add_u32 s48, s48, 128
    s_bfe_u32 s44, s48, 0x30002
    s_lshl_b32 s44, s44, 3
    s_lshr_b32 s45, s48, 5
    s_lshl_b32 s45, s45, 8
    s_add_u32 s44, s44, s45
    s_mul_i32 s49, s44, 514
    s_and_b32 s45, s48, 3
    s_lshl_b32 s45, s45, 7
    s_add_u32 s49, s49, s45
    s_add_u32 s49, s49, 2
    v_lshrrev_b32 v12, 3, v1
    v_and_b32 v13, 7, v1
    v_mul_u32_u24 v11, 514, v12
    v_lshl_add_u32 v11, v13, 4, v11
    s_mov_b32 s30, 1052672
    s_mov_b32 s31, 0x20000
    s_mov_b32 s34, 1052672
    s_mov_b32 s35, 0x20000
    s_mul_i32 s44, s40, 32896
    s_add_u32 s49, s49, s44
    v_cmp_gt_u32 vcc, 8, v3
    v_and_b32 v176, 7, v3
    v_lshlrev_b32 v176, 5, v176
    v_mov_b32 v177, 0x80008000
    v_cndmask_b32 v178, 0, v177, vcc
    v_cndmask_b32 v179, v177, 0, vcc
    v_lshl_add_u32 v180, v2, 3, 1
    v_cvt_f32_u32 v180, v180
    v_mul_f32 v180, 0x3a800000, v180
    v_add_f32 v181, 0x3b000000, v180
    v_add_f32 v182, 0x3b800000, v180
    v_add_f32 v183, 0x3bc00000, v180
    s_lshl_b32 s46, s40, 2
    v_cndmask_b32 v177, -1.0, 1.0, vcc
    s_sub_u32 s47, 32, s46
    v_mov_b32 v184, s47
    v_mov_b32 v185, s46
    v_cndmask_b32 v184, v184, v185, vcc
    v_add_u32 v184, v184, v176
    v_cvt_f32_u32 v184, v184
    v_mul_f32 v186, v184, v180
    v_fract_f32 v186, v186
    v_mul_f32 v187, v184, v181
    v_fract_f32 v187, v187
    v_mul_f32 v188, v184, v182
    v_fract_f32 v188, v188
    v_mul_f32 v189, v184, v183
    v_fract_f32 v189, v189
    v_sin_f32 v190, v186
    v_cos_f32 v186, v186
    v_sin_f32 v191, v187
    v_cos_f32 v187, v187
    v_sin_f32 v192, v188
    v_cos_f32 v188, v188
    v_sin_f32 v193, v189
    v_cos_f32 v189, v189
    v_cvt_pk_f16_f32 v144, v186, v187
    v_cvt_pk_f16_f32 v148, -v190, -v191
    v_cvt_pk_f16_f32 v145, v188, v189
    v_cvt_pk_f16_f32 v149, -v192, -v193
    v_xor_b32 v146, v148, v178
    v_xor_b32 v150, v144, v179
    v_xor_b32 v147, v149, v178
    v_xor_b32 v151, v145, v179
    v_add_f32 v184, v184, v177
    v_mul_f32 v186, v184, v180
    v_fract_f32 v186, v186
    v_mul_f32 v187, v184, v181
    v_fract_f32 v187, v187
    v_mul_f32 v188, v184, v182
    v_fract_f32 v188, v188
    v_mul_f32 v189, v184, v183
    v_fract_f32 v189, v189
    v_sin_f32 v190, v186
    v_cos_f32 v186, v186
    v_sin_f32 v191, v187
    v_cos_f32 v187, v187
    v_sin_f32 v192, v188
    v_cos_f32 v188, v188
    v_sin_f32 v193, v189
    v_cos_f32 v189, v189
    v_cvt_pk_f16_f32 v152, v186, v187
    v_cvt_pk_f16_f32 v156, -v190, -v191
    v_cvt_pk_f16_f32 v153, v188, v189
    v_cvt_pk_f16_f32 v157, -v192, -v193
    v_xor_b32 v154, v156, v178
    v_xor_b32 v158, v152, v179
    v_xor_b32 v155, v157, v178
    v_xor_b32 v159, v153, v179
    v_add_f32 v184, v184, v177
    v_mul_f32 v186, v184, v180
    v_fract_f32 v186, v186
    v_mul_f32 v187, v184, v181
    v_fract_f32 v187, v187
    v_mul_f32 v188, v184, v182
    v_fract_f32 v188, v188
    v_mul_f32 v189, v184, v183
    v_fract_f32 v189, v189
    v_sin_f32 v190, v186
    v_cos_f32 v186, v186
    v_sin_f32 v191, v187
    v_cos_f32 v187, v187
    v_sin_f32 v192, v188
    v_cos_f32 v188, v188
    v_sin_f32 v193, v189
    v_cos_f32 v189, v189
    v_cvt_pk_f16_f32 v160, v186, v187
    v_cvt_pk_f16_f32 v164, -v190, -v191
    v_cvt_pk_f16_f32 v161, v188, v189
    v_cvt_pk_f16_f32 v165, -v192, -v193
    v_xor_b32 v162, v164, v178
    v_xor_b32 v166, v160, v179
    v_xor_b32 v163, v165, v178
    v_xor_b32 v167, v161, v179
    v_add_f32 v184, v184, v177
    v_mul_f32 v186, v184, v180
    v_fract_f32 v186, v186
    v_mul_f32 v187, v184, v181
    v_fract_f32 v187, v187
    v_mul_f32 v188, v184, v182
    v_fract_f32 v188, v188
    v_mul_f32 v189, v184, v183
    v_fract_f32 v189, v189
    v_sin_f32 v190, v186
    v_cos_f32 v186, v186
    v_sin_f32 v191, v187
    v_cos_f32 v187, v187
    v_sin_f32 v192, v188
    v_cos_f32 v188, v188
    v_sin_f32 v193, v189
    v_cos_f32 v189, v189
    v_cvt_pk_f16_f32 v168, v186, v187
    v_cvt_pk_f16_f32 v172, -v190, -v191
    v_cvt_pk_f16_f32 v169, v188, v189
    v_cvt_pk_f16_f32 v173, -v192, -v193
    v_xor_b32 v170, v172, v178
    v_xor_b32 v174, v168, v179
    v_xor_b32 v171, v173, v178
    v_xor_b32 v175, v169, v179
    s_cmp_lg_u32 s40, 0
    s_cbranch_scc1 L_ow2
    v_cmp_gt_u32 vcc, 8, v3
    v_add_u32 v184, 16, v176
    v_cmp_eq_u32 s[46:47], 0, v3
    v_cndmask_b32 v184, v184, v176, vcc
    v_mov_b32 v185, 0x100
    v_mov_b32 v194, 0x3f3504f3
    v_mov_b32 v195, 0x3e800000
    v_cndmask_b32 v184, v184, v185, s[46:47]
    v_cndmask_b32 v194, 1.0, v194, s[46:47]
    v_cndmask_b32 v195, 0, v195, s[46:47]
    v_cvt_f32_u32 v184, v184
    v_fma_f32 v186, v184, v180, v195
    v_fract_f32 v186, v186
    v_fma_f32 v187, v184, v181, v195
    v_fract_f32 v187, v187
    v_fma_f32 v188, v184, v182, v195
    v_fract_f32 v188, v188
    v_fma_f32 v189, v184, v183, v195
    v_fract_f32 v189, v189
    v_sin_f32 v190, v186
    v_cos_f32 v186, v186
    v_sin_f32 v191, v187
    v_cos_f32 v187, v187
    v_sin_f32 v192, v188
    v_cos_f32 v188, v188
    v_sin_f32 v193, v189
    v_cos_f32 v189, v189
    v_mul_f32 v186, v186, v194
    v_mul_f32 v187, v187, v194
    v_mul_f32 v188, v188, v194
    v_mul_f32 v189, v189, v194
    v_mul_f32 v190, v190, v194
    v_mul_f32 v191, v191, v194
    v_mul_f32 v192, v192, v194
    v_mul_f32 v193, v193, v194
    v_cvt_pk_f16_f32 v144, v186, v187
    v_cvt_pk_f16_f32 v148, -v190, -v191
    v_cvt_pk_f16_f32 v145, v188, v189
    v_cvt_pk_f16_f32 v149, -v192, -v193
    v_cndmask_b32 v146, v144, 0, vcc
    v_cndmask_b32 v144, 0, v144, vcc
    v_cndmask_b32 v147, v145, 0, vcc
    v_cndmask_b32 v145, 0, v145, vcc
    v_cndmask_b32 v150, v148, 0, vcc
    v_cndmask_b32 v148, 0, v148, vcc
    v_cndmask_b32 v151, v149, 0, vcc
    v_cndmask_b32 v149, 0, v149, vcc
    s_nop 4
    s_mov_b64 exec, -1
L_ow2:
    s_waitcnt lgkmcnt(0)
    s_mov_b32 s36, s4
    s_and_b32 s37, s5, 0xffff
    buffer_load_dwordx4 v[32:35], v4, s[36:39], s56 offen nt
    buffer_load_dwordx4 v[36:39], v4, s[36:39], s57 offen nt
    buffer_load_dwordx4 v[40:43], v4, s[36:39], s58 offen nt
    buffer_load_dwordx4 v[44:47], v4, s[36:39], s59 offen nt
    s_mov_b32 s28, s6
    s_and_b32 s29, s7, 0xffff
    s_mov_b32 s32, s8
    s_and_b32 s33, s9, 0xffff
    v_lshrrev_b32 v15, 1, v3
    v_mul_u32_u24 v15, 514, v15
    v_and_b32 v16, 1, v1
    v_mul_u32_u24 v16, 126, v16
    v_add_u32 v15, v15, v16
    s_mov_b32 s45, 0x5555
    s_and_b32 s44, s48, 3
    s_cmp_eq_u32 s44, 3
    s_cselect_b32 exec_lo, 0xffff, s45
    s_mov_b32 exec_hi, 0
    buffer_load_ushort v120, v15, s[28:31], s49 offen
    buffer_load_ushort v121, v15, s[32:35], s49 offen
    s_mov_b64 exec, -1
    v_mov_b32 v15, v11
    s_lshl_b32 s50, s48, 13
    s_add_u32 s50, s50, 2752512
    s_mov_b32 s53, 0x05040100
    s_mov_b32 s54, 0x07060302
    v_mov_b32 v11, v4
    v_xor_b32 v12, v12, v13
    v_lshlrev_b32 v12, 4, v12
    v_lshl_add_u32 v12, v13, 10, v12
    s_lshl_b32 s44, s40, 2
    s_add_u32 s44, s44, 0xa000
    v_add_u32 v12, s44, v12
    s_lshl_b32 s44, s40, 5
    v_xor_b32 v13, s44, v4
    s_lshl_b32 s44, s40, 11
    s_add_u32 s44, s44, 0xa000
    v_add_u32 v13, s44, v13
    v_xor_b32 v14, 16, v13
    s_lshl_b32 s44, s40, 11
    s_add_u32 s50, s50, s44
    s_add_u32 s51, s50, 1024
    s_mov_b32 s24, s22
    s_and_b32 s25, s23, 0xffff
    s_mov_b32 s26, 22626304
    s_mov_b32 s27, 0x20000
    s_lshl_b32 s44, s40, 12
    v_add_u32 v30, s44, v4
    v_lshrrev_b32 v31, 1, v4
    v_add_u32 v31, s44, v31
    v_mul_u32_u24 v6, 1040, v3
    v_lshl_add_u32 v6, v2, 8, v6
    s_lshl_b32 s44, s40, 6
    s_add_u32 s44, s44, 16384
    v_add_u32 v6, s44, v6
    s_mul_i32 s44, s40, 4160
    s_add_u32 s44, s44, 16384
    v_add_u32 v7, s44, v4
    v_cmp_eq_u32 vcc, 0, v3
    s_nop 1
    v_cndmask_b32 v8, 0, 1.0, vcc
    s_mov_b32 s62, 0x3f803f80
    v_lshlrev_b32 v9, 6, v3
    v_lshl_add_u32 v9, v2, 4, v9
    s_lshl_b32 s44, s60, 14
    s_lshl_b32 s63, s60, 7
    s_add_u32 s63, s63, 5373952
    s_lshl_b32 s47, s40, 12
    s_add_u32 s44, s44, s47
    s_add_u32 s64, s44, 131072
    s_lshl_b32 s44, s40, 4
    s_add_u32 s44, s44, 0x9000
    v_lshl_add_u32 v10, v2, 2, s44
    s_waitcnt vmcnt(5)
    ds_write_b128 v30, v[32:35] offset:0
    ds_read_b64_tr_b16 v[80:81], v31 offset:0
    ds_read_b64_tr_b16 v[82:83], v31 offset:512
    v_dot2_f32_bf16 v96, v32, s62, 0
    v_dot2_f32_bf16 v100, v32, v32, 0
    v_dot2_f32_bf16 v96, v33, s62, v96
    v_dot2_f32_bf16 v100, v33, v33, v100
    v_dot2_f32_bf16 v96, v34, s62, v96
    v_dot2_f32_bf16 v100, v34, v34, v100
    v_dot2_f32_bf16 v96, v35, s62, v96
    v_dot2_f32_bf16 v100, v35, v35, v100
    s_waitcnt vmcnt(4)
    ds_write_b128 v30, v[36:39] offset:1024
    ds_read_b64_tr_b16 v[84:85], v31 offset:1024
    ds_read_b64_tr_b16 v[86:87], v31 offset:1536
    v_dot2_f32_bf16 v97, v36, s62, 0
    v_dot2_f32_bf16 v101, v36, v36, 0
    v_dot2_f32_bf16 v97, v37, s62, v97
    v_dot2_f32_bf16 v101, v37, v37, v101
    v_dot2_f32_bf16 v97, v38, s62, v97
    v_dot2_f32_bf16 v101, v38, v38, v101
    v_dot2_f32_bf16 v97, v39, s62, v97
    v_dot2_f32_bf16 v101, v39, v39, v101
    s_waitcnt vmcnt(3)
    ds_write_b128 v30, v[40:43] offset:2048
    ds_read_b64_tr_b16 v[88:89], v31 offset:2048
    ds_read_b64_tr_b16 v[90:91], v31 offset:2560
    v_dot2_f32_bf16 v98, v40, s62, 0
    v_dot2_f32_bf16 v102, v40, v40, 0
    v_dot2_f32_bf16 v98, v41, s62, v98
    v_dot2_f32_bf16 v102, v41, v41, v102
    v_dot2_f32_bf16 v98, v42, s62, v98
    v_dot2_f32_bf16 v102, v42, v42, v102
    v_dot2_f32_bf16 v98, v43, s62, v98
    v_dot2_f32_bf16 v102, v43, v43, v102
    s_waitcnt vmcnt(2)
    ds_write_b128 v30, v[44:47] offset:3072
    ds_read_b64_tr_b16 v[92:93], v31 offset:3072
    ds_read_b64_tr_b16 v[94:95], v31 offset:3584
    v_dot2_f32_bf16 v99, v44, s62, 0
    v_dot2_f32_bf16 v103, v44, v44, 0
    v_dot2_f32_bf16 v99, v45, s62, v99
    v_dot2_f32_bf16 v103, v45, v45, v103
    v_dot2_f32_bf16 v99, v46, s62, v99
    v_dot2_f32_bf16 v103, v46, v46, v103
    v_dot2_f32_bf16 v99, v47, s62, v99
    v_dot2_f32_bf16 v103, v47, v47, v103
    s_waitcnt lgkmcnt(9)
    v_mfma_f32_16x16x32_bf16 v[48:51], v[80:83], a[200:203], 0
    v_mfma_f32_16x16x32_bf16 v[52:55], v[80:83], a[204:207], 0
    v_permlane32_swap_b32 v96, v98
    v_permlane32_swap_b32 v97, v99
    v_permlane32_swap_b32 v100, v102
    v_permlane32_swap_b32 v101, v103
    v_add_f32 v96, v96, v98
    v_add_f32 v97, v97, v99
    v_add_f32 v100, v100, v102
    v_add_f32 v101, v101, v103
    s_waitcnt lgkmcnt(6)
    v_mfma_f32_16x16x32_bf16 v[56:59], v[84:87], a[200:203], 0
    v_permlane16_swap_b32 v96, v97
    v_permlane16_swap_b32 v100, v101
    v_add_f32 v96, v96, v97
    v_add_f32 v100, v100, v101
    v_mfma_f32_16x16x32_bf16 v[60:63], v[84:87], a[204:207], 0
    v_add_f32_dpp v96, v96, v96 row_ror:8 row_mask:0xf bank_mask:0xf
    v_add_f32_dpp v100, v100, v100 row_ror:8 row_mask:0xf bank_mask:0xf
    s_waitcnt lgkmcnt(3)
    v_mfma_f32_16x16x32_bf16 v[64:67], v[88:91], a[200:203], 0
    v_add_f32_dpp v96, v96, v96 row_ror:4 row_mask:0xf bank_mask:0xf
    v_add_f32_dpp v100, v100, v100 row_ror:4 row_mask:0xf bank_mask:0xf
    v_mfma_f32_16x16x32_bf16 v[68:71], v[88:91], a[204:207], 0
    v_add_f32_dpp v96, v96, v96 row_ror:2 row_mask:0xf bank_mask:0xf
    v_add_f32_dpp v100, v100, v100 row_ror:2 row_mask:0xf bank_mask:0xf
    s_waitcnt lgkmcnt(0)
    v_mfma_f32_16x16x32_bf16 v[72:75], v[92:95], a[200:203], 0
    v_add_f32_dpp v96, v96, v96 row_ror:1 row_mask:0xf bank_mask:0xf
    v_add_f32_dpp v100, v100, v100 row_ror:1 row_mask:0xf bank_mask:0xf
    v_mfma_f32_16x16x32_bf16 v[76:79], v[92:95], a[204:207], 0
    v_mul_f32 v96, 0x3b000000, v96
    v_mul_f32 v100, 0x3b000000, v100
    v_fma_f32 v100, -v96, v96, v100
    v_max_f32 v100, 0, v100
    v_add_f32 v100, 0x3727c5ac, v100
    v_rsq_f32 v97, v100
    v_mul_f32 v98, 0xc0000000, v96
    v_mul_f32 v98, v98, v97
    v_mul_f32 v99, 0x3d800000, v97
    s_nop 0
    v_readlane_b32 s68, v99, 0
    v_readlane_b32 s69, v98, 0
    v_readlane_b32 s70, v99, 16
    v_readlane_b32 s71, v98, 16
    v_readlane_b32 s72, v99, 32
    v_readlane_b32 s73, v98, 32
    v_readlane_b32 s74, v99, 48
    v_readlane_b32 s75, v98, 48
    v_mul_f32 v80, s69, v8
    v_pk_mul_f32 v[52:53], v[52:53], s[68:69] op_sel_hi:[1,0]
    v_pk_mul_f32 v[54:55], v[54:55], s[68:69] op_sel_hi:[1,0]
    v_pk_fma_f32 v[48:49], v[48:49], s[68:69], v[80:81] op_sel_hi:[1,0,0]
    v_pk_fma_f32 v[50:51], v[50:51], s[68:69], v[80:81] op_sel_hi:[1,0,0]
    v_cvt_pk_f16_f32 v34, v52, v53
    v_cvt_pk_f16_f32 v35, v54, v55
    v_cvt_pk_f16_f32 v32, v48, v49
    v_cvt_pk_f16_f32 v33, v50, v51
    ds_write_b128 v6, v[32:35] offset:0
    v_mul_f32 v80, s71, v8
    v_pk_mul_f32 v[60:61], v[60:61], s[70:71] op_sel_hi:[1,0]
    v_pk_mul_f32 v[62:63], v[62:63], s[70:71] op_sel_hi:[1,0]
    v_pk_fma_f32 v[56:57], v[56:57], s[70:71], v[80:81] op_sel_hi:[1,0,0]
    v_pk_fma_f32 v[58:59], v[58:59], s[70:71], v[80:81] op_sel_hi:[1,0,0]
    v_cvt_pk_f16_f32 v38, v60, v61
    v_cvt_pk_f16_f32 v39, v62, v63
    v_cvt_pk_f16_f32 v36, v56, v57
    v_cvt_pk_f16_f32 v37, v58, v59
    ds_write_b128 v6, v[36:39] offset:16
    v_mul_f32 v80, s73, v8
    v_pk_mul_f32 v[68:69], v[68:69], s[72:73] op_sel_hi:[1,0]
    v_pk_mul_f32 v[70:71], v[70:71], s[72:73] op_sel_hi:[1,0]
    v_pk_fma_f32 v[64:65], v[64:65], s[72:73], v[80:81] op_sel_hi:[1,0,0]
    v_pk_fma_f32 v[66:67], v[66:67], s[72:73], v[80:81] op_sel_hi:[1,0,0]
    v_cvt_pk_f16_f32 v42, v68, v69
    v_cvt_pk_f16_f32 v43, v70, v71
    v_cvt_pk_f16_f32 v40, v64, v65
    v_cvt_pk_f16_f32 v41, v66, v67
    ds_write_b128 v6, v[40:43] offset:32
    v_mul_f32 v80, s75, v8
    v_pk_mul_f32 v[76:77], v[76:77], s[74:75] op_sel_hi:[1,0]
    v_pk_mul_f32 v[78:79], v[78:79], s[74:75] op_sel_hi:[1,0]
    v_pk_fma_f32 v[72:73], v[72:73], s[74:75], v[80:81] op_sel_hi:[1,0,0]
    v_pk_fma_f32 v[74:75], v[74:75], s[74:75], v[80:81] op_sel_hi:[1,0,0]
    v_cvt_pk_f16_f32 v46, v76, v77
    v_cvt_pk_f16_f32 v47, v78, v79
    v_cvt_pk_f16_f32 v44, v72, v73
    v_cvt_pk_f16_f32 v45, v74, v75
    ds_write_b128 v6, v[44:47] offset:48
    v_mul_f32 v100, v100, v97
    ds_write2_b32 v10, v100, v96 offset0:0 offset1:16
    buffer_load_dwordx4 v[104:107], v15, s[28:31], s49 offen
    buffer_load_dwordx4 v[108:111], v15, s[32:35], s49 offen
    s_waitcnt lgkmcnt(0)
    s_barrier
    ds_read_b128 v[80:83], v7 offset:0
    ds_read_b128 v[84:87], v7 offset:1040
    ds_read_b128 v[88:91], v7 offset:2080
    ds_read_b128 v[92:95], v7 offset:3120
    ds_read_b128 v[96:99], v4 offset:0x9000
    v_mov_b32 v250, 0
    global_load_dword v254, v250, s[20:21] sc1
    s_waitcnt lgkmcnt(4)
    v_mfma_f32_16x16x32_f16 v[48:51], v[80:83], v[144:147], 0
    v_mfma_f32_16x16x32_f16 v[52:55], v[80:83], v[148:151], 0
    s_waitcnt lgkmcnt(3)
    v_mfma_f32_16x16x32_f16 v[56:59], v[84:87], v[152:155], 0
    v_mfma_f32_16x16x32_f16 v[60:63], v[84:87], v[156:159], 0
    s_waitcnt lgkmcnt(2)
    v_mfma_f32_16x16x32_f16 v[64:67], v[88:91], v[160:163], 0
    v_mfma_f32_16x16x32_f16 v[68:71], v[88:91], v[164:167], 0
    s_waitcnt lgkmcnt(1)
    v_mfma_f32_16x16x32_f16 v[72:75], v[92:95], v[168:171], 0
    v_mfma_f32_16x16x32_f16 v[76:79], v[92:95], v[172:175], 0
    s_waitcnt lgkmcnt(0)
    s_cmp_lg_u32 s40, 3
    s_cbranch_scc1 L_ow3
    s_mov_b64 exec, 0xff
    buffer_store_dwordx4 v[96:99], v4, s[24:27], s63 offen sc1
    s_mov_b64 exec, -1
L_ow3:
    v_cvt_pk_f16_f32 v32, v48, v49
    v_cvt_pk_f16_f32 v33, v50, v51
    v_cvt_pk_f16_f32 v34, v52, v53
    v_cvt_pk_f16_f32 v35, v54, v55
    buffer_store_dwordx4 v[32:35], v9, s[24:27], s64 offen offset:0 sc1
    v_cvt_pk_f16_f32 v36, v56, v57
    v_cvt_pk_f16_f32 v37, v58, v59
    v_cvt_pk_f16_f32 v38, v60, v61
    v_cvt_pk_f16_f32 v39, v62, v63
    buffer_store_dwordx4 v[36:39], v9, s[24:27], s64 offen offset:1024 sc1
    v_cvt_pk_f16_f32 v40, v64, v65
    v_cvt_pk_f16_f32 v41, v66, v67
    v_cvt_pk_f16_f32 v42, v68, v69
    v_cvt_pk_f16_f32 v43, v70, v71
    buffer_store_dwordx4 v[40:43], v9, s[24:27], s64 offen offset:2048 sc1
    v_cvt_pk_f16_f32 v44, v72, v73
    v_cvt_pk_f16_f32 v45, v74, v75
    v_cvt_pk_f16_f32 v46, v76, v77
    v_cvt_pk_f16_f32 v47, v78, v79
    buffer_store_dwordx4 v[44:47], v9, s[24:27], s64 offen offset:3072 sc1
    s_waitcnt vmcnt(5)
    v_perm_b32 v120, v108, v104, s53
    ds_write_b32 v12, v120 offset:0
    v_perm_b32 v121, v108, v104, s54
    ds_write_b32 v12, v121 offset:128
    v_perm_b32 v122, v109, v105, s53
    ds_write_b32 v12, v122 offset:256
    v_perm_b32 v123, v109, v105, s54
    ds_write_b32 v12, v123 offset:384
    v_perm_b32 v124, v110, v106, s53
    ds_write_b32 v12, v124 offset:512
    v_perm_b32 v125, v110, v106, s54
    ds_write_b32 v12, v125 offset:640
    v_perm_b32 v126, v111, v107, s53
    ds_write_b32 v12, v126 offset:768
    v_perm_b32 v127, v111, v107, s54
    ds_write_b32 v12, v127 offset:896
    s_waitcnt lgkmcnt(0)
    s_barrier
    ds_read_b128 v[104:107], v13 offset:0
    ds_read_b128 v[108:111], v14 offset:1024
    s_waitcnt lgkmcnt(1)
    buffer_store_dwordx4 v[104:107], v11, s[24:27], s50 offen sc1
    s_waitcnt lgkmcnt(0)
    buffer_store_dwordx4 v[108:111], v11, s[24:27], s51 offen sc1
    s_lshl_b32 s44, s40, 13
    s_add_u32 s44, s44, 6144
    s_add_u32 s46, s42, s44
    s_addc_u32 s47, s43, 0
    v_mov_b32 v27, s47
    v_add_co_u32 v26, vcc, s46, v4
    s_nop 1
    v_addc_co_u32 v27, vcc, 0, v27, vcc
    s_add_u32 s46, s42, 38912
    s_addc_u32 s47, s43, 0
    v_mov_b32 v29, s47
    v_add_co_u32 v28, vcc, s46, v4
    s_nop 1
    v_addc_co_u32 v29, vcc, 0, v29, vcc
L_join1:
    s_and_b32 s44, s2, 1
    s_lshl_b32 s44, s44, 3
    s_bfe_u32 s45, s2, 0x30003
    s_add_u32 s48, s44, s45
    s_bfe_u32 s44, s2, 0x20001
    s_lshl_b32 s44, s44, 2
    s_lshr_b32 s46, s2, 6
    s_add_u32 s49, s44, s46
    s_lshl_b32 s46, s46, 1
    s_mov_b32 s53, 0
    s_lshl_b32 s46, s48, 11
    s_lshl_b32 s47, s49, 7
    s_add_u32 s41, s46, s47
    s_add_u32 s41, s41, 65536
    v_mov_b32 v250, 0
    s_and_b32 s74, s2, 7
    s_lshl_b32 s74, s74, 8
    s_add_u32 s75, s74, 4096
    s_and_b32 s44, s2, 1
    s_mul_i32 s44, s44, 44
    s_bfe_u32 s45, s2, 0x20001
    s_mul_i32 s45, s45, 11
    s_add_u32 s44, s44, s45
    s_bfe_u32 s45, s2, 0x40003
    s_add_u32 s44, s44, s45
    s_sub_u32 s45, s2, 160
    s_cmp_ge_u32 s2, 248
    s_cselect_b32 s44, s45, s44
    s_cselect_b32 s46, 0, s2
    s_lshl_b32 s44, s44, 7
    s_add_u32 s71, s44, 20480
    s_cmp_lt_u32 s2, 128
    s_cselect_b32 s71, 0, s71
    s_cmp_ge_u32 s46, 216
    s_cselect_b32 s71, 0, s71
    v_mov_b32 v251, 1
    s_mov_b32 s63, 0x80008000
    s_cmp_lg_u32 s40, 0
    s_cbranch_scc1 L_b1o
    s_mov_b64 exec, 1
    s_mov_b32 s46, 0
    s_waitcnt vmcnt(0)
L_go:
    v_cmp_ne_u32 vcc, 0, v254
    s_add_u32 s46, s46, 1
    s_cbranch_vccnz L_gone
    global_load_dword v254, v250, s[20:21] sc1
    s_waitcnt vmcnt(0)
    s_cmp_lt_u32 s46, 400000
    s_cbranch_scc1 L_go
L_gone:
    s_barrier
    s_cmp_eq_u32 s71, 0
    s_cbranch_scc1 L_b1a
    buffer_store_dword v251, v250, s[24:27], s71 offen sc1
    s_mov_b64 exec, -1
    s_branch L_b1n
L_b1a:
    buffer_atomic_add v251, v250, s[24:27], s74 offen sc0 sc1
    s_mov_b64 exec, -1
    s_mul_i32 s44, s49, 11
    s_add_u32 s45, s44, 10
    s_lshr_b32 s44, s44, 2
    s_lshr_b32 s45, s45, 2
    v_and_b32 v23, 3, v1
    v_add_u32 v23, s44, v23
    v_min_u32 v23, s45, v23
    v_bfe_u32 v240, v1, 2, 1
    v_mul_u32_u24 v240, 44, v240
    v_add_u32 v23, v23, v240
    s_lshr_b32 s44, s49, 1
    s_add_u32 s44, s44, 88
    v_mov_b32 v240, s44
    v_cmp_gt_u32 vcc, 8, v1
    s_nop 1
    v_cndmask_b32 v23, v240, v23, vcc
    v_lshlrev_b32 v23, 7, v23
    v_add_u32 v23, 20480, v23
    s_cmp_ge_u32 s2, 216
    s_cbranch_scc1 L_tw4
    s_lshl_b32 s44, s40, 4
    v_add_u32 v240, s44, v3
    v_cvt_f32_u32 v240, v240
    v_mul_f32 v240, 0x3a000000, v240
    v_lshlrev_b32 v241, 2, v2
    v_add_u32 v242, s44, v241
    v_cvt_f32_u32 v241, v241
    v_cvt_f32_u32 v242, v242
    v_cvt_f32_u32 v243, v3
    v_mul_f32 v243, 0x3a000000, v243
    v_add_f32 v112, 0x00000000, v241
    v_mul_f32 v112, v112, v240
    v_sin_f32 v116, v112
    v_cos_f32 v112, v112
    v_add_f32 v113, 0x3f800000, v241
    v_mul_f32 v113, v113, v240
    v_sin_f32 v117, v113
    v_cos_f32 v113, v113
    v_add_f32 v114, 0x40000000, v241
    v_mul_f32 v114, v114, v240
    v_sin_f32 v118, v114
    v_cos_f32 v114, v114
    v_add_f32 v115, 0x40400000, v241
    v_mul_f32 v115, v115, v240
    v_sin_f32 v119, v115
    v_cos_f32 v115, v115
    v_add_f32 v120, 0x41800000, v241
    v_mul_f32 v120, v120, v240
    v_sin_f32 v124, v120
    v_cos_f32 v120, v120
    v_add_f32 v121, 0x41880000, v241
    v_mul_f32 v121, v121, v240
    v_sin_f32 v125, v121
    v_cos_f32 v121, v121
    v_add_f32 v122, 0x41900000, v241
    v_mul_f32 v122, v122, v240
    v_sin_f32 v126, v122
    v_cos_f32 v122, v122
    v_add_f32 v123, 0x41980000, v241
    v_mul_f32 v123, v123, v240
    v_sin_f32 v127, v123
    v_cos_f32 v123, v123
    v_add_f32 v128, 0x00000000, v242
    v_mul_f32 v128, v128, v243
    v_sin_f32 v132, v128
    v_cos_f32 v128, v128
    v_add_f32 v129, 0x3f800000, v242
    v_mul_f32 v129, v129, v243
    v_sin_f32 v133, v129
    v_cos_f32 v129, v129
    v_add_f32 v130, 0x40000000, v242
    v_mul_f32 v130, v130, v243
    v_sin_f32 v134, v130
    v_cos_f32 v130, v130
    v_add_f32 v131, 0x40400000, v242
    v_mul_f32 v131, v131, v243
    v_sin_f32 v135, v131
    v_cos_f32 v131, v131
    v_add_f32 v243, 0x3c000000, v243
    v_add_f32 v136, 0x00000000, v242
    v_mul_f32 v136, v136, v243
    v_sin_f32 v140, v136
    v_cos_f32 v136, v136
    v_add_f32 v137, 0x3f800000, v242
    v_mul_f32 v137, v137, v243
    v_sin_f32 v141, v137
    v_cos_f32 v137, v137
    v_add_f32 v138, 0x40000000, v242
    v_mul_f32 v138, v138, v243
    v_sin_f32 v142, v138
    v_cos_f32 v138, v138
    v_add_f32 v139, 0x40400000, v242
    v_mul_f32 v139, v139, v243
    v_sin_f32 v143, v139
    v_cos_f32 v139, v139
    s_nop 4
L_tw4:
    s_add_u32 s45, s40, 0
    s_and_b32 s45, s45, 3
    s_lshl_b32 s45, s45, 11
    v_add_u32 v16, s45, v4
    s_add_u32 s45, s40, 1
    s_and_b32 s45, s45, 3
    s_lshl_b32 s45, s45, 11
    v_add_u32 v17, s45, v4
    s_add_u32 s45, s40, 2
    s_and_b32 s45, s45, 3
    s_lshl_b32 s45, s45, 11
    v_add_u32 v18, s45, v4
    s_add_u32 s45, s40, 3
    s_and_b32 s45, s45, 3
    s_lshl_b32 s45, s45, 11
    v_add_u32 v19, s45, v4
    s_and_b32 s58, s2, 0xf6
    s_bfe_u32 s45, s2, 0x10003
    s_add_u32 s58, s58, s45
    s_and_b32 s45, s2, 1
    s_lshl_b32 s45, s45, 3
    s_add_u32 s58, s58, s45
    s_lshl_b32 s44, s58, 6
    s_lshl_b32 s45, s40, 19
    s_add_u32 s44, s44, s45
    s_add_u32 s55, s44, 131072
    s_add_u32 s56, s55, 0x10000
    s_lshr_b32 s44, s58, 4
    s_sub_u32 s45, 32, s44
    s_cmp_eq_u32 s44, 0
    s_cselect_b32 s45, 16, s45
    s_bitcmp1_b32 s58, 3
    s_cselect_b32 s44, s45, s44
    s_and_b32 s45, s58, 7
    s_lshl_b32 s45, s45, 5
    s_add_u32 s44, s44, s45
    s_sub_u32 s44, s44, 1
    s_and_b32 s44, s44, 255
    s_lshl_b32 s44, s44, 7
    s_lshl_b32 s45, s40, 16
    s_add_u32 s44, s44, s45
    s_add_u32 s59, s44, 2752512
    s_add_u32 s60, s59, 0x100000
    v_and_b32 v15, 7, v1
    v_lshlrev_b32 v15, 4, v15
    v_bfe_u32 v14, v1, 3, 1
    v_lshl_add_u32 v15, v14, 15, v15
    v_lshl_add_u32 v15, v2, 18, v15
    s_lshl_b32 s45, s40, 12
    s_add_u32 s61, s45, 5373952
    v_lshrrev_b32 v21, 2, v3
    v_lshlrev_b32 v21, 7, v21
    v_lshl_add_u32 v21, v2, 10, v21
    v_and_b32 v22, 3, v1
    v_lshlrev_b32 v14, 4, v22
    v_lshl_add_u32 v14, v21, 7, v14
    v_lshl_add_u32 v22, v22, 4, v21
    s_mov_b32 s63, 0x80008000
    s_mov_b64 exec, 0xff
    v_lshlrev_b32 v252, 11, v1
    v_mov_b32 v250, 1
    s_waitcnt vmcnt(0)
    v_readfirstlane_b32 s47, v251
    s_nop 0
    s_cmp_lg_u32 s47, 19
    s_cbranch_scc1 L_nl5
    buffer_store_dword v250, v252, s[24:27], s75 offen sc1
L_nl5:
    s_mov_b64 exec, -1
    s_cmp_lg_u32 s71, 0
    s_cbranch_scc1 L_zt6
    global_load_dwordx4 v[146:149], v[26:27], off offset:-4096
    global_load_dwordx4 v[152:155], v[26:27], off offset:-3072
    global_load_dwordx4 v[158:161], v[26:27], off offset:-2048
    global_load_dwordx4 v[164:167], v[26:27], off offset:-1024
    global_load_dwordx4 v[194:197], v[28:29], off offset:-4096
    global_load_dwordx4 v[200:203], v[28:29], off offset:-3072
    global_load_dwordx4 v[206:209], v[28:29], off offset:-2048
    global_load_dwordx4 v[212:215], v[28:29], off offset:-1024
    global_load_dwordx4 v[218:221], v[28:29], off offset:0
    global_load_dwordx4 v[224:227], v[28:29], off offset:1024
    global_load_dwordx4 v[230:233], v[28:29], off offset:2048
    global_load_dwordx4 v[236:239], v[28:29], off offset:3072
    global_load_dwordx4 v[170:173], v[26:27], off offset:0
    global_load_dwordx4 v[176:179], v[26:27], off offset:1024
    global_load_dwordx4 v[182:185], v[26:27], off offset:2048
    global_load_dwordx4 v[188:191], v[26:27], off offset:3072
L_zt6:
    s_mov_b64 exec, -1
    s_branch L_b1m
L_b1o:
    s_waitcnt vmcnt(0)
    s_barrier
L_b1n:
    s_cmp_lg_u32 s71, 0
    s_cbranch_scc1 L_zt7
    global_load_dwordx4 v[146:149], v[26:27], off offset:-4096
    global_load_dwordx4 v[152:155], v[26:27], off offset:-3072
    global_load_dwordx4 v[158:161], v[26:27], off offset:-2048
    global_load_dwordx4 v[164:167], v[26:27], off offset:-1024
    global_load_dwordx4 v[194:197], v[28:29], off offset:-4096
    global_load_dwordx4 v[200:203], v[28:29], off offset:-3072
    global_load_dwordx4 v[206:209], v[28:29], off offset:-2048
    global_load_dwordx4 v[212:215], v[28:29], off offset:-1024
    global_load_dwordx4 v[218:221], v[28:29], off offset:0
    global_load_dwordx4 v[224:227], v[28:29], off offset:1024
    global_load_dwordx4 v[230:233], v[28:29], off offset:2048
    global_load_dwordx4 v[236:239], v[28:29], off offset:3072
    global_load_dwordx4 v[170:173], v[26:27], off offset:0
    global_load_dwordx4 v[176:179], v[26:27], off offset:1024
    global_load_dwordx4 v[182:185], v[26:27], off offset:2048
    global_load_dwordx4 v[188:191], v[26:27], off offset:3072
L_zt7:
    s_mul_i32 s44, s49, 11
    s_add_u32 s45, s44, 10
    s_lshr_b32 s44, s44, 2
    s_lshr_b32 s45, s45, 2
    v_and_b32 v23, 3, v1
    v_add_u32 v23, s44, v23
    v_min_u32 v23, s45, v23
    v_bfe_u32 v240, v1, 2, 1
    v_mul_u32_u24 v240, 44, v240
    v_add_u32 v23, v23, v240
    s_lshr_b32 s44, s49, 1
    s_add_u32 s44, s44, 88
    v_mov_b32 v240, s44
    v_cmp_gt_u32 vcc, 8, v1
    s_nop 1
    v_cndmask_b32 v23, v240, v23, vcc
    v_lshlrev_b32 v23, 7, v23
    v_add_u32 v23, 20480, v23
    s_cmp_ge_u32 s2, 216
    s_cbranch_scc1 L_tw8
    s_lshl_b32 s44, s40, 4
    v_add_u32 v240, s44, v3
    v_cvt_f32_u32 v240, v240
    v_mul_f32 v240, 0x3a000000, v240
    v_lshlrev_b32 v241, 2, v2
    v_add_u32 v242, s44, v241
    v_cvt_f32_u32 v241, v241
    v_cvt_f32_u32 v242, v242
    v_cvt_f32_u32 v243, v3
    v_mul_f32 v243, 0x3a000000, v243
    v_add_f32 v112, 0x00000000, v241
    v_mul_f32 v112, v112, v240
    v_sin_f32 v116, v112
    v_cos_f32 v112, v112
    v_add_f32 v113, 0x3f800000, v241
    v_mul_f32 v113, v113, v240
    v_sin_f32 v117, v113
    v_cos_f32 v113, v113
    v_add_f32 v114, 0x40000000, v241
    v_mul_f32 v114, v114, v240
    v_sin_f32 v118, v114
    v_cos_f32 v114, v114
    v_add_f32 v115, 0x40400000, v241
    v_mul_f32 v115, v115, v240
    v_sin_f32 v119, v115
    v_cos_f32 v115, v115
    v_add_f32 v120, 0x41800000, v241
    v_mul_f32 v120, v120, v240
    v_sin_f32 v124, v120
    v_cos_f32 v120, v120
    v_add_f32 v121, 0x41880000, v241
    v_mul_f32 v121, v121, v240
    v_sin_f32 v125, v121
    v_cos_f32 v121, v121
    v_add_f32 v122, 0x41900000, v241
    v_mul_f32 v122, v122, v240
    v_sin_f32 v126, v122
    v_cos_f32 v122, v122
    v_add_f32 v123, 0x41980000, v241
    v_mul_f32 v123, v123, v240
    v_sin_f32 v127, v123
    v_cos_f32 v123, v123
    v_add_f32 v128, 0x00000000, v242
    v_mul_f32 v128, v128, v243
    v_sin_f32 v132, v128
    v_cos_f32 v128, v128
    v_add_f32 v129, 0x3f800000, v242
    v_mul_f32 v129, v129, v243
    v_sin_f32 v133, v129
    v_cos_f32 v129, v129
    v_add_f32 v130, 0x40000000, v242
    v_mul_f32 v130, v130, v243
    v_sin_f32 v134, v130
    v_cos_f32 v130, v130
    v_add_f32 v131, 0x40400000, v242
    v_mul_f32 v131, v131, v243
    v_sin_f32 v135, v131
    v_cos_f32 v131, v131
    v_add_f32 v243, 0x3c000000, v243
    v_add_f32 v136, 0x00000000, v242
    v_mul_f32 v136, v136, v243
    v_sin_f32 v140, v136
    v_cos_f32 v136, v136
    v_add_f32 v137, 0x3f800000, v242
    v_mul_f32 v137, v137, v243
    v_sin_f32 v141, v137
    v_cos_f32 v137, v137
    v_add_f32 v138, 0x40000000, v242
    v_mul_f32 v138, v138, v243
    v_sin_f32 v142, v138
    v_cos_f32 v138, v138
    v_add_f32 v139, 0x40400000, v242
    v_mul_f32 v139, v139, v243
    v_sin_f32 v143, v139
    v_cos_f32 v139, v139
    s_nop 4
L_tw8:
    s_add_u32 s45, s40, 0
    s_and_b32 s45, s45, 3
    s_lshl_b32 s45, s45, 11
    v_add_u32 v16, s45, v4
    s_add_u32 s45, s40, 1
    s_and_b32 s45, s45, 3
    s_lshl_b32 s45, s45, 11
    v_add_u32 v17, s45, v4
    s_add_u32 s45, s40, 2
    s_and_b32 s45, s45, 3
    s_lshl_b32 s45, s45, 11
    v_add_u32 v18, s45, v4
    s_add_u32 s45, s40, 3
    s_and_b32 s45, s45, 3
    s_lshl_b32 s45, s45, 11
    v_add_u32 v19, s45, v4
    s_and_b32 s58, s2, 0xf6
    s_bfe_u32 s45, s2, 0x10003
    s_add_u32 s58, s58, s45
    s_and_b32 s45, s2, 1
    s_lshl_b32 s45, s45, 3
    s_add_u32 s58, s58, s45
    s_lshl_b32 s44, s58, 6
    s_lshl_b32 s45, s40, 19
    s_add_u32 s44, s44, s45
    s_add_u32 s55, s44, 131072
    s_add_u32 s56, s55, 0x10000
    s_lshr_b32 s44, s58, 4
    s_sub_u32 s45, 32, s44
    s_cmp_eq_u32 s44, 0
    s_cselect_b32 s45, 16, s45
    s_bitcmp1_b32 s58, 3
    s_cselect_b32 s44, s45, s44
    s_and_b32 s45, s58, 7
    s_lshl_b32 s45, s45, 5
    s_add_u32 s44, s44, s45
    s_sub_u32 s44, s44, 1
    s_and_b32 s44, s44, 255
    s_lshl_b32 s44, s44, 7
    s_lshl_b32 s45, s40, 16
    s_add_u32 s44, s44, s45
    s_add_u32 s59, s44, 2752512
    s_add_u32 s60, s59, 0x100000
    v_and_b32 v15, 7, v1
    v_lshlrev_b32 v15, 4, v15
    v_bfe_u32 v14, v1, 3, 1
    v_lshl_add_u32 v15, v14, 15, v15
    v_lshl_add_u32 v15, v2, 18, v15
    s_lshl_b32 s45, s40, 12
    s_add_u32 s61, s45, 5373952
    v_lshrrev_b32 v21, 2, v3
    v_lshlrev_b32 v21, 7, v21
    v_lshl_add_u32 v21, v2, 10, v21
    v_and_b32 v22, 3, v1
    v_lshlrev_b32 v14, 4, v22
    v_lshl_add_u32 v14, v21, 7, v14
    v_lshl_add_u32 v22, v22, 4, v21
    s_mov_b32 s63, 0x80008000
L_b1m:
    s_waitcnt vmcnt(0)
    v_xor_b32 v144, s63, v148
    v_xor_b32 v145, s63, v149
    v_xor_b32 v150, s63, v154
    v_xor_b32 v151, s63, v155
    v_xor_b32 v156, s63, v160
    v_xor_b32 v157, s63, v161
    v_xor_b32 v162, s63, v166
    v_xor_b32 v163, s63, v167
    v_xor_b32 v192, s63, v196
    v_xor_b32 v193, s63, v197
    v_xor_b32 v198, s63, v202
    v_xor_b32 v199, s63, v203
    v_xor_b32 v204, s63, v208
    v_xor_b32 v205, s63, v209
    v_xor_b32 v210, s63, v214
    v_xor_b32 v211, s63, v215
    v_xor_b32 v216, s63, v220
    v_xor_b32 v217, s63, v221
    v_xor_b32 v222, s63, v226
    v_xor_b32 v223, s63, v227
    v_xor_b32 v228, s63, v232
    v_xor_b32 v229, s63, v233
    v_xor_b32 v234, s63, v238
    v_xor_b32 v235, s63, v239
    v_xor_b32 v168, s63, v172
    v_xor_b32 v169, s63, v173
    v_xor_b32 v174, s63, v178
    v_xor_b32 v175, s63, v179
    v_xor_b32 v180, s63, v184
    v_xor_b32 v181, s63, v185
    v_xor_b32 v186, s63, v190
    v_xor_b32 v187, s63, v191
L_b1q:
    s_cmp_lg_u32 s40, 1
    s_cbranch_scc1 L_ow9
    v_lshlrev_b32 v252, 15, v1
    s_mov_b64 exec, 3
    buffer_store_dword v250, v252, s[24:27], s41 offen sc1
    s_mov_b64 exec, -1
L_ow9:
    s_cmp_lg_u32 s40, 0
    s_cbranch_scc1 L_ow10
    s_mov_b64 exec, 0xff
    v_lshlrev_b32 v253, 8, v1
    s_and_b32 s44, s2, 7
    s_lshl_b32 s44, s44, 11
    s_add_u32 s44, s44, 4096
    s_mov_b32 s46, 0
L_bp11:
    buffer_load_dword v251, v253, s[24:27], s44 offen sc1
    s_add_u32 s46, s46, 1
    s_waitcnt vmcnt(0)
    v_cmp_gt_u32 vcc, 1, v251
    s_cmp_gt_u32 s46, 400000
    s_cbranch_scc1 L_bd11
    s_cbranch_vccnz L_bp11
L_bd11:
    s_mov_b64 exec, -1
    s_mov_b64 exec, -1
L_ow10:
L_b1x:
    s_barrier
    buffer_load_dwordx4 v[32:35], v14, s[24:27], s55 offen sc1
    buffer_load_dwordx4 v[36:39], v14, s[24:27], s56 offen sc1
    v_lshrrev_b32 v20, 2, v1
    v_lshlrev_b32 v20, 15, v20
    v_and_b32 v24, 3, v1
    v_lshl_add_u32 v20, v24, 4, v20
    s_lshr_b32 s44, s58, 5
    s_lshl_b32 s44, s44, 6
    s_and_b32 s45, s58, 31
    s_add_u32 s44, s44, s45
    s_lshl_b32 s44, s44, 6
    s_lshl_b32 s45, s40, 19
    s_add_u32 s44, s44, s45
    s_add_u32 s62, s44, 5390336
    s_mul_i32 s44, s49, 11
    s_mul_i32 s45, s40, 3
    buffer_load_dword v26, v23, s[24:27], 0 offen sc1
    s_add_u32 s50, s44, s45
    s_add_u32 s44, s50, s49
    s_mul_i32 s44, s44, 16384
    s_add_u32 s44, s44, 7487488
    v_add_u32 v248, s44, v4
    v_add_u32 v249, 16384, v248
    v_add_u32 v255, 32768, v248
    s_and_b32 s46, s40, 1
    s_lshr_b32 s47, s40, 1
    s_lshl_b32 s45, s46, 15
    s_lshl_b32 s54, s47, 12
    s_add_u32 m0, s54, s45
    s_lshl_b32 s44, s48, 17
    s_add_u32 s44, s44, 5390336
    buffer_load_dwordx4 v[68:71], v15, s[24:27], s59 offen sc1
    v_and_b32 v6, 1, v2
    v_lshlrev_b32 v6, 5, v6
    v_xor_b32 v5, v6, v4
    v_add_u32 v5, s44, v5
    v_lshrrev_b32 v7, 2, v1
    v_lshl_add_u32 v6, v7, 6, v6
    v_lshl_add_u32 v6, v24, 3, v6
    s_lshl_b32 s44, s47, 5
    s_add_u32 s44, s44, s45
    v_xor_b32 v6, s44, v6
    v_xor_b32 v7, 32, v6
    v_lshrrev_b32 v9, 2, v3
    v_cmp_eq_u32 vcc, v9, v2
    s_lshl_b32 s47, s47, 8
    buffer_load_dwordx4 v[76:79], v15, s[24:27], s60 offen sc1
    s_lshl_b32 s44, s46, 9
    s_add_u32 s44, s44, s47
    s_add_u32 s44, s44, 131072
    v_lshl_add_u32 v10, v3, 4, s44
    v_xor_b32 v8, 0x100, v10
    v_add_u32 v9, 133120, v4
    v_cndmask_b32 v9, v9, v10, vcc
    v_lshrrev_b32 v24, 1, v2
    v_lshlrev_b32 v11, 8, v24
    v_xor_b32 v11, v11, v10
    s_mov_b32 s64, 0x22222222
    s_mov_b32 s65, s64
    s_mov_b32 s66, 0x44444444
    s_mov_b32 s67, s66
    buffer_load_dwordx4 v[80:83], v22, s[24:27], s61 offen sc1
    s_mov_b32 s68, 0x88888888
    s_mov_b32 s69, s68
    v_add_u32 v25, s50, v24
    v_lshrrev_b32 v12, 1, v25
    v_mul_u32_u24 v12, 65536, v12
    v_and_b32 v25, 1, v25
    v_lshl_add_u32 v12, v25, 9, v12
    v_and_b32 v25, 0x1f0, v4
    v_xor_b32 v25, s47, v25
    v_add_u32 v12, v25, v12
    s_add_u32 s44, s50, 2
    s_lshr_b32 s45, s44, 1
    s_mul_i32 s45, s45, 65536
    s_and_b32 s44, s44, 1
    buffer_load_dwordx4 v[84:87], v22, s[24:27], s61 offen offset:512 sc1
    s_lshl_b32 s44, s44, 9
    s_add_u32 s44, s44, s45
    v_lshlrev_b32 v13, 8, v24
    v_xor_b32 v13, s47, v13
    v_add_u32 v13, s44, v13
    v_lshl_add_u32 v13, v3, 4, v13
    v_and_b32 v25, 1, v2
    v_xor_b32 v25, 1, v25
    v_lshlrev_b32 v25, 10, v25
    s_lshl_b32 s44, s46, 1
    s_sub_u32 s44, 1, s44
    v_mul_i32_i24 v25, s44, v25
    v_sub_u32 v13, v13, v25
    s_mov_b32 s32, s24
    s_mov_b32 s33, s25
    s_mov_b32 s34, 18628608
    s_mov_b32 s35, 0x20000
    s_mov_b32 s28, s24
    s_mov_b32 s29, s25
    s_mov_b32 s31, 0x20000
    s_mov_b32 s36, s24
    s_mov_b32 s37, s25
    s_mov_b32 s39, 0x20000
    s_mov_b32 s70, 4096
    s_mov_b32 s71, 8192
    s_mov_b32 s72, 12288
    s_waitcnt vmcnt(6)
    ds_write_b128 v16, v[32:35] offset:8192
    s_waitcnt vmcnt(5)
    ds_write_b128 v16, v[36:39] offset:9216
    v_mfma_f32_16x16x32_f16 v[88:91], v[32:35], v[146:149], 0
    v_mfma_f32_16x16x32_f16 v[92:95], v[32:35], v[144:147], 0
    v_mfma_f32_16x16x32_f16 v[96:99], v[36:39], v[146:149], 0
    v_mfma_f32_16x16x32_f16 v[100:103], v[36:39], v[144:147], 0
    s_waitcnt lgkmcnt(0)
    s_barrier
    ds_read_b128 v[40:43], v17 offset:8192
    ds_read_b128 v[44:47], v17 offset:9216
    ds_read_b128 v[48:51], v18 offset:8192
    ds_read_b128 v[52:55], v18 offset:9216
    ds_read_b128 v[56:59], v19 offset:8192
    ds_read_b128 v[60:63], v19 offset:9216
    s_waitcnt lgkmcnt(5)
    v_mfma_f32_16x16x32_f16 v[88:91], v[40:43], v[152:155], v[88:91]
    v_mfma_f32_16x16x32_f16 v[92:95], v[40:43], v[150:153], v[92:95]
    s_waitcnt lgkmcnt(4)
    v_mfma_f32_16x16x32_f16 v[96:99], v[44:47], v[152:155], v[96:99]
    v_mfma_f32_16x16x32_f16 v[100:103], v[44:47], v[150:153], v[100:103]
    s_waitcnt lgkmcnt(3)
    v_mfma_f32_16x16x32_f16 v[88:91], v[48:51], v[158:161], v[88:91]
    v_mfma_f32_16x16x32_f16 v[92:95], v[48:51], v[156:159], v[92:95]
    s_waitcnt lgkmcnt(2)
    v_mfma_f32_16x16x32_f16 v[96:99], v[52:55], v[158:161], v[96:99]
    v_mfma_f32_16x16x32_f16 v[100:103], v[52:55], v[156:159], v[100:103]
    s_waitcnt lgkmcnt(1)
    v_mfma_f32_16x16x32_f16 v[88:91], v[56:59], v[164:167], v[88:91]
    v_mfma_f32_16x16x32_f16 v[92:95], v[56:59], v[162:165], v[92:95]
    s_waitcnt lgkmcnt(0)
    v_mfma_f32_16x16x32_f16 v[96:99], v[60:63], v[164:167], v[96:99]
    v_mfma_f32_16x16x32_f16 v[100:103], v[60:63], v[162:165], v[100:103]
    s_waitcnt vmcnt(4)
    v_cmp_ne_u32 vcc, 1, v26
    s_nop 0
    s_cmp_eq_u64 vcc, 0
    s_cselect_b32 s30, 22626304, 0
    buffer_load_dword v27, v23, s[24:27], 0 offen sc1
    v_pk_mul_f32 v[104:105], v[88:89], v[112:113]
    buffer_load_dwordx4 a[0:3], v248, s[28:31], 0 offen offset:0 sc1
    v_pk_mul_f32 v[108:109], v[92:93], v[112:113]
    v_pk_mul_f32 v[106:107], v[90:91], v[114:115]
    v_pk_mul_f32 v[110:111], v[94:95], v[114:115]
    v_pk_fma_f32 v[104:105], v[92:93], v[116:117], v[104:105]
    v_pk_fma_f32 v[108:109], v[88:89], v[116:117], v[108:109] neg_lo:[1,0,0] neg_hi:[1,0,0]
    v_pk_fma_f32 v[106:107], v[94:95], v[118:119], v[106:107]
    v_pk_fma_f32 v[110:111], v[90:91], v[118:119], v[110:111] neg_lo:[1,0,0] neg_hi:[1,0,0]
    v_cvt_pk_f16_f32 v240, v104, v105
    v_cvt_pk_f16_f32 v241, v106, v107
    v_cvt_pk_f16_f32 v242, v108, v109
    v_cvt_pk_f16_f32 v243, v110, v111
    buffer_load_dwordx4 a[4:7], v249, s[28:31], 0 offen offset:0 sc1
    s_nop 0
    v_mfma_f32_16x16x32_f16 v[40:43], v[194:197], v[240:243], 0
    v_mfma_f32_16x16x32_f16 v[44:47], v[192:195], v[240:243], 0
    v_mfma_f32_16x16x32_f16 v[48:51], v[206:209], v[240:243], 0
    buffer_load_dwordx4 a[8:11], v255, s[28:31], 0 offen offset:0 sc1
    v_mfma_f32_16x16x32_f16 v[52:55], v[204:207], v[240:243], 0
    v_pk_mul_f32 v[104:105], v[96:97], v[120:121]
    v_pk_mul_f32 v[108:109], v[100:101], v[120:121]
    v_pk_mul_f32 v[106:107], v[98:99], v[122:123]
    v_pk_mul_f32 v[110:111], v[102:103], v[122:123]
    v_pk_fma_f32 v[104:105], v[100:101], v[124:125], v[104:105]
    v_pk_fma_f32 v[108:109], v[96:97], v[124:125], v[108:109] neg_lo:[1,0,0] neg_hi:[1,0,0]
    v_pk_fma_f32 v[106:107], v[102:103], v[126:127], v[106:107]
    v_pk_fma_f32 v[110:111], v[98:99], v[126:127], v[110:111] neg_lo:[1,0,0] neg_hi:[1,0,0]
    buffer_load_dwordx4 a[12:15], v248, s[28:31], 0 offen offset:1024 sc1
    v_cvt_pk_f16_f32 v244, v104, v105
    v_cvt_pk_f16_f32 v245, v106, v107
    v_cvt_pk_f16_f32 v246, v108, v109
    v_cvt_pk_f16_f32 v247, v110, v111
    s_nop 1
    v_mfma_f32_16x16x32_f16 v[40:43], v[200:203], v[244:247], v[40:43]
    v_mfma_f32_16x16x32_f16 v[44:47], v[198:201], v[244:247], v[44:47]
    buffer_load_dwordx4 a[16:19], v249, s[28:31], 0 offen offset:1024 sc1
    v_mfma_f32_16x16x32_f16 v[48:51], v[212:215], v[244:247], v[48:51]
    v_mfma_f32_16x16x32_f16 v[52:55], v[210:213], v[244:247], v[52:55]
    s_waitcnt vmcnt(9)
    v_lshlrev_b32 v64, 16, v68
    v_and_b32 v68, 0xffff0000, v68
    v_lshlrev_b32 v65, 16, v69
    v_and_b32 v69, 0xffff0000, v69
    buffer_load_dwordx4 a[20:23], v255, s[28:31], 0 offen offset:1024 sc1
    v_lshlrev_b32 v66, 16, v70
    v_and_b32 v70, 0xffff0000, v70
    v_lshlrev_b32 v67, 16, v71
    v_and_b32 v71, 0xffff0000, v71
    s_waitcnt vmcnt(9)
    v_lshlrev_b32 v72, 16, v76
    v_and_b32 v76, 0xffff0000, v76
    v_lshlrev_b32 v73, 16, v77
    v_and_b32 v77, 0xffff0000, v77
    v_lshlrev_b32 v74, 16, v78
    v_and_b32 v78, 0xffff0000, v78
    v_lshlrev_b32 v75, 16, v79
    buffer_load_dwordx4 a[24:27], v248, s[28:31], 0 offen offset:2048 sc1
    v_and_b32 v79, 0xffff0000, v79
    v_pk_mul_f32 v[104:105], v[40:41], v[64:65]
    v_pk_mul_f32 v[108:109], v[44:45], v[64:65]
    v_pk_mul_f32 v[106:107], v[42:43], v[66:67]
    v_pk_mul_f32 v[110:111], v[46:47], v[66:67]
    v_pk_fma_f32 v[104:105], v[44:45], v[68:69], v[104:105] neg_lo:[1,0,0] neg_hi:[1,0,0]
    v_pk_fma_f32 v[108:109], v[40:41], v[68:69], v[108:109]
    v_pk_fma_f32 v[106:107], v[46:47], v[70:71], v[106:107] neg_lo:[1,0,0] neg_hi:[1,0,0]
    v_pk_fma_f32 v[110:111], v[42:43], v[70:71], v[110:111]
    v_cvt_pk_bf16_f32 v240, v104, v105
    v_cvt_pk_bf16_f32 v241, v106, v107
    buffer_load_dwordx4 a[28:31], v249, s[28:31], 0 offen offset:2048 sc1
    v_cvt_pk_bf16_f32 v242, v108, v109
    v_cvt_pk_bf16_f32 v243, v110, v111
    s_nop 1
    v_mfma_f32_16x16x32_bf16 v[88:91], v[240:243], v[218:221], 0
    v_mfma_f32_16x16x32_bf16 v[92:95], v[240:243], v[216:219], 0
    buffer_load_dwordx4 a[32:35], v255, s[28:31], 0 offen offset:2048 sc1
    v_mfma_f32_16x16x32_bf16 v[96:99], v[240:243], v[230:233], 0
    v_mfma_f32_16x16x32_bf16 v[100:103], v[240:243], v[228:231], 0
    v_pk_mul_f32 v[104:105], v[48:49], v[72:73]
    v_pk_mul_f32 v[108:109], v[52:53], v[72:73]
    v_pk_mul_f32 v[106:107], v[50:51], v[74:75]
    v_pk_mul_f32 v[110:111], v[54:55], v[74:75]
    buffer_load_dwordx4 a[36:39], v248, s[28:31], 0 offen offset:3072 sc1
    v_pk_fma_f32 v[104:105], v[52:53], v[76:77], v[104:105] neg_lo:[1,0,0] neg_hi:[1,0,0]
    v_pk_fma_f32 v[108:109], v[48:49], v[76:77], v[108:109]
    v_pk_fma_f32 v[106:107], v[54:55], v[78:79], v[106:107] neg_lo:[1,0,0] neg_hi:[1,0,0]
    v_pk_fma_f32 v[110:111], v[50:51], v[78:79], v[110:111]
    v_cvt_pk_bf16_f32 v244, v104, v105
    v_cvt_pk_bf16_f32 v245, v106, v107
    v_cvt_pk_bf16_f32 v246, v108, v109
    v_cvt_pk_bf16_f32 v247, v110, v111
    s_nop 1
    v_mfma_f32_16x16x32_bf16 v[88:91], v[244:247], v[224:227], v[88:91]
    buffer_load_dwordx4 a[40:43], v249, s[28:31], 0 offen offset:3072 sc1
    v_mfma_f32_16x16x32_bf16 v[92:95], v[244:247], v[222:225], v[92:95]
    v_mfma_f32_16x16x32_bf16 v[96:99], v[244:247], v[236:239], v[96:99]
    v_mfma_f32_16x16x32_bf16 v[100:103], v[244:247], v[234:237], v[100:103]
    buffer_load_dwordx4 a[44:47], v255, s[28:31], 0 offen offset:3072 sc1
    s_waitcnt vmcnt(12)
    v_cmp_ne_u32 vcc, 1, v27
    s_nop 0
    s_cmp_eq_u64 vcc, 0
    s_cselect_b32 s38, 22626304, 0
    v_pk_mul_f32 v[104:105], v[88:89], v[128:129]
    v_pk_mul_f32 v[108:109], v[92:93], v[128:129]
    v_pk_mul_f32 v[106:107], v[90:91], v[130:131]
    v_pk_mul_f32 v[110:111], v[94:95], v[130:131]
    v_pk_fma_f32 v[104:105], v[92:93], v[132:133], v[104:105] neg_lo:[1,0,0] neg_hi:[1,0,0]
    v_pk_fma_f32 v[108:109], v[88:89], v[132:133], v[108:109]
    v_pk_fma_f32 v[106:107], v[94:95], v[134:135], v[106:107] neg_lo:[1,0,0] neg_hi:[1,0,0]
    v_pk_fma_f32 v[110:111], v[90:91], v[134:135], v[110:111]
    v_cvt_pk_bf16_f32 v240, v104, v105
    v_cvt_pk_bf16_f32 v241, v106, v107
    v_cvt_pk_bf16_f32 v242, v108, v109
    buffer_load_dwordx4 a[48:51], v248, s[36:39], s70 offen offset:0 sc1
    v_cvt_pk_bf16_f32 v243, v110, v111
    ds_write_b128 v16, v[240:243] offset:0
    v_pk_mul_f32 v[104:105], v[96:97], v[136:137]
    v_pk_mul_f32 v[108:109], v[100:101], v[136:137]
    v_pk_mul_f32 v[106:107], v[98:99], v[138:139]
    v_pk_mul_f32 v[110:111], v[102:103], v[138:139]
    v_pk_fma_f32 v[104:105], v[100:101], v[140:141], v[104:105] neg_lo:[1,0,0] neg_hi:[1,0,0]
    v_pk_fma_f32 v[108:109], v[96:97], v[140:141], v[108:109]
    v_pk_fma_f32 v[106:107], v[102:103], v[142:143], v[106:107] neg_lo:[1,0,0] neg_hi:[1,0,0]
    v_pk_fma_f32 v[110:111], v[98:99], v[142:143], v[110:111]
    v_cvt_pk_bf16_f32 v244, v104, v105
    buffer_load_dwordx4 a[52:55], v249, s[36:39], s70 offen offset:0 sc1
    v_cvt_pk_bf16_f32 v245, v106, v107
    v_cvt_pk_bf16_f32 v246, v108, v109
    v_cvt_pk_bf16_f32 v247, v110, v111
    ds_write_b128 v16, v[244:247] offset:1024
    v_fma_mix_f32 v88, v80, v32, 0 op_sel:[0,0,0] op_sel_hi:[0,1,0]
    v_fma_mix_f32 v89, v81, v32, 0 op_sel:[0,1,0] op_sel_hi:[0,1,0]
    v_fma_mix_f32 v90, v82, v33, 0 op_sel:[0,0,0] op_sel_hi:[0,1,0]
    v_fma_mix_f32 v91, v83, v33, 0 op_sel:[0,1,0] op_sel_hi:[0,1,0]
    v_fma_mix_f32 v96, v84, v36, 0 op_sel:[0,0,0] op_sel_hi:[0,1,0]
    v_fma_mix_f32 v97, v85, v36, 0 op_sel:[0,1,0] op_sel_hi:[0,1,0]
    v_fma_mix_f32 v98, v86, v37, 0 op_sel:[0,0,0] op_sel_hi:[0,1,0]
    buffer_load_dwordx4 a[56:59], v255, s[36:39], s70 offen offset:0 sc1
    v_fma_mix_f32 v99, v87, v37, 0 op_sel:[0,1,0] op_sel_hi:[0,1,0]
    v_fma_mix_f32 v92, v80, v34, 0 op_sel:[0,0,0] op_sel_hi:[0,1,0]
    v_fma_mix_f32 v93, v81, v34, 0 op_sel:[0,1,0] op_sel_hi:[0,1,0]
    v_fma_mix_f32 v94, v82, v35, 0 op_sel:[0,0,0] op_sel_hi:[0,1,0]
    v_fma_mix_f32 v95, v83, v35, 0 op_sel:[0,1,0] op_sel_hi:[0,1,0]
    v_fma_mix_f32 v100, v84, v38, 0 op_sel:[0,0,0] op_sel_hi:[0,1,0]
    v_fma_mix_f32 v101, v85, v38, 0 op_sel:[0,1,0] op_sel_hi:[0,1,0]
    v_fma_mix_f32 v102, v86, v39, 0 op_sel:[0,0,0] op_sel_hi:[0,1,0]
    v_fma_mix_f32 v103, v87, v39, 0 op_sel:[0,1,0] op_sel_hi:[0,1,0]
    s_waitcnt lgkmcnt(0)
    s_barrier
    ds_read_b128 v[40:43], v17 offset:0
    buffer_load_dwordx4 a[60:63], v248, s[36:39], s70 offen offset:1024 sc1
    ds_read_b128 v[44:47], v17 offset:1024
    ds_read_b128 v[48:51], v18 offset:0
    ds_read_b128 v[52:55], v18 offset:1024
    ds_read_b128 v[56:59], v19 offset:0
    ds_read_b128 v[60:63], v19 offset:1024
    v_mfma_f32_16x16x32_bf16 v[88:91], v[170:173], v[240:243], v[88:91]
    v_mfma_f32_16x16x32_bf16 v[92:95], v[168:171], v[240:243], v[92:95]
    buffer_load_dwordx4 a[64:67], v249, s[36:39], s70 offen offset:1024 sc1
    v_mfma_f32_16x16x32_bf16 v[96:99], v[170:173], v[244:247], v[96:99]
    v_mfma_f32_16x16x32_bf16 v[100:103], v[168:171], v[244:247], v[100:103]
    s_waitcnt lgkmcnt(5)
    v_mfma_f32_16x16x32_bf16 v[88:91], v[176:179], v[40:43], v[88:91]
    buffer_load_dwordx4 a[68:71], v255, s[36:39], s70 offen offset:1024 sc1
    v_mfma_f32_16x16x32_bf16 v[92:95], v[174:177], v[40:43], v[92:95]
    s_waitcnt lgkmcnt(4)
    v_mfma_f32_16x16x32_bf16 v[96:99], v[176:179], v[44:47], v[96:99]
    v_mfma_f32_16x16x32_bf16 v[100:103], v[174:177], v[44:47], v[100:103]
    buffer_load_dwordx4 a[72:75], v248, s[36:39], s70 offen offset:2048 sc1
    s_waitcnt lgkmcnt(3)
    v_mfma_f32_16x16x32_bf16 v[88:91], v[182:185], v[48:51], v[88:91]
    v_mfma_f32_16x16x32_bf16 v[92:95], v[180:183], v[48:51], v[92:95]
    s_waitcnt lgkmcnt(2)
    v_mfma_f32_16x16x32_bf16 v[96:99], v[182:185], v[52:55], v[96:99]
    buffer_load_dwordx4 a[76:79], v249, s[36:39], s70 offen offset:2048 sc1
    v_mfma_f32_16x16x32_bf16 v[100:103], v[180:183], v[52:55], v[100:103]
    s_waitcnt lgkmcnt(1)
    v_mfma_f32_16x16x32_bf16 v[88:91], v[188:191], v[56:59], v[88:91]
    v_mfma_f32_16x16x32_bf16 v[92:95], v[186:189], v[56:59], v[92:95]
    buffer_load_dwordx4 a[80:83], v255, s[36:39], s70 offen offset:2048 sc1
    s_waitcnt lgkmcnt(0)
    v_mfma_f32_16x16x32_bf16 v[96:99], v[188:191], v[60:63], v[96:99]
    v_mfma_f32_16x16x32_bf16 v[100:103], v[186:189], v[60:63], v[100:103]
    s_nop 2
    v_cvt_pk_bf16_f32 v64, v88, v89
    v_cvt_pk_bf16_f32 v65, v90, v91
    s_nop 1
    v_cvt_pk_bf16_f32 v66, v96, v97
    v_cvt_pk_bf16_f32 v67, v98, v99
    v_cvt_pk_bf16_f32 v68, v92, v93
    v_cvt_pk_bf16_f32 v69, v94, v95
    v_cvt_pk_bf16_f32 v70, v100, v101
    v_cvt_pk_bf16_f32 v71, v102, v103
    s_cmp_lg_u32 s2, 0
    s_cbranch_scc1 L_p2_st
    v_mov_b32 v68, v64
    v_mov_b32 v64, 0
    v_mov_b32 v69, v65
    v_mov_b32 v65, 0
    v_mov_b32 v70, v66
    v_mov_b32 v66, 0
    v_mov_b32 v71, v67
    v_mov_b32 v67, 0
L_p2_st:
    buffer_store_dwordx4 v[64:67], v20, s[24:27], s62 offen offset:0 sc1
    buffer_store_dwordx4 v[68:71], v20, s[24:27], s62 offen offset:2048 sc1
    s_lshl_b32 s44, s48, 12
    s_add_u32 s44, s44, 12992512
    s_and_b32 s46, s40, 1
    s_xor_b32 s45, s46, 0
    s_lshl_b32 s45, s45, 10
    s_add_u32 s55, s44, s45
    s_xor_b32 s45, s46, 1
    s_lshl_b32 s45, s45, 10
    s_add_u32 s56, s44, s45
    s_xor_b32 s45, s46, 2
    s_lshl_b32 s45, s45, 10
    s_add_u32 s57, s44, s45
    s_xor_b32 s45, s46, 3
    s_lshl_b32 s45, s45, 10
    s_add_u32 s58, s44, s45
    s_lshl_b32 s44, s49, 17
    s_lshl_b32 s45, s48, 11
    s_add_u32 s44, s44, s45
    s_add_u32 s59, s44, 19480576
    s_add_u32 s60, s59, 0x10000
    s_lshl_b32 s44, s48, 10
    s_add_u32 s61, s44, 5374016
    s_mov_b32 s46, 0
    buffer_load_dwordx4 a[84:87], v248, s[36:39], s70 offen offset:3072 sc1
    buffer_load_dwordx4 a[88:91], v249, s[36:39], s70 offen offset:3072 sc1
    buffer_load_dwordx4 a[92:95], v255, s[36:39], s70 offen offset:3072 sc1
    buffer_load_dwordx4 a[96:99], v248, s[36:39], s71 offen offset:0 sc1
    buffer_load_dwordx4 a[100:103], v249, s[36:39], s71 offen offset:0 sc1
    buffer_load_dwordx4 a[104:107], v255, s[36:39], s71 offen offset:0 sc1
    v_mov_b32 v250, 0
    v_mov_b32 v251, 1
    s_cmp_lg_u32 s40, 0
    s_cbranch_scc1 L_b2o
    s_mov_b64 exec, 1
    s_waitcnt vmcnt(6)
    s_barrier
    buffer_atomic_add v251, v250, s[24:27], s74 offen sc0 sc1
    s_barrier
    s_mov_b64 exec, 0xff
    v_lshlrev_b32 v252, 11, v1
    v_mov_b32 v250, 2
    s_waitcnt vmcnt(0)
    v_readfirstlane_b32 s47, v251
    s_nop 0
    s_cmp_lg_u32 s47, 51
    s_cbranch_scc1 L_nl12
    buffer_store_dword v250, v252, s[24:27], s75 offen sc1
L_nl12:
    s_barrier
    s_mov_b64 exec, -1
    s_branch L_b2m
L_b2o:
    s_waitcnt vmcnt(6)
    s_barrier
    s_barrier
    s_barrier
L_b2m:
    s_cmp_lg_u32 s30, 0
    s_cbranch_scc1 L_bok
    s_cmp_lg_u32 s38, 0
    s_cbranch_scc1 L_bok2
L_bchk:
    buffer_load_dword v26, v23, s[24:27], 0 offen sc1
    s_add_u32 s46, s46, 1
    s_waitcnt vmcnt(0)
    v_cmp_ne_u32 vcc, 1, v26
    s_cmp_gt_u32 s46, 400000
    s_cbranch_scc1 L_bgo
    s_cbranch_vccnz L_bchk
L_bgo:
    buffer_load_dwordx4 a[48:51], v248, s[24:27], s70 offen offset:0 sc1
    buffer_load_dwordx4 a[52:55], v249, s[24:27], s70 offen offset:0 sc1
    buffer_load_dwordx4 a[56:59], v255, s[24:27], s70 offen offset:0 sc1
    buffer_load_dwordx4 a[60:63], v248, s[24:27], s70 offen offset:1024 sc1
    buffer_load_dwordx4 a[64:67], v249, s[24:27], s70 offen offset:1024 sc1
    buffer_load_dwordx4 a[68:71], v255, s[24:27], s70 offen offset:1024 sc1
    buffer_load_dwordx4 a[72:75], v248, s[24:27], s70 offen offset:2048 sc1
    buffer_load_dwordx4 a[76:79], v249, s[24:27], s70 offen offset:2048 sc1
    buffer_load_dwordx4 a[80:83], v255, s[24:27], s70 offen offset:2048 sc1
    buffer_load_dwordx4 a[84:87], v248, s[24:27], s70 offen offset:3072 sc1
    buffer_load_dwordx4 a[88:91], v249, s[24:27], s70 offen offset:3072 sc1
    buffer_load_dwordx4 a[92:95], v255, s[24:27], s70 offen offset:3072 sc1
    buffer_load_dwordx4 a[96:99], v248, s[24:27], s71 offen offset:0 sc1
    buffer_load_dwordx4 a[100:103], v249, s[24:27], s71 offen offset:0 sc1
    buffer_load_dwordx4 a[104:107], v255, s[24:27], s71 offen offset:0 sc1
L_bok2:
    buffer_load_dwordx4 a[0:3], v248, s[24:27], 0 offen offset:0 sc1
    buffer_load_dwordx4 a[4:7], v249, s[24:27], 0 offen offset:0 sc1
    buffer_load_dwordx4 a[8:11], v255, s[24:27], 0 offen offset:0 sc1
    buffer_load_dwordx4 a[12:15], v248, s[24:27], 0 offen offset:1024 sc1
    buffer_load_dwordx4 a[16:19], v249, s[24:27], 0 offen offset:1024 sc1
    buffer_load_dwordx4 a[20:23], v255, s[24:27], 0 offen offset:1024 sc1
    buffer_load_dwordx4 a[24:27], v248, s[24:27], 0 offen offset:2048 sc1
    buffer_load_dwordx4 a[28:31], v249, s[24:27], 0 offen offset:2048 sc1
    buffer_load_dwordx4 a[32:35], v255, s[24:27], 0 offen offset:2048 sc1
    buffer_load_dwordx4 a[36:39], v248, s[24:27], 0 offen offset:3072 sc1
    buffer_load_dwordx4 a[40:43], v249, s[24:27], 0 offen offset:3072 sc1
    buffer_load_dwordx4 a[44:47], v255, s[24:27], 0 offen offset:3072 sc1
L_bok:
    buffer_load_dwordx4 a[108:111], v248, s[24:27], s71 offen offset:1024 sc1
    buffer_load_dwordx4 a[112:115], v249, s[24:27], s71 offen offset:1024 sc1
    buffer_load_dwordx4 a[116:119], v255, s[24:27], s71 offen offset:1024 sc1
    buffer_load_dwordx4 a[120:123], v248, s[24:27], s71 offen offset:2048 sc1
    buffer_load_dwordx4 a[124:127], v249, s[24:27], s71 offen offset:2048 sc1
    buffer_load_dwordx4 a[128:131], v255, s[24:27], s71 offen offset:2048 sc1
    buffer_load_dwordx4 a[132:135], v248, s[24:27], s71 offen offset:3072 sc1
    buffer_load_dwordx4 a[136:139], v249, s[24:27], s71 offen offset:3072 sc1
    buffer_load_dwordx4 a[140:143], v255, s[24:27], s71 offen offset:3072 sc1
    buffer_load_dwordx4 a[144:147], v248, s[24:27], s72 offen offset:0 sc1
    buffer_load_dwordx4 a[148:151], v249, s[24:27], s72 offen offset:0 sc1
    buffer_load_dwordx4 a[152:155], v255, s[24:27], s72 offen offset:0 sc1
    buffer_load_dwordx4 a[156:159], v248, s[24:27], s72 offen offset:1024 sc1
    buffer_load_dwordx4 a[160:163], v249, s[24:27], s72 offen offset:1024 sc1
    buffer_load_dwordx4 a[164:167], v255, s[24:27], s72 offen offset:1024 sc1
    buffer_load_dwordx4 a[168:171], v248, s[24:27], s72 offen offset:2048 sc1
    buffer_load_dwordx4 a[172:175], v249, s[24:27], s72 offen offset:2048 sc1
    buffer_load_dwordx4 a[176:179], v255, s[24:27], s72 offen offset:2048 sc1
    buffer_load_dwordx4 a[180:183], v248, s[24:27], s72 offen offset:3072 sc1
    buffer_load_dwordx4 a[184:187], v249, s[24:27], s72 offen offset:3072 sc1
    buffer_load_dwordx4 a[188:191], v255, s[24:27], s72 offen offset:3072 sc1
    s_cmp_lg_u32 s40, 2
    s_cbranch_scc1 L_ow13
    s_lshr_b32 s44, s2, 3
    s_lshl_b32 s44, s44, 10
    v_lshl_add_u32 v252, v3, 6, s44
    v_min_u32 v252, L_notz-L_b2x-4, v252
    s_sub_u32 s44, s42, tables-L_b2x
    s_subb_u32 s45, s43, 0
    v_mov_b32 v253, s45
    v_add_co_u32 v252, vcc, s44, v252
    s_nop 1
    v_addc_co_u32 v253, vcc, 0, v253, vcc
    s_mov_b64 exec, 0xffff
    global_load_dword v254, v[252:253], off
    s_mov_b64 exec, -1
L_ow13:
    s_cmp_lg_u32 s40, 0
    s_cbranch_scc1 L_ow14
    s_mov_b64 exec, 0xff
    v_lshlrev_b32 v253, 8, v1
    s_and_b32 s44, s2, 7
    s_lshl_b32 s44, s44, 11
    s_add_u32 s44, s44, 4096
    s_mov_b32 s46, 0
L_bp15:
    buffer_load_dword v251, v253, s[24:27], s44 offen sc1
    s_add_u32 s46, s46, 1
    s_waitcnt vmcnt(0)
    v_cmp_gt_u32 vcc, 2, v251
    s_cmp_gt_u32 s46, 400000
    s_cbranch_scc1 L_bd15
    s_cbranch_vccnz L_bp15
L_bd15:
    s_mov_b64 exec, -1
    s_mov_b64 exec, -1
L_ow14:
    s_cmp_eq_u32 s40, 3
    s_cbranch_scc1 L_p3h
L_b2x:
    s_barrier
    buffer_load_dwordx4 v5, s[24:27], m0 offen offset:0 sc1 lds
    buffer_load_dwordx4 v5, s[24:27], m0 offen offset:1024 sc1 lds
    buffer_load_dwordx4 v5, s[24:27], m0 offen offset:2048 sc1 lds
    buffer_load_dwordx4 v5, s[24:27], m0 offen offset:3072 sc1 lds
    s_add_u32 m0, m0, 8192
    s_nop 0
    buffer_load_dwordx4 v5, s[24:27], m0 offen offset:0 sc1 lds
    buffer_load_dwordx4 v5, s[24:27], m0 offen offset:1024 sc1 lds
    buffer_load_dwordx4 v5, s[24:27], m0 offen offset:2048 sc1 lds
    buffer_load_dwordx4 v5, s[24:27], m0 offen offset:3072 sc1 lds
    s_add_u32 m0, m0, 8192
    s_nop 0
    buffer_load_dwordx4 v5, s[24:27], m0 offen offset:0 sc1 lds
    buffer_load_dwordx4 v5, s[24:27], m0 offen offset:1024 sc1 lds
    buffer_load_dwordx4 v5, s[24:27], m0 offen offset:2048 sc1 lds
    buffer_load_dwordx4 v5, s[24:27], m0 offen offset:3072 sc1 lds
    s_add_u32 m0, m0, 8192
    s_and_b32 s44, s2, 7
    s_lshl_b32 s44, s44, 2
    s_bfe_u32 s46, s2, 0x20003
    s_add_u32 s44, s44, s46
    s_lshr_b32 s45, s2, 5
    s_mov_b32 s51, 0
    s_lshl_b32 s45, s45, 2
    s_add_u32 s45, s45, s40
    s_mul_i32 s45, s45, 45056
    s_add_u32 s45, s45, 11419648
    v_add_u32 v15, s45, v4
    s_lshr_b32 s46, s44, 1
    s_lshl_b32 s45, s46, 11
    s_add_u32 s62, s45, 65536
    s_add_u32 s63, s62, 0x8000
    s_lshl_b32 s46, s46, 2
    s_and_b32 s44, s44, 1
    s_add_u32 s73, s46, s44
    s_lshl_b32 s46, s73, 10
    s_mul_i32 s47, s40, 65536
    s_add_u32 s46, s46, s47
    s_add_u32 s74, s46, 12992512
    s_mov_b32 s75, 0
    s_waitcnt vmcnt(8)
    s_barrier
    ds_read_b64_tr_b16 v[32:33], v6 offset:0
    ds_read_b64_tr_b16 v[34:35], v6 offset:1024
    ds_read_b64_tr_b16 v[36:37], v7 offset:0
    ds_read_b64_tr_b16 v[38:39], v7 offset:1024
    ds_read_b64_tr_b16 v[40:41], v6 offset:2048
    ds_read_b64_tr_b16 v[42:43], v6 offset:3072
    ds_read_b64_tr_b16 v[44:45], v7 offset:2048
    ds_read_b64_tr_b16 v[46:47], v7 offset:3072
    s_waitcnt lgkmcnt(4)
    v_mfma_f32_16x16x32_bf16 v[28:31], v[32:35], v[32:35], 0
    ds_read_b64_tr_b16 v[48:49], v6 offset:4096
    v_mfma_f32_16x16x32_bf16 v[64:67], a[0:3], v[32:35], 0
    ds_read_b64_tr_b16 v[50:51], v6 offset:5120
    v_mfma_f32_16x16x32_bf16 v[68:71], a[0:3], v[36:39], 0
    buffer_load_dwordx4 v5, s[24:27], m0 offen offset:0 sc1 lds
    v_mfma_f32_16x16x32_bf16 v[76:79], a[4:7], v[36:39], 0
    ds_read_b64_tr_b16 v[52:53], v7 offset:4096
    v_mfma_f32_16x16x32_bf16 v[72:75], a[4:7], v[32:35], 0
    buffer_load_dwordx4 v5, s[24:27], m0 offen offset:1024 sc1 lds
    v_mfma_f32_16x16x32_bf16 v[80:83], a[8:11], v[32:35], 0
    ds_read_b64_tr_b16 v[54:55], v7 offset:5120
    v_mfma_f32_16x16x32_bf16 v[84:87], a[8:11], v[36:39], 0
    s_waitcnt lgkmcnt(4)
    v_mfma_f32_16x16x32_bf16 v[28:31], v[40:43], v[40:43], v[28:31]
    ds_read_b64_tr_b16 v[56:57], v6 offset:6144
    v_mfma_f32_16x16x32_bf16 v[64:67], a[12:15], v[40:43], v[64:67]
    ds_read_b64_tr_b16 v[58:59], v6 offset:7168
    v_mfma_f32_16x16x32_bf16 v[68:71], a[12:15], v[44:47], v[68:71]
    buffer_load_dwordx4 v5, s[24:27], m0 offen offset:2048 sc1 lds
    v_mfma_f32_16x16x32_bf16 v[76:79], a[16:19], v[44:47], v[76:79]
    ds_read_b64_tr_b16 v[60:61], v7 offset:6144
    v_mfma_f32_16x16x32_bf16 v[72:75], a[16:19], v[40:43], v[72:75]
    buffer_load_dwordx4 v5, s[24:27], m0 offen offset:3072 sc1 lds
    v_mfma_f32_16x16x32_bf16 v[80:83], a[20:23], v[40:43], v[80:83]
    s_add_u32 m0, m0, 40960
    ds_read_b64_tr_b16 v[62:63], v7 offset:7168
    v_mfma_f32_16x16x32_bf16 v[84:87], a[20:23], v[44:47], v[84:87]
    s_waitcnt lgkmcnt(4)
    v_mfma_f32_16x16x32_bf16 v[28:31], v[48:51], v[48:51], v[28:31]
    s_waitcnt vmcnt(8)
    s_barrier
    ds_read_b64_tr_b16 v[32:33], v6 offset:8192
    v_mfma_f32_16x16x32_bf16 v[64:67], a[24:27], v[48:51], v[64:67]
    ds_read_b64_tr_b16 v[34:35], v6 offset:9216
    v_mfma_f32_16x16x32_bf16 v[68:71], a[24:27], v[52:55], v[68:71]
    ds_read_b64_tr_b16 v[36:37], v7 offset:8192
    v_mfma_f32_16x16x32_bf16 v[76:79], a[28:31], v[52:55], v[76:79]
    buffer_load_dwordx4 v5, s[24:27], m0 offen offset:0 sc1 lds
    v_mfma_f32_16x16x32_bf16 v[72:75], a[28:31], v[48:51], v[72:75]
    ds_read_b64_tr_b16 v[38:39], v7 offset:9216
    v_mfma_f32_16x16x32_bf16 v[80:83], a[32:35], v[48:51], v[80:83]
    v_mfma_f32_16x16x32_bf16 v[84:87], a[32:35], v[52:55], v[84:87]
    s_waitcnt lgkmcnt(4)
    v_mfma_f32_16x16x32_bf16 v[28:31], v[56:59], v[56:59], v[28:31]
    ds_read_b64_tr_b16 v[40:41], v6 offset:10240
    v_mfma_f32_16x16x32_bf16 v[64:67], a[36:39], v[56:59], v[64:67]
    ds_read_b64_tr_b16 v[42:43], v6 offset:11264
    v_mfma_f32_16x16x32_bf16 v[68:71], a[36:39], v[60:63], v[68:71]
    buffer_load_dwordx4 v5, s[24:27], m0 offen offset:1024 sc1 lds
    v_mfma_f32_16x16x32_bf16 v[76:79], a[40:43], v[60:63], v[76:79]
    ds_read_b64_tr_b16 v[44:45], v7 offset:10240
    v_mfma_f32_16x16x32_bf16 v[72:75], a[40:43], v[56:59], v[72:75]
    buffer_load_dwordx4 v5, s[24:27], m0 offen offset:2048 sc1 lds
    v_mfma_f32_16x16x32_bf16 v[80:83], a[44:47], v[56:59], v[80:83]
    ds_read_b64_tr_b16 v[46:47], v7 offset:11264
    v_mfma_f32_16x16x32_bf16 v[84:87], a[44:47], v[60:63], v[84:87]
    s_waitcnt lgkmcnt(4)
    v_mfma_f32_16x16x32_bf16 v[28:31], v[32:35], v[32:35], v[28:31]
    ds_read_b64_tr_b16 v[48:49], v6 offset:12288
    v_mfma_f32_16x16x32_bf16 v[64:67], a[48:51], v[32:35], v[64:67]
    ds_read_b64_tr_b16 v[50:51], v6 offset:13312
    v_mfma_f32_16x16x32_bf16 v[68:71], a[48:51], v[36:39], v[68:71]
    ds_read_b64_tr_b16 v[52:53], v7 offset:12288
    v_mfma_f32_16x16x32_bf16 v[76:79], a[52:55], v[36:39], v[76:79]
    buffer_load_dwordx4 v5, s[24:27], m0 offen offset:3072 sc1 lds
    v_mfma_f32_16x16x32_bf16 v[72:75], a[52:55], v[32:35], v[72:75]
    s_add_u32 m0, m0, 8192
    ds_read_b64_tr_b16 v[54:55], v7 offset:13312
    v_mfma_f32_16x16x32_bf16 v[80:83], a[56:59], v[32:35], v[80:83]
    v_mfma_f32_16x16x32_bf16 v[84:87], a[56:59], v[36:39], v[84:87]
    s_waitcnt lgkmcnt(4)
    v_mfma_f32_16x16x32_bf16 v[28:31], v[40:43], v[40:43], v[28:31]
    ds_read_b64_tr_b16 v[56:57], v6 offset:14336
    v_mfma_f32_16x16x32_bf16 v[64:67], a[60:63], v[40:43], v[64:67]
    ds_read_b64_tr_b16 v[58:59], v6 offset:15360
    v_mfma_f32_16x16x32_bf16 v[68:71], a[60:63], v[44:47], v[68:71]
    buffer_load_dwordx4 v5, s[24:27], m0 offen offset:0 sc1 lds
    v_mfma_f32_16x16x32_bf16 v[76:79], a[64:67], v[44:47], v[76:79]
    ds_read_b64_tr_b16 v[60:61], v7 offset:14336
    v_mfma_f32_16x16x32_bf16 v[72:75], a[64:67], v[40:43], v[72:75]
    buffer_load_dwordx4 v5, s[24:27], m0 offen offset:1024 sc1 lds
    v_mfma_f32_16x16x32_bf16 v[80:83], a[68:71], v[40:43], v[80:83]
    ds_read_b64_tr_b16 v[62:63], v7 offset:15360
    v_mfma_f32_16x16x32_bf16 v[84:87], a[68:71], v[44:47], v[84:87]
    s_waitcnt lgkmcnt(4)
    v_mfma_f32_16x16x32_bf16 v[28:31], v[48:51], v[48:51], v[28:31]
    s_waitcnt vmcnt(10)
    s_barrier
    ds_read_b64_tr_b16 v[32:33], v6 offset:16384
    v_mfma_f32_16x16x32_bf16 v[64:67], a[72:75], v[48:51], v[64:67]
    ds_read_b64_tr_b16 v[34:35], v6 offset:17408
    v_mfma_f32_16x16x32_bf16 v[68:71], a[72:75], v[52:55], v[68:71]
    ds_read_b64_tr_b16 v[36:37], v7 offset:16384
    v_mfma_f32_16x16x32_bf16 v[76:79], a[76:79], v[52:55], v[76:79]
    buffer_load_dwordx4 v5, s[24:27], m0 offen offset:2048 sc1 lds
    v_mfma_f32_16x16x32_bf16 v[72:75], a[76:79], v[48:51], v[72:75]
    ds_read_b64_tr_b16 v[38:39], v7 offset:17408
    v_mfma_f32_16x16x32_bf16 v[80:83], a[80:83], v[48:51], v[80:83]
    v_mfma_f32_16x16x32_bf16 v[84:87], a[80:83], v[52:55], v[84:87]
    s_waitcnt lgkmcnt(4)
    v_mfma_f32_16x16x32_bf16 v[28:31], v[56:59], v[56:59], v[28:31]
    ds_read_b64_tr_b16 v[40:41], v6 offset:18432
    v_mfma_f32_16x16x32_bf16 v[64:67], a[84:87], v[56:59], v[64:67]
    ds_read_b64_tr_b16 v[42:43], v6 offset:19456
    v_mfma_f32_16x16x32_bf16 v[68:71], a[84:87], v[60:63], v[68:71]
    buffer_load_dwordx4 v5, s[24:27], m0 offen offset:3072 sc1 lds
    v_mfma_f32_16x16x32_bf16 v[76:79], a[88:91], v[60:63], v[76:79]
    s_add_u32 m0, m0, 8192
    ds_read_b64_tr_b16 v[44:45], v7 offset:18432
    v_mfma_f32_16x16x32_bf16 v[72:75], a[88:91], v[56:59], v[72:75]
    buffer_load_dwordx4 v5, s[24:27], m0 offen offset:0 sc1 lds
    v_mfma_f32_16x16x32_bf16 v[80:83], a[92:95], v[56:59], v[80:83]
    ds_read_b64_tr_b16 v[46:47], v7 offset:19456
    v_mfma_f32_16x16x32_bf16 v[84:87], a[92:95], v[60:63], v[84:87]
    s_waitcnt lgkmcnt(4)
    v_mfma_f32_16x16x32_bf16 v[28:31], v[32:35], v[32:35], v[28:31]
    ds_read_b64_tr_b16 v[48:49], v6 offset:20480
    v_mfma_f32_16x16x32_bf16 v[64:67], a[96:99], v[32:35], v[64:67]
    ds_read_b64_tr_b16 v[50:51], v6 offset:21504
    v_mfma_f32_16x16x32_bf16 v[68:71], a[96:99], v[36:39], v[68:71]
    ds_read_b64_tr_b16 v[52:53], v7 offset:20480
    v_mfma_f32_16x16x32_bf16 v[76:79], a[100:103], v[36:39], v[76:79]
    buffer_load_dwordx4 v5, s[24:27], m0 offen offset:1024 sc1 lds
    v_mfma_f32_16x16x32_bf16 v[72:75], a[100:103], v[32:35], v[72:75]
    ds_read_b64_tr_b16 v[54:55], v7 offset:21504
    v_mfma_f32_16x16x32_bf16 v[80:83], a[104:107], v[32:35], v[80:83]
    v_mfma_f32_16x16x32_bf16 v[84:87], a[104:107], v[36:39], v[84:87]
    s_waitcnt lgkmcnt(4)
    v_mfma_f32_16x16x32_bf16 v[28:31], v[40:43], v[40:43], v[28:31]
    ds_read_b64_tr_b16 v[56:57], v6 offset:22528
    v_mfma_f32_16x16x32_bf16 v[64:67], a[108:111], v[40:43], v[64:67]
    ds_read_b64_tr_b16 v[58:59], v6 offset:23552
    v_mfma_f32_16x16x32_bf16 v[68:71], a[108:111], v[44:47], v[68:71]
    buffer_load_dwordx4 v5, s[24:27], m0 offen offset:2048 sc1 lds
    v_mfma_f32_16x16x32_bf16 v[76:79], a[112:115], v[44:47], v[76:79]
    ds_read_b64_tr_b16 v[60:61], v7 offset:22528
    v_mfma_f32_16x16x32_bf16 v[72:75], a[112:115], v[40:43], v[72:75]
    buffer_load_dwordx4 v5, s[24:27], m0 offen offset:3072 sc1 lds
    v_mfma_f32_16x16x32_bf16 v[80:83], a[116:119], v[40:43], v[80:83]
    s_add_u32 m0, m0, 8192
    ds_read_b64_tr_b16 v[62:63], v7 offset:23552
    v_mfma_f32_16x16x32_bf16 v[84:87], a[116:119], v[44:47], v[84:87]
    s_waitcnt lgkmcnt(4)
    v_mfma_f32_16x16x32_bf16 v[28:31], v[48:51], v[48:51], v[28:31]
    s_waitcnt vmcnt(12)
    s_barrier
    ds_read_b64_tr_b16 v[32:33], v6 offset:24576
    v_mfma_f32_16x16x32_bf16 v[64:67], a[120:123], v[48:51], v[64:67]
    ds_read_b64_tr_b16 v[34:35], v6 offset:25600
    v_mfma_f32_16x16x32_bf16 v[68:71], a[120:123], v[52:55], v[68:71]
    ds_read_b64_tr_b16 v[36:37], v7 offset:24576
    v_mfma_f32_16x16x32_bf16 v[76:79], a[124:127], v[52:55], v[76:79]
    buffer_load_dwordx4 v5, s[24:27], m0 offen offset:0 sc1 lds
    v_mfma_f32_16x16x32_bf16 v[72:75], a[124:127], v[48:51], v[72:75]
    ds_read_b64_tr_b16 v[38:39], v7 offset:25600
    v_mfma_f32_16x16x32_bf16 v[80:83], a[128:131], v[48:51], v[80:83]
    v_mfma_f32_16x16x32_bf16 v[84:87], a[128:131], v[52:55], v[84:87]
    s_waitcnt lgkmcnt(4)
    v_mfma_f32_16x16x32_bf16 v[28:31], v[56:59], v[56:59], v[28:31]
    ds_read_b64_tr_b16 v[40:41], v6 offset:26624
    v_mfma_f32_16x16x32_bf16 v[64:67], a[132:135], v[56:59], v[64:67]
    ds_read_b64_tr_b16 v[42:43], v6 offset:27648
    v_mfma_f32_16x16x32_bf16 v[68:71], a[132:135], v[60:63], v[68:71]
    buffer_load_dwordx4 v5, s[24:27], m0 offen offset:1024 sc1 lds
    v_mfma_f32_16x16x32_bf16 v[76:79], a[136:139], v[60:63], v[76:79]
    ds_read_b64_tr_b16 v[44:45], v7 offset:26624
    v_mfma_f32_16x16x32_bf16 v[72:75], a[136:139], v[56:59], v[72:75]
    buffer_load_dwordx4 v5, s[24:27], m0 offen offset:2048 sc1 lds
    v_mfma_f32_16x16x32_bf16 v[80:83], a[140:143], v[56:59], v[80:83]
    ds_read_b64_tr_b16 v[46:47], v7 offset:27648
    v_mfma_f32_16x16x32_bf16 v[84:87], a[140:143], v[60:63], v[84:87]
    s_waitcnt lgkmcnt(4)
    v_mfma_f32_16x16x32_bf16 v[28:31], v[32:35], v[32:35], v[28:31]
    ds_read_b64_tr_b16 v[48:49], v6 offset:28672
    v_mfma_f32_16x16x32_bf16 v[64:67], a[144:147], v[32:35], v[64:67]
    ds_read_b64_tr_b16 v[50:51], v6 offset:29696
    v_mfma_f32_16x16x32_bf16 v[68:71], a[144:147], v[36:39], v[68:71]
    ds_read_b64_tr_b16 v[52:53], v7 offset:28672
    v_mfma_f32_16x16x32_bf16 v[76:79], a[148:151], v[36:39], v[76:79]
    buffer_load_dwordx4 v5, s[24:27], m0 offen offset:3072 sc1 lds
    v_mfma_f32_16x16x32_bf16 v[72:75], a[148:151], v[32:35], v[72:75]
    ds_read_b64_tr_b16 v[54:55], v7 offset:29696
    v_mfma_f32_16x16x32_bf16 v[80:83], a[152:155], v[32:35], v[80:83]
    v_mfma_f32_16x16x32_bf16 v[84:87], a[152:155], v[36:39], v[84:87]
    s_waitcnt lgkmcnt(4)
    v_mfma_f32_16x16x32_bf16 v[28:31], v[40:43], v[40:43], v[28:31]
    ds_read_b64_tr_b16 v[56:57], v6 offset:30720
    v_mfma_f32_16x16x32_bf16 v[64:67], a[156:159], v[40:43], v[64:67]
    ds_read_b64_tr_b16 v[58:59], v6 offset:31744
    v_mfma_f32_16x16x32_bf16 v[68:71], a[156:159], v[44:47], v[68:71]
    ds_read_b64_tr_b16 v[60:61], v7 offset:30720
    v_mfma_f32_16x16x32_bf16 v[76:79], a[160:163], v[44:47], v[76:79]
    buffer_load_dwordx4 a[192:195], v15, s[24:27], s51 offen offset:0 sc1
    v_mfma_f32_16x16x32_bf16 v[72:75], a[160:163], v[40:43], v[72:75]
    ds_read_b64_tr_b16 v[62:63], v7 offset:31744
    v_mfma_f32_16x16x32_bf16 v[80:83], a[164:167], v[40:43], v[80:83]
    v_mfma_f32_16x16x32_bf16 v[84:87], a[164:167], v[44:47], v[84:87]
    s_waitcnt lgkmcnt(4)
    v_xor_b32 v6, 0x8000, v6
    v_xor_b32 v7, 0x8000, v7
    v_mfma_f32_16x16x32_bf16 v[28:31], v[48:51], v[48:51], v[28:31]
    ds_read_b64_tr_b16 v[32:33], v6 offset:0
    v_mfma_f32_16x16x32_bf16 v[64:67], a[168:171], v[48:51], v[64:67]
    ds_read_b64_tr_b16 v[34:35], v6 offset:1024
    v_mfma_f32_16x16x32_bf16 v[68:71], a[168:171], v[52:55], v[68:71]
    ds_read_b64_tr_b16 v[36:37], v7 offset:0
    v_mfma_f32_16x16x32_bf16 v[76:79], a[172:175], v[52:55], v[76:79]
    buffer_load_dwordx4 a[196:199], v15, s[24:27], s51 offen offset:1024 sc1
    v_mfma_f32_16x16x32_bf16 v[72:75], a[172:175], v[48:51], v[72:75]
    ds_read_b64_tr_b16 v[38:39], v7 offset:1024
    v_mfma_f32_16x16x32_bf16 v[80:83], a[176:179], v[48:51], v[80:83]
    v_mfma_f32_16x16x32_bf16 v[84:87], a[176:179], v[52:55], v[84:87]
    s_waitcnt lgkmcnt(4)
    v_mfma_f32_16x16x32_bf16 v[28:31], v[56:59], v[56:59], v[28:31]
    ds_read_b64_tr_b16 v[40:41], v6 offset:2048
    v_mfma_f32_16x16x32_bf16 v[64:67], a[180:183], v[56:59], v[64:67]
    ds_read_b64_tr_b16 v[42:43], v6 offset:3072
    v_mfma_f32_16x16x32_bf16 v[68:71], a[180:183], v[60:63], v[68:71]
    ds_read_b64_tr_b16 v[44:45], v7 offset:2048
    v_mfma_f32_16x16x32_bf16 v[76:79], a[184:187], v[60:63], v[76:79]
    buffer_load_dwordx4 a[200:203], v15, s[24:27], s51 offen offset:2048 sc1
    v_mfma_f32_16x16x32_bf16 v[72:75], a[184:187], v[56:59], v[72:75]
    ds_read_b64_tr_b16 v[46:47], v7 offset:3072
    v_mfma_f32_16x16x32_bf16 v[80:83], a[188:191], v[56:59], v[80:83]
    v_mfma_f32_16x16x32_bf16 v[84:87], a[188:191], v[60:63], v[84:87]
    s_waitcnt lgkmcnt(4)
    v_mfma_f32_16x16x32_bf16 v[96:99], a[0:3], v[32:35], 0
    ds_read_b64_tr_b16 v[48:49], v6 offset:4096
    v_cndmask_b32 v28, v28, v29, s[64:65]
    v_mfma_f32_16x16x32_bf16 v[100:103], a[0:3], v[36:39], 0
    ds_read_b64_tr_b16 v[50:51], v6 offset:5120
    v_cndmask_b32 v28, v28, v30, s[66:67]
    v_mfma_f32_16x16x32_bf16 v[108:111], a[4:7], v[36:39], 0
    ds_read_b64_tr_b16 v[52:53], v7 offset:4096
    v_cndmask_b32 v28, v28, v31, s[68:69]
    v_mov_b32 v30, 0x3b27c5ac
    v_mfma_f32_16x16x32_bf16 v[104:107], a[4:7], v[32:35], 0
    buffer_load_dwordx4 a[204:207], v15, s[24:27], s51 offen offset:3072 sc1
    v_mfma_f32_16x16x32_bf16 v[112:115], a[8:11], v[32:35], 0
    s_add_u32 s51, s51, 4096
    ds_read_b64_tr_b16 v[54:55], v7 offset:5120
    v_fmac_f32 v30, 0.5, v28
    v_mfma_f32_16x16x32_bf16 v[116:119], a[8:11], v[36:39], 0
    s_waitcnt lgkmcnt(4)
    v_rsq_f32 v31, v30
    v_mfma_f32_16x16x32_bf16 v[96:99], a[12:15], v[40:43], v[96:99]
    ds_read_b64_tr_b16 v[56:57], v6 offset:6144
    v_mul_f32 v28, 0xc0135761, v31
    v_mfma_f32_16x16x32_bf16 v[100:103], a[12:15], v[44:47], v[100:103]
    ds_read_b64_tr_b16 v[58:59], v6 offset:7168
    v_mul_f32 v31, v31, v31
    v_mfma_f32_16x16x32_bf16 v[108:111], a[16:19], v[44:47], v[108:111]
    ds_read_b64_tr_b16 v[60:61], v7 offset:6144
    v_mul_f32 v29, 0x3d372713, v28
    v_mfma_f32_16x16x32_bf16 v[104:107], a[16:19], v[40:43], v[104:107]
    buffer_load_dwordx4 a[208:211], v15, s[24:27], s51 offen offset:0 sc1
    v_mfma_f32_16x16x32_bf16 v[112:115], a[20:23], v[40:43], v[112:115]
    ds_read_b64_tr_b16 v[62:63], v7 offset:7168
    v_mul_f32 v29, v29, v31
    v_mfma_f32_16x16x32_bf16 v[116:119], a[20:23], v[44:47], v[116:119]
    s_waitcnt lgkmcnt(4)
    ds_write_b128 v9, v[28:31] offset:0
    v_mfma_f32_16x16x32_bf16 v[96:99], a[24:27], v[48:51], v[96:99]
    ds_read_b64_tr_b16 v[32:33], v6 offset:8192
    v_permlane32_swap_b32 v80, v84
    v_permlane32_swap_b32 v81, v85
    v_mfma_f32_16x16x32_bf16 v[100:103], a[24:27], v[52:55], v[100:103]
    ds_read_b64_tr_b16 v[34:35], v6 offset:9216
    v_permlane32_swap_b32 v82, v86
    v_mfma_f32_16x16x32_bf16 v[108:111], a[28:31], v[52:55], v[108:111]
    ds_read_b64_tr_b16 v[36:37], v7 offset:8192
    v_permlane32_swap_b32 v83, v87
    v_mul_f32 v128, v64, v64
    v_mul_f32 v129, v65, v65
    v_mfma_f32_16x16x32_bf16 v[104:107], a[28:31], v[48:51], v[104:107]
    buffer_load_dwordx4 a[212:215], v15, s[24:27], s51 offen offset:1024 sc1
    v_mul_f32 v130, v66, v66
    v_mul_f32 v131, v67, v67
    v_mfma_f32_16x16x32_bf16 v[112:115], a[32:35], v[48:51], v[112:115]
    ds_read_b64_tr_b16 v[38:39], v7 offset:9216
    v_mul_f32 v132, v68, v68
    v_mul_f32 v133, v69, v69
    v_mul_f32 v134, v70, v70
    v_mfma_f32_16x16x32_bf16 v[116:119], a[32:35], v[52:55], v[116:119]
    s_waitcnt lgkmcnt(5)
    v_mul_f32 v135, v71, v71
    v_mul_f32 v72, v64, v72
    v_mul_f32 v73, v65, v73
    v_mul_f32 v74, v66, v74
    v_mfma_f32_16x16x32_bf16 v[96:99], a[36:39], v[56:59], v[96:99]
    s_waitcnt lgkmcnt(4)
    s_waitcnt vmcnt(6)
    s_barrier
    ds_read_b64_tr_b16 v[40:41], v6 offset:10240
    ds_read_b64_tr_b16 v[42:43], v6 offset:11264
    v_mfma_f32_16x16x32_bf16 v[100:103], a[36:39], v[60:63], v[100:103]
    ds_read_b64_tr_b16 v[44:45], v7 offset:10240
    v_mul_f32 v75, v67, v75
    v_mfma_f32_16x16x32_bf16 v[108:111], a[40:43], v[60:63], v[108:111]
    ds_read_b64_tr_b16 v[46:47], v7 offset:11264
    v_mul_f32 v76, v68, v76
    v_mfma_f32_16x16x32_bf16 v[104:107], a[40:43], v[56:59], v[104:107]
    ds_read_b128 v[16:19], v10 offset:0
    v_mul_f32 v77, v69, v77
    v_mfma_f32_16x16x32_bf16 v[112:115], a[44:47], v[56:59], v[112:115]
    ds_read_b128 v[20:23], v8 offset:0
    v_mul_f32 v78, v70, v78
    v_mfma_f32_16x16x32_bf16 v[116:119], a[44:47], v[60:63], v[116:119]
    s_waitcnt lgkmcnt(6)
    ds_read_b128 v[24:27], v11 offset:0
    v_mul_f32 v79, v71, v79
    v_mfma_f32_16x16x32_bf16 v[96:99], a[48:51], v[32:35], v[96:99]
    ds_read_b64_tr_b16 v[48:49], v6 offset:12288
    s_waitcnt lgkmcnt(3)
    v_fma_f32 v128, v128, v17, v16
    v_fma_f32 v129, v129, v17, v16
    v_mfma_f32_16x16x32_bf16 v[100:103], a[48:51], v[36:39], v[100:103]
    ds_read_b64_tr_b16 v[50:51], v6 offset:13312
    v_fma_f32 v130, v130, v17, v16
    v_fma_f32 v131, v131, v17, v16
    v_mfma_f32_16x16x32_bf16 v[108:111], a[52:55], v[36:39], v[108:111]
    ds_read_b64_tr_b16 v[52:53], v7 offset:12288
    s_waitcnt lgkmcnt(4)
    v_fma_f32 v132, v132, v21, v20
    v_fma_f32 v133, v133, v21, v20
    v_fma_f32 v134, v134, v21, v20
    v_mfma_f32_16x16x32_bf16 v[104:107], a[52:55], v[32:35], v[104:107]
    ds_read_b64_tr_b16 v[54:55], v7 offset:13312
    v_fma_f32 v135, v135, v21, v20
    v_mul_f32 v128, v128, v64
    v_mfma_f32_16x16x32_bf16 v[112:115], a[56:59], v[32:35], v[112:115]
    v_mul_f32 v129, v129, v65
    v_mul_f32 v130, v130, v66
    v_mul_f32 v131, v131, v67
    v_mfma_f32_16x16x32_bf16 v[116:119], a[56:59], v[36:39], v[116:119]
    v_mul_f32 v132, v132, v68
    v_mul_f32 v133, v133, v69
    v_mul_f32 v134, v134, v70
    v_mfma_f32_16x16x32_bf16 v[96:99], a[60:63], v[40:43], v[96:99]
    ds_read_b64_tr_b16 v[56:57], v6 offset:14336
    v_mul_f32 v135, v135, v71
    v_mfma_f32_16x16x32_bf16 v[100:103], a[60:63], v[44:47], v[100:103]
    ds_read_b64_tr_b16 v[58:59], v6 offset:15360
    v_exp_f32 v128, v128
    v_mfma_f32_16x16x32_bf16 v[108:111], a[64:67], v[44:47], v[108:111]
    ds_read_b64_tr_b16 v[60:61], v7 offset:14336
    v_exp_f32 v129, v129
    v_mfma_f32_16x16x32_bf16 v[104:107], a[64:67], v[40:43], v[104:107]
    buffer_load_dwordx4 a[216:219], v15, s[24:27], s51 offen offset:2048 sc1
    v_mfma_f32_16x16x32_bf16 v[112:115], a[68:71], v[40:43], v[112:115]
    ds_read_b64_tr_b16 v[62:63], v7 offset:15360
    v_exp_f32 v130, v130
    v_mfma_f32_16x16x32_bf16 v[116:119], a[68:71], v[44:47], v[116:119]
    s_waitcnt lgkmcnt(4)
    v_exp_f32 v131, v131
    v_mfma_f32_16x16x32_bf16 v[96:99], a[72:75], v[48:51], v[96:99]
    ds_read_b64_tr_b16 v[32:33], v6 offset:16384
    v_exp_f32 v132, v132
    v_mfma_f32_16x16x32_bf16 v[100:103], a[72:75], v[52:55], v[100:103]
    ds_read_b64_tr_b16 v[34:35], v6 offset:17408
    v_exp_f32 v133, v133
    v_mfma_f32_16x16x32_bf16 v[108:111], a[76:79], v[52:55], v[108:111]
    ds_read_b64_tr_b16 v[36:37], v7 offset:16384
    v_exp_f32 v134, v134
    v_mfma_f32_16x16x32_bf16 v[104:107], a[76:79], v[48:51], v[104:107]
    buffer_load_dwordx4 a[220:223], v15, s[24:27], s51 offen offset:3072 sc1
    v_mfma_f32_16x16x32_bf16 v[112:115], a[80:83], v[48:51], v[112:115]
    s_add_u32 s51, s51, 4096
    ds_read_b64_tr_b16 v[38:39], v7 offset:17408
    v_exp_f32 v135, v135
    v_mfma_f32_16x16x32_bf16 v[116:119], a[80:83], v[52:55], v[116:119]
    s_waitcnt lgkmcnt(4)
    v_fma_f32 v128, v128, v18, v18
    v_fma_f32 v129, v129, v18, v18
    v_mfma_f32_16x16x32_bf16 v[96:99], a[84:87], v[56:59], v[96:99]
    ds_read_b64_tr_b16 v[40:41], v6 offset:18432
    v_fma_f32 v130, v130, v18, v18
    v_fma_f32 v131, v131, v18, v18
    v_mfma_f32_16x16x32_bf16 v[100:103], a[84:87], v[60:63], v[100:103]
    ds_read_b64_tr_b16 v[42:43], v6 offset:19456
    v_fma_f32 v132, v132, v22, v22
    v_mfma_f32_16x16x32_bf16 v[108:111], a[88:91], v[60:63], v[108:111]
    ds_read_b64_tr_b16 v[44:45], v7 offset:18432
    v_fma_f32 v133, v133, v22, v22
    v_fma_f32 v134, v134, v22, v22
    v_mfma_f32_16x16x32_bf16 v[104:107], a[88:91], v[56:59], v[104:107]
    buffer_load_dwordx4 a[224:227], v15, s[24:27], s51 offen offset:0 sc1
    v_fma_f32 v135, v135, v22, v22
    v_mfma_f32_16x16x32_bf16 v[112:115], a[92:95], v[56:59], v[112:115]
    ds_read_b64_tr_b16 v[46:47], v7 offset:19456
    v_rcp_f32 v128, v128
    v_mfma_f32_16x16x32_bf16 v[116:119], a[92:95], v[60:63], v[116:119]
    s_waitcnt lgkmcnt(4)
    v_rcp_f32 v129, v129
    v_mfma_f32_16x16x32_bf16 v[96:99], a[96:99], v[32:35], v[96:99]
    ds_read_b64_tr_b16 v[48:49], v6 offset:20480
    v_rcp_f32 v130, v130
    v_mfma_f32_16x16x32_bf16 v[100:103], a[96:99], v[36:39], v[100:103]
    ds_read_b64_tr_b16 v[50:51], v6 offset:21504
    v_rcp_f32 v131, v131
    v_mfma_f32_16x16x32_bf16 v[108:111], a[100:103], v[36:39], v[108:111]
    ds_read_b64_tr_b16 v[52:53], v7 offset:20480
    v_rcp_f32 v132, v132
    v_mfma_f32_16x16x32_bf16 v[104:107], a[100:103], v[32:35], v[104:107]
    buffer_load_dwordx4 a[228:231], v15, s[24:27], s51 offen offset:1024 sc1
    v_mfma_f32_16x16x32_bf16 v[112:115], a[104:107], v[32:35], v[112:115]
    ds_read_b64_tr_b16 v[54:55], v7 offset:21504
    v_rcp_f32 v133, v133
    v_mfma_f32_16x16x32_bf16 v[116:119], a[104:107], v[36:39], v[116:119]
    s_waitcnt lgkmcnt(4)
    v_rcp_f32 v134, v134
    v_mfma_f32_16x16x32_bf16 v[96:99], a[108:111], v[40:43], v[96:99]
    ds_read_b64_tr_b16 v[56:57], v6 offset:22528
    v_rcp_f32 v135, v135
    v_mfma_f32_16x16x32_bf16 v[100:103], a[108:111], v[44:47], v[100:103]
    ds_read_b64_tr_b16 v[58:59], v6 offset:23552
    v_mul_f32 v64, v72, v128
    v_mfma_f32_16x16x32_bf16 v[108:111], a[112:115], v[44:47], v[108:111]
    ds_read_b64_tr_b16 v[60:61], v7 offset:22528
    v_mul_f32 v65, v73, v129
    v_mul_f32 v66, v74, v130
    v_mfma_f32_16x16x32_bf16 v[104:107], a[112:115], v[40:43], v[104:107]
    buffer_load_dwordx4 a[232:235], v15, s[24:27], s51 offen offset:2048 sc1
    v_mfma_f32_16x16x32_bf16 v[112:115], a[116:119], v[40:43], v[112:115]
    ds_read_b64_tr_b16 v[62:63], v7 offset:23552
    v_mul_f32 v67, v75, v131
    v_mul_f32 v68, v76, v132
    v_mfma_f32_16x16x32_bf16 v[116:119], a[116:119], v[44:47], v[116:119]
    s_waitcnt lgkmcnt(4)
    v_mul_f32 v69, v77, v133
    v_mul_f32 v70, v78, v134
    v_mfma_f32_16x16x32_bf16 v[96:99], a[120:123], v[48:51], v[96:99]
    ds_read_b64_tr_b16 v[32:33], v6 offset:24576
    v_mul_f32 v71, v79, v135
    v_cvt_pk_bf16_f32 v136, v64, v65
    v_mfma_f32_16x16x32_bf16 v[100:103], a[120:123], v[52:55], v[100:103]
    ds_read_b64_tr_b16 v[34:35], v6 offset:25600
    v_cvt_pk_bf16_f32 v138, v68, v69
    v_mfma_f32_16x16x32_bf16 v[108:111], a[124:127], v[52:55], v[108:111]
    ds_read_b64_tr_b16 v[36:37], v7 offset:24576
    v_cvt_pk_bf16_f32 v137, v66, v67
    v_cvt_pk_bf16_f32 v139, v70, v71
    v_mfma_f32_16x16x32_bf16 v[104:107], a[124:127], v[48:51], v[104:107]
    buffer_load_dwordx4 a[236:239], v15, s[24:27], s51 offen offset:3072 sc1
    v_mfma_f32_16x16x32_bf16 v[112:115], a[128:131], v[48:51], v[112:115]
    s_add_u32 s51, s51, 4096
    ds_read_b64_tr_b16 v[38:39], v7 offset:25600
    v_mul_f32 v128, v80, v80
    v_mul_f32 v129, v81, v81
    v_mfma_f32_16x16x32_bf16 v[116:119], a[128:131], v[52:55], v[116:119]
    s_waitcnt lgkmcnt(4)
    v_permlane16_swap_b32 v136, v138
    v_mfma_f32_16x16x32_bf16 v[96:99], a[132:135], v[56:59], v[96:99]
    ds_read_b64_tr_b16 v[40:41], v6 offset:26624
    v_permlane16_swap_b32 v137, v139
    v_mfma_f32_16x16x32_bf16 v[100:103], a[132:135], v[60:63], v[100:103]
    buffer_store_dwordx4 v[136:139], v12, s[32:35], s55 offen sc1
    v_mul_f32 v130, v82, v82
    v_mfma_f32_16x16x32_bf16 v[108:111], a[136:139], v[60:63], v[108:111]
    ds_read_b64_tr_b16 v[42:43], v6 offset:27648
    v_mul_f32 v131, v83, v83
    v_mul_f32 v84, v80, v84
    v_mfma_f32_16x16x32_bf16 v[104:107], a[136:139], v[56:59], v[104:107]
    ds_read_b64_tr_b16 v[44:45], v7 offset:26624
    v_mul_f32 v85, v81, v85
    v_mfma_f32_16x16x32_bf16 v[112:115], a[140:143], v[56:59], v[112:115]
    buffer_load_dwordx4 a[240:243], v15, s[24:27], s51 offen offset:0 sc1
    v_mul_f32 v86, v82, v86
    v_mfma_f32_16x16x32_bf16 v[116:119], a[140:143], v[60:63], v[116:119]
    s_waitcnt lgkmcnt(3)
    ds_read_b64_tr_b16 v[46:47], v7 offset:27648
    v_mul_f32 v87, v83, v87
    v_fma_f32 v128, v128, v25, v24
    v_mfma_f32_16x16x32_bf16 v[96:99], a[144:147], v[32:35], v[96:99]
    ds_read_b64_tr_b16 v[48:49], v6 offset:28672
    v_fma_f32 v129, v129, v25, v24
    v_fma_f32 v130, v130, v25, v24
    v_mfma_f32_16x16x32_bf16 v[100:103], a[144:147], v[36:39], v[100:103]
    ds_read_b64_tr_b16 v[50:51], v6 offset:29696
    v_fma_f32 v131, v131, v25, v24
    v_mul_f32 v128, v128, v80
    v_mfma_f32_16x16x32_bf16 v[108:111], a[148:151], v[36:39], v[108:111]
    ds_read_b64_tr_b16 v[52:53], v7 offset:28672
    v_mul_f32 v129, v129, v81
    v_mul_f32 v130, v130, v82
    v_mfma_f32_16x16x32_bf16 v[104:107], a[148:151], v[32:35], v[104:107]
    buffer_load_dwordx4 a[244:247], v15, s[24:27], s51 offen offset:1024 sc1
    v_mfma_f32_16x16x32_bf16 v[112:115], a[152:155], v[32:35], v[112:115]
    ds_read_b64_tr_b16 v[54:55], v7 offset:29696
    v_mul_f32 v131, v131, v83
    v_exp_f32 v128, v128
    v_mfma_f32_16x16x32_bf16 v[116:119], a[152:155], v[36:39], v[116:119]
    s_waitcnt lgkmcnt(4)
    v_exp_f32 v129, v129
    v_mfma_f32_16x16x32_bf16 v[96:99], a[156:159], v[40:43], v[96:99]
    ds_read_b64_tr_b16 v[56:57], v6 offset:30720
    v_exp_f32 v130, v130
    v_mfma_f32_16x16x32_bf16 v[100:103], a[156:159], v[44:47], v[100:103]
    ds_read_b64_tr_b16 v[58:59], v6 offset:31744
    v_exp_f32 v131, v131
    v_mfma_f32_16x16x32_bf16 v[108:111], a[160:163], v[44:47], v[108:111]
    ds_read_b64_tr_b16 v[60:61], v7 offset:30720
    v_fma_f32 v128, v128, v26, v26
    v_mfma_f32_16x16x32_bf16 v[104:107], a[160:163], v[40:43], v[104:107]
    buffer_load_dwordx4 a[248:251], v15, s[24:27], s51 offen offset:2048 sc1
    v_fma_f32 v129, v129, v26, v26
    v_mfma_f32_16x16x32_bf16 v[112:115], a[164:167], v[40:43], v[112:115]
    ds_read_b64_tr_b16 v[62:63], v7 offset:31744
    v_fma_f32 v130, v130, v26, v26
    v_mfma_f32_16x16x32_bf16 v[116:119], a[164:167], v[44:47], v[116:119]
    s_waitcnt lgkmcnt(4)
    v_xor_b32 v6, 0x18000, v6
    v_xor_b32 v7, 0x18000, v7
    v_fma_f32 v131, v131, v26, v26
    v_mfma_f32_16x16x32_bf16 v[96:99], a[168:171], v[48:51], v[96:99]
    ds_read_b64_tr_b16 v[32:33], v6 offset:0
    v_rcp_f32 v128, v128
    v_mfma_f32_16x16x32_bf16 v[100:103], a[168:171], v[52:55], v[100:103]
    ds_read_b64_tr_b16 v[34:35], v6 offset:1024
    v_rcp_f32 v129, v129
    v_mfma_f32_16x16x32_bf16 v[108:111], a[172:175], v[52:55], v[108:111]
    ds_read_b64_tr_b16 v[36:37], v7 offset:0
    v_rcp_f32 v130, v130
    v_mfma_f32_16x16x32_bf16 v[104:107], a[172:175], v[48:51], v[104:107]
    buffer_load_dwordx4 a[252:255], v15, s[24:27], s51 offen offset:3072 sc1
    v_mfma_f32_16x16x32_bf16 v[112:115], a[176:179], v[48:51], v[112:115]
    s_add_u32 s51, s51, 4096
    ds_read_b64_tr_b16 v[38:39], v7 offset:1024
    v_rcp_f32 v131, v131
    v_mfma_f32_16x16x32_bf16 v[116:119], a[176:179], v[52:55], v[116:119]
    s_waitcnt lgkmcnt(4)
    v_mul_f32 v80, v84, v128
    v_mul_f32 v81, v85, v129
    v_mfma_f32_16x16x32_bf16 v[96:99], a[180:183], v[56:59], v[96:99]
    ds_read_b64_tr_b16 v[40:41], v6 offset:2048
    v_mul_f32 v82, v86, v130
    v_mfma_f32_16x16x32_bf16 v[100:103], a[180:183], v[60:63], v[100:103]
    ds_read_b64_tr_b16 v[42:43], v6 offset:3072
    v_mul_f32 v83, v87, v131
    v_cvt_pk_bf16_f32 v140, v80, v81
    v_mfma_f32_16x16x32_bf16 v[108:111], a[184:187], v[60:63], v[108:111]
    ds_read_b64_tr_b16 v[44:45], v7 offset:2048
    v_cvt_pk_bf16_f32 v141, v82, v83
    v_mfma_f32_16x16x32_bf16 v[104:107], a[184:187], v[56:59], v[104:107]
    ds_read_b64_tr_b16 v[46:47], v7 offset:3072
    v_xor_b32 v10, 0x200, v10
    v_mfma_f32_16x16x32_bf16 v[112:115], a[188:191], v[56:59], v[112:115]
    v_xor_b32 v8, 0x200, v8
    v_xor_b32 v11, 0x200, v11
    v_mfma_f32_16x16x32_bf16 v[116:119], a[188:191], v[60:63], v[116:119]
    s_waitcnt lgkmcnt(4)
    ds_read_b128 v[16:19], v10 offset:0
    ds_read_b128 v[20:23], v8 offset:0
    ds_read_b128 v[24:27], v11 offset:0
    v_mfma_f32_16x16x32_bf16 v[28:31], v[32:35], v[32:35], 0
    ds_read_b64_tr_b16 v[48:49], v6 offset:4096
    s_nop 1
    v_permlane32_swap_b32 v112, v116
    v_mfma_f32_16x16x32_bf16 v[64:67], a[0:3], v[32:35], 0
    ds_read_b64_tr_b16 v[50:51], v6 offset:5120
    v_mfma_f32_16x16x32_bf16 v[68:71], a[0:3], v[36:39], 0
    ds_read_b64_tr_b16 v[52:53], v7 offset:4096
    v_permlane32_swap_b32 v113, v117
    v_mfma_f32_16x16x32_bf16 v[76:79], a[4:7], v[36:39], 0
    buffer_load_dwordx4 v[144:147], v15, s[24:27], s51 offen offset:0 sc1
    v_mfma_f32_16x16x32_bf16 v[72:75], a[4:7], v[32:35], 0
    ds_read_b64_tr_b16 v[54:55], v7 offset:5120
    v_permlane32_swap_b32 v114, v118
    v_mfma_f32_16x16x32_bf16 v[80:83], a[8:11], v[32:35], 0
    v_permlane32_swap_b32 v115, v119
    v_mul_f32 v128, v96, v96
    v_mfma_f32_16x16x32_bf16 v[84:87], a[8:11], v[36:39], 0
    s_waitcnt lgkmcnt(7)
    v_mul_f32 v129, v97, v97
    v_mul_f32 v130, v98, v98
    v_mfma_f32_16x16x32_bf16 v[28:31], v[40:43], v[40:43], v[28:31]
    ds_read_b64_tr_b16 v[56:57], v6 offset:6144
    v_mul_f32 v131, v99, v99
    v_mfma_f32_16x16x32_bf16 v[64:67], a[12:15], v[40:43], v[64:67]
    ds_read_b64_tr_b16 v[58:59], v6 offset:7168
    v_mul_f32 v132, v100, v100
    v_mul_f32 v133, v101, v101
    v_mfma_f32_16x16x32_bf16 v[68:71], a[12:15], v[44:47], v[68:71]
    ds_read_b64_tr_b16 v[60:61], v7 offset:6144
    v_mul_f32 v134, v102, v102
    v_mfma_f32_16x16x32_bf16 v[76:79], a[16:19], v[44:47], v[76:79]
    buffer_load_dwordx4 v[148:151], v15, s[24:27], s51 offen offset:1024 sc1
    v_mul_f32 v135, v103, v103
    v_mfma_f32_16x16x32_bf16 v[72:75], a[16:19], v[40:43], v[72:75]
    ds_read_b64_tr_b16 v[62:63], v7 offset:7168
    v_mul_f32 v104, v96, v104
    v_mfma_f32_16x16x32_bf16 v[80:83], a[20:23], v[40:43], v[80:83]
    v_mul_f32 v105, v97, v105
    v_mul_f32 v106, v98, v106
    v_mul_f32 v107, v99, v107
    v_mfma_f32_16x16x32_bf16 v[84:87], a[20:23], v[44:47], v[84:87]
    s_waitcnt lgkmcnt(4)
    v_mul_f32 v108, v100, v108
    v_mul_f32 v109, v101, v109
    v_mfma_f32_16x16x32_bf16 v[28:31], v[48:51], v[48:51], v[28:31]
    ds_read_b64_tr_b16 v[32:33], v6 offset:8192
    v_mul_f32 v110, v102, v110
    v_mfma_f32_16x16x32_bf16 v[64:67], a[24:27], v[48:51], v[64:67]
    ds_read_b64_tr_b16 v[34:35], v6 offset:9216
    v_mul_f32 v111, v103, v111
    v_fma_f32 v128, v128, v17, v16
    v_mfma_f32_16x16x32_bf16 v[68:71], a[24:27], v[52:55], v[68:71]
    ds_read_b64_tr_b16 v[36:37], v7 offset:8192
    v_fma_f32 v129, v129, v17, v16
    v_mfma_f32_16x16x32_bf16 v[76:79], a[28:31], v[52:55], v[76:79]
    buffer_load_dwordx4 v[152:155], v15, s[24:27], s51 offen offset:2048 sc1
    v_fma_f32 v130, v130, v17, v16
    v_mfma_f32_16x16x32_bf16 v[72:75], a[28:31], v[48:51], v[72:75]
    ds_read_b64_tr_b16 v[38:39], v7 offset:9216
    v_fma_f32 v131, v131, v17, v16
    v_mfma_f32_16x16x32_bf16 v[80:83], a[32:35], v[48:51], v[80:83]
    v_fma_f32 v132, v132, v21, v20
    v_fma_f32 v133, v133, v21, v20
    v_fma_f32 v134, v134, v21, v20
    v_mfma_f32_16x16x32_bf16 v[84:87], a[32:35], v[52:55], v[84:87]
    s_waitcnt lgkmcnt(4)
    v_fma_f32 v135, v135, v21, v20
    v_mul_f32 v128, v128, v96
    v_mfma_f32_16x16x32_bf16 v[28:31], v[56:59], v[56:59], v[28:31]
    ds_read_b64_tr_b16 v[40:41], v6 offset:10240
    v_mul_f32 v129, v129, v97
    v_mfma_f32_16x16x32_bf16 v[64:67], a[36:39], v[56:59], v[64:67]
    ds_read_b64_tr_b16 v[42:43], v6 offset:11264
    v_mul_f32 v130, v130, v98
    v_mul_f32 v131, v131, v99
    v_mfma_f32_16x16x32_bf16 v[68:71], a[36:39], v[60:63], v[68:71]
    ds_read_b64_tr_b16 v[44:45], v7 offset:10240
    v_mul_f32 v132, v132, v100
    v_mfma_f32_16x16x32_bf16 v[76:79], a[40:43], v[60:63], v[76:79]
    buffer_load_dwordx4 v[156:159], v15, s[24:27], s51 offen offset:3072 sc1
    v_mul_f32 v133, v133, v101
    v_mfma_f32_16x16x32_bf16 v[72:75], a[40:43], v[56:59], v[72:75]
    s_add_u32 s51, s51, 4096
    ds_read_b64_tr_b16 v[46:47], v7 offset:11264
    v_mul_f32 v134, v134, v102
    v_mfma_f32_16x16x32_bf16 v[80:83], a[44:47], v[56:59], v[80:83]
    v_mul_f32 v135, v135, v103
    v_exp_f32 v128, v128
    v_mfma_f32_16x16x32_bf16 v[84:87], a[44:47], v[60:63], v[84:87]
    s_waitcnt lgkmcnt(4)
    v_exp_f32 v129, v129
    v_mfma_f32_16x16x32_bf16 v[28:31], v[32:35], v[32:35], v[28:31]
    ds_read_b64_tr_b16 v[48:49], v6 offset:12288
    v_exp_f32 v130, v130
    v_mfma_f32_16x16x32_bf16 v[64:67], a[48:51], v[32:35], v[64:67]
    ds_read_b64_tr_b16 v[50:51], v6 offset:13312
    v_exp_f32 v131, v131
    v_mfma_f32_16x16x32_bf16 v[68:71], a[48:51], v[36:39], v[68:71]
    ds_read_b64_tr_b16 v[52:53], v7 offset:12288
    v_mfma_f32_16x16x32_bf16 v[76:79], a[52:55], v[36:39], v[76:79]
    buffer_load_dwordx4 v[160:163], v15, s[24:27], s51 offen offset:0 sc1
    v_exp_f32 v132, v132
    v_mfma_f32_16x16x32_bf16 v[72:75], a[52:55], v[32:35], v[72:75]
    ds_read_b64_tr_b16 v[54:55], v7 offset:13312
    v_mfma_f32_16x16x32_bf16 v[80:83], a[56:59], v[32:35], v[80:83]
    v_exp_f32 v133, v133
    v_exp_f32 v134, v134
    v_mfma_f32_16x16x32_bf16 v[84:87], a[56:59], v[36:39], v[84:87]
    s_waitcnt lgkmcnt(4)
    v_exp_f32 v135, v135
    v_mfma_f32_16x16x32_bf16 v[28:31], v[40:43], v[40:43], v[28:31]
    ds_read_b64_tr_b16 v[56:57], v6 offset:14336
    v_fma_f32 v128, v128, v18, v18
    v_mfma_f32_16x16x32_bf16 v[64:67], a[60:63], v[40:43], v[64:67]
    ds_read_b64_tr_b16 v[58:59], v6 offset:15360
    v_fma_f32 v129, v129, v18, v18
    v_fma_f32 v130, v130, v18, v18
    v_mfma_f32_16x16x32_bf16 v[68:71], a[60:63], v[44:47], v[68:71]
    ds_read_b64_tr_b16 v[60:61], v7 offset:14336
    v_fma_f32 v131, v131, v18, v18
    v_mfma_f32_16x16x32_bf16 v[76:79], a[64:67], v[44:47], v[76:79]
    buffer_load_dwordx4 v[164:167], v15, s[24:27], s51 offen offset:1024 sc1
    v_mfma_f32_16x16x32_bf16 v[72:75], a[64:67], v[40:43], v[72:75]
    ds_read_b64_tr_b16 v[62:63], v7 offset:15360
    v_fma_f32 v132, v132, v22, v22
    v_mfma_f32_16x16x32_bf16 v[80:83], a[68:71], v[40:43], v[80:83]
    v_fma_f32 v133, v133, v22, v22
    v_fma_f32 v134, v134, v22, v22
    v_fma_f32 v135, v135, v22, v22
    v_mfma_f32_16x16x32_bf16 v[84:87], a[68:71], v[44:47], v[84:87]
    s_waitcnt lgkmcnt(4)
    v_rcp_f32 v128, v128
    v_mfma_f32_16x16x32_bf16 v[28:31], v[48:51], v[48:51], v[28:31]
    ds_read_b64_tr_b16 v[32:33], v6 offset:16384
    v_rcp_f32 v129, v129
    v_mfma_f32_16x16x32_bf16 v[64:67], a[72:75], v[48:51], v[64:67]
    ds_read_b64_tr_b16 v[34:35], v6 offset:17408
    v_rcp_f32 v130, v130
    v_mfma_f32_16x16x32_bf16 v[68:71], a[72:75], v[52:55], v[68:71]
    ds_read_b64_tr_b16 v[36:37], v7 offset:16384
    v_mfma_f32_16x16x32_bf16 v[76:79], a[76:79], v[52:55], v[76:79]
    buffer_load_dwordx4 v[168:171], v15, s[24:27], s51 offen offset:2048 sc1
    v_rcp_f32 v131, v131
    v_mfma_f32_16x16x32_bf16 v[72:75], a[76:79], v[48:51], v[72:75]
    ds_read_b64_tr_b16 v[38:39], v7 offset:17408
    v_mfma_f32_16x16x32_bf16 v[80:83], a[80:83], v[48:51], v[80:83]
    v_rcp_f32 v132, v132
    v_rcp_f32 v133, v133
    v_mfma_f32_16x16x32_bf16 v[84:87], a[80:83], v[52:55], v[84:87]
    s_waitcnt lgkmcnt(4)
    v_rcp_f32 v134, v134
    v_mfma_f32_16x16x32_bf16 v[28:31], v[56:59], v[56:59], v[28:31]
    ds_read_b64_tr_b16 v[40:41], v6 offset:18432
    v_rcp_f32 v135, v135
    v_mfma_f32_16x16x32_bf16 v[64:67], a[84:87], v[56:59], v[64:67]
    ds_read_b64_tr_b16 v[42:43], v6 offset:19456
    v_mul_f32 v96, v104, v128
    v_mfma_f32_16x16x32_bf16 v[68:71], a[84:87], v[60:63], v[68:71]
    ds_read_b64_tr_b16 v[44:45], v7 offset:18432
    v_mul_f32 v97, v105, v129
    v_mfma_f32_16x16x32_bf16 v[76:79], a[88:91], v[60:63], v[76:79]
    buffer_load_dwordx4 v[172:175], v15, s[24:27], s51 offen offset:3072 sc1
    v_mul_f32 v98, v106, v130
    v_mfma_f32_16x16x32_bf16 v[72:75], a[88:91], v[56:59], v[72:75]
    s_add_u32 s51, s51, 4096
    ds_read_b64_tr_b16 v[46:47], v7 offset:19456
    v_mul_f32 v99, v107, v131
    v_mfma_f32_16x16x32_bf16 v[80:83], a[92:95], v[56:59], v[80:83]
    v_mul_f32 v100, v108, v132
    v_mul_f32 v101, v109, v133
    v_mul_f32 v102, v110, v134
    v_mfma_f32_16x16x32_bf16 v[84:87], a[92:95], v[60:63], v[84:87]
    s_waitcnt lgkmcnt(4)
    v_mul_f32 v103, v111, v135
    v_cvt_pk_bf16_f32 v136, v96, v97
    v_mfma_f32_16x16x32_bf16 v[28:31], v[32:35], v[32:35], v[28:31]
    ds_read_b64_tr_b16 v[48:49], v6 offset:20480
    v_cvt_pk_bf16_f32 v138, v100, v101
    v_cvt_pk_bf16_f32 v137, v98, v99
    v_mfma_f32_16x16x32_bf16 v[64:67], a[96:99], v[32:35], v[64:67]
    ds_read_b64_tr_b16 v[50:51], v6 offset:21504
    v_cvt_pk_bf16_f32 v139, v102, v103
    v_mfma_f32_16x16x32_bf16 v[68:71], a[96:99], v[36:39], v[68:71]
    ds_read_b64_tr_b16 v[52:53], v7 offset:20480
    v_mul_f32 v128, v112, v112
    v_mul_f32 v129, v113, v113
    v_mfma_f32_16x16x32_bf16 v[76:79], a[100:103], v[36:39], v[76:79]
    buffer_load_dwordx4 v[176:179], v15, s[24:27], s51 offen offset:0 sc1
    v_mfma_f32_16x16x32_bf16 v[72:75], a[100:103], v[32:35], v[72:75]
    ds_read_b64_tr_b16 v[54:55], v7 offset:21504
    v_permlane16_swap_b32 v136, v138
    v_mfma_f32_16x16x32_bf16 v[80:83], a[104:107], v[32:35], v[80:83]
    v_permlane16_swap_b32 v137, v139
    v_mfma_f32_16x16x32_bf16 v[84:87], a[104:107], v[36:39], v[84:87]
    s_waitcnt lgkmcnt(4)
    buffer_store_dwordx4 v[136:139], v12, s[32:35], s56 offen sc1
    v_mul_f32 v130, v114, v114
    v_mfma_f32_16x16x32_bf16 v[28:31], v[40:43], v[40:43], v[28:31]
    ds_read_b64_tr_b16 v[56:57], v6 offset:22528
    v_mul_f32 v131, v115, v115
    v_mfma_f32_16x16x32_bf16 v[64:67], a[108:111], v[40:43], v[64:67]
    ds_read_b64_tr_b16 v[58:59], v6 offset:23552
    v_mul_f32 v116, v112, v116
    v_mfma_f32_16x16x32_bf16 v[68:71], a[108:111], v[44:47], v[68:71]
    ds_read_b64_tr_b16 v[60:61], v7 offset:22528
    v_mul_f32 v117, v113, v117
    v_mfma_f32_16x16x32_bf16 v[76:79], a[112:115], v[44:47], v[76:79]
    ds_read_b64_tr_b16 v[62:63], v7 offset:23552
    v_mul_f32 v118, v114, v118
    v_mul_f32 v119, v115, v119
    v_mfma_f32_16x16x32_bf16 v[72:75], a[112:115], v[40:43], v[72:75]
    v_fma_f32 v128, v128, v25, v24
    v_fma_f32 v129, v129, v25, v24
    v_mfma_f32_16x16x32_bf16 v[80:83], a[116:119], v[40:43], v[80:83]
    v_fma_f32 v130, v130, v25, v24
    v_fma_f32 v131, v131, v25, v24
    v_mfma_f32_16x16x32_bf16 v[84:87], a[116:119], v[44:47], v[84:87]
    s_waitcnt lgkmcnt(4)
    v_mul_f32 v128, v128, v112
    v_mul_f32 v129, v129, v113
    v_mfma_f32_16x16x32_bf16 v[28:31], v[48:51], v[48:51], v[28:31]
    ds_read_b64_tr_b16 v[32:33], v6 offset:24576
    v_mul_f32 v130, v130, v114
    v_mfma_f32_16x16x32_bf16 v[64:67], a[120:123], v[48:51], v[64:67]
    ds_read_b64_tr_b16 v[34:35], v6 offset:25600
    v_mul_f32 v131, v131, v115
    v_mfma_f32_16x16x32_bf16 v[68:71], a[120:123], v[52:55], v[68:71]
    ds_read_b64_tr_b16 v[36:37], v7 offset:24576
    v_exp_f32 v128, v128
    v_mfma_f32_16x16x32_bf16 v[76:79], a[124:127], v[52:55], v[76:79]
    buffer_load_dwordx4 v[180:183], v15, s[24:27], s51 offen offset:1024 sc1
    v_mfma_f32_16x16x32_bf16 v[72:75], a[124:127], v[48:51], v[72:75]
    ds_read_b64_tr_b16 v[38:39], v7 offset:25600
    v_exp_f32 v129, v129
    v_mfma_f32_16x16x32_bf16 v[80:83], a[128:131], v[48:51], v[80:83]
    v_exp_f32 v130, v130
    v_mfma_f32_16x16x32_bf16 v[84:87], a[128:131], v[52:55], v[84:87]
    s_waitcnt lgkmcnt(4)
    v_exp_f32 v131, v131
    v_fma_f32 v128, v128, v26, v26
    v_mfma_f32_16x16x32_bf16 v[28:31], v[56:59], v[56:59], v[28:31]
    ds_read_b64_tr_b16 v[40:41], v6 offset:26624
    v_fma_f32 v129, v129, v26, v26
    v_mfma_f32_16x16x32_bf16 v[64:67], a[132:135], v[56:59], v[64:67]
    ds_read_b64_tr_b16 v[42:43], v6 offset:27648
    v_fma_f32 v130, v130, v26, v26
    v_fma_f32 v131, v131, v26, v26
    v_mfma_f32_16x16x32_bf16 v[68:71], a[132:135], v[60:63], v[68:71]
    ds_read_b64_tr_b16 v[44:45], v7 offset:26624
    v_rcp_f32 v128, v128
    v_mfma_f32_16x16x32_bf16 v[76:79], a[136:139], v[60:63], v[76:79]
    buffer_load_dwordx4 v[184:187], v15, s[24:27], s51 offen offset:2048 sc1
    v_mfma_f32_16x16x32_bf16 v[72:75], a[136:139], v[56:59], v[72:75]
    ds_read_b64_tr_b16 v[46:47], v7 offset:27648
    v_rcp_f32 v129, v129
    v_mfma_f32_16x16x32_bf16 v[80:83], a[140:143], v[56:59], v[80:83]
    v_rcp_f32 v130, v130
    v_mfma_f32_16x16x32_bf16 v[84:87], a[140:143], v[60:63], v[84:87]
    s_waitcnt lgkmcnt(4)
    v_rcp_f32 v131, v131
    v_mfma_f32_16x16x32_bf16 v[28:31], v[32:35], v[32:35], v[28:31]
    ds_read_b64_tr_b16 v[48:49], v6 offset:28672
    v_mul_f32 v112, v116, v128
    v_mul_f32 v113, v117, v129
    v_mfma_f32_16x16x32_bf16 v[64:67], a[144:147], v[32:35], v[64:67]
    ds_read_b64_tr_b16 v[50:51], v6 offset:29696
    v_mul_f32 v114, v118, v130
    v_mfma_f32_16x16x32_bf16 v[68:71], a[144:147], v[36:39], v[68:71]
    ds_read_b64_tr_b16 v[52:53], v7 offset:28672
    v_mul_f32 v115, v119, v131
    v_cvt_pk_bf16_f32 v142, v112, v113
    v_mfma_f32_16x16x32_bf16 v[76:79], a[148:151], v[36:39], v[76:79]
    buffer_load_dwordx4 v[188:191], v15, s[24:27], s51 offen offset:3072 sc1
    v_mfma_f32_16x16x32_bf16 v[72:75], a[148:151], v[32:35], v[72:75]
    s_add_u32 s51, s51, 4096
    ds_read_b64_tr_b16 v[54:55], v7 offset:29696
    v_cvt_pk_bf16_f32 v143, v114, v115
    v_mfma_f32_16x16x32_bf16 v[80:83], a[152:155], v[32:35], v[80:83]
    v_permlane16_swap_b32 v140, v142
    v_permlane16_swap_b32 v141, v143
    v_mfma_f32_16x16x32_bf16 v[84:87], a[152:155], v[36:39], v[84:87]
    s_waitcnt lgkmcnt(4)
    buffer_store_dwordx4 v[140:143], v13, s[32:35], s56 offen sc1
    v_mfma_f32_16x16x32_bf16 v[28:31], v[40:43], v[40:43], v[28:31]
    ds_read_b64_tr_b16 v[56:57], v6 offset:30720
    v_mfma_f32_16x16x32_bf16 v[64:67], a[156:159], v[40:43], v[64:67]
    ds_read_b64_tr_b16 v[58:59], v6 offset:31744
    v_mfma_f32_16x16x32_bf16 v[68:71], a[156:159], v[44:47], v[68:71]
    ds_read_b64_tr_b16 v[60:61], v7 offset:30720
    v_mfma_f32_16x16x32_bf16 v[76:79], a[160:163], v[44:47], v[76:79]
    buffer_load_dwordx4 v[192:195], v15, s[24:27], s51 offen offset:0 sc1
    v_mfma_f32_16x16x32_bf16 v[72:75], a[160:163], v[40:43], v[72:75]
    ds_read_b64_tr_b16 v[62:63], v7 offset:31744
    v_mfma_f32_16x16x32_bf16 v[80:83], a[164:167], v[40:43], v[80:83]
    v_mfma_f32_16x16x32_bf16 v[84:87], a[164:167], v[44:47], v[84:87]
    s_waitcnt lgkmcnt(4)
    v_xor_b32 v6, 0x8000, v6
    v_xor_b32 v7, 0x8000, v7
    v_mfma_f32_16x16x32_bf16 v[28:31], v[48:51], v[48:51], v[28:31]
    ds_read_b64_tr_b16 v[32:33], v6 offset:0
    v_mfma_f32_16x16x32_bf16 v[64:67], a[168:171], v[48:51], v[64:67]
    ds_read_b64_tr_b16 v[34:35], v6 offset:1024
    v_mfma_f32_16x16x32_bf16 v[68:71], a[168:171], v[52:55], v[68:71]
    ds_read_b64_tr_b16 v[36:37], v7 offset:0
    v_mfma_f32_16x16x32_bf16 v[76:79], a[172:175], v[52:55], v[76:79]
    buffer_load_dwordx4 v[196:199], v15, s[24:27], s51 offen offset:1024 sc1
    v_mfma_f32_16x16x32_bf16 v[72:75], a[172:175], v[48:51], v[72:75]
    ds_read_b64_tr_b16 v[38:39], v7 offset:1024
    v_mfma_f32_16x16x32_bf16 v[80:83], a[176:179], v[48:51], v[80:83]
    v_mfma_f32_16x16x32_bf16 v[84:87], a[176:179], v[52:55], v[84:87]
    s_waitcnt lgkmcnt(4)
    v_mfma_f32_16x16x32_bf16 v[28:31], v[56:59], v[56:59], v[28:31]
    ds_read_b64_tr_b16 v[40:41], v6 offset:2048
    v_mfma_f32_16x16x32_bf16 v[64:67], a[180:183], v[56:59], v[64:67]
    ds_read_b64_tr_b16 v[42:43], v6 offset:3072
    v_mfma_f32_16x16x32_bf16 v[68:71], a[180:183], v[60:63], v[68:71]
    ds_read_b64_tr_b16 v[44:45], v7 offset:2048
    v_mfma_f32_16x16x32_bf16 v[76:79], a[184:187], v[60:63], v[76:79]
    buffer_load_dwordx4 v[200:203], v15, s[24:27], s51 offen offset:2048 sc1
    v_mfma_f32_16x16x32_bf16 v[72:75], a[184:187], v[56:59], v[72:75]
    ds_read_b64_tr_b16 v[46:47], v7 offset:3072
    v_mfma_f32_16x16x32_bf16 v[80:83], a[188:191], v[56:59], v[80:83]
    v_mfma_f32_16x16x32_bf16 v[84:87], a[188:191], v[60:63], v[84:87]
    s_waitcnt lgkmcnt(4)
    v_mfma_f32_16x16x32_bf16 v[96:99], a[0:3], v[32:35], 0
    ds_read_b64_tr_b16 v[48:49], v6 offset:4096
    v_cndmask_b32 v28, v28, v29, s[64:65]
    v_mfma_f32_16x16x32_bf16 v[100:103], a[0:3], v[36:39], 0
    ds_read_b64_tr_b16 v[50:51], v6 offset:5120
    v_cndmask_b32 v28, v28, v30, s[66:67]
    v_mfma_f32_16x16x32_bf16 v[108:111], a[4:7], v[36:39], 0
    ds_read_b64_tr_b16 v[52:53], v7 offset:4096
    v_cndmask_b32 v28, v28, v31, s[68:69]
    v_mov_b32 v30, 0x3b27c5ac
    v_mfma_f32_16x16x32_bf16 v[104:107], a[4:7], v[32:35], 0
    buffer_load_dwordx4 v[204:207], v15, s[24:27], s51 offen offset:3072 sc1
    v_mfma_f32_16x16x32_bf16 v[112:115], a[8:11], v[32:35], 0
    s_add_u32 s51, s51, 4096
    ds_read_b64_tr_b16 v[54:55], v7 offset:5120
    v_fmac_f32 v30, 0.5, v28
    v_mfma_f32_16x16x32_bf16 v[116:119], a[8:11], v[36:39], 0
    s_waitcnt lgkmcnt(4)
    v_rsq_f32 v31, v30
    v_mfma_f32_16x16x32_bf16 v[96:99], a[12:15], v[40:43], v[96:99]
    ds_read_b64_tr_b16 v[56:57], v6 offset:6144
    v_mul_f32 v28, 0xc0135761, v31
    v_mul_f32 v31, v31, v31
    v_mfma_f32_16x16x32_bf16 v[100:103], a[12:15], v[44:47], v[100:103]
    ds_read_b64_tr_b16 v[58:59], v6 offset:7168
    v_mul_f32 v29, 0x3d372713, v28
    v_mfma_f32_16x16x32_bf16 v[108:111], a[16:19], v[44:47], v[108:111]
    ds_read_b64_tr_b16 v[60:61], v7 offset:6144
    v_mul_f32 v29, v29, v31
    v_mfma_f32_16x16x32_bf16 v[104:107], a[16:19], v[40:43], v[104:107]
    ds_write_b128 v9, v[28:31] offset:1024
    v_xor_b32 v10, 0x200, v10
    v_mfma_f32_16x16x32_bf16 v[112:115], a[20:23], v[40:43], v[112:115]
    buffer_load_dwordx4 v[208:211], v15, s[24:27], s51 offen offset:0 sc1
    v_xor_b32 v8, 0x200, v8
    v_mfma_f32_16x16x32_bf16 v[116:119], a[20:23], v[44:47], v[116:119]
    s_waitcnt lgkmcnt(4)
    ds_read_b64_tr_b16 v[62:63], v7 offset:7168
    v_xor_b32 v11, 0x200, v11
    v_mfma_f32_16x16x32_bf16 v[96:99], a[24:27], v[48:51], v[96:99]
    ds_read_b64_tr_b16 v[32:33], v6 offset:8192
    v_permlane32_swap_b32 v80, v84
    v_permlane32_swap_b32 v81, v85
    v_mfma_f32_16x16x32_bf16 v[100:103], a[24:27], v[52:55], v[100:103]
    ds_read_b64_tr_b16 v[34:35], v6 offset:9216
    v_permlane32_swap_b32 v82, v86
    v_mfma_f32_16x16x32_bf16 v[108:111], a[28:31], v[52:55], v[108:111]
    ds_read_b64_tr_b16 v[36:37], v7 offset:8192
    v_permlane32_swap_b32 v83, v87
    v_mul_f32 v128, v64, v64
    v_mul_f32 v129, v65, v65
    v_mfma_f32_16x16x32_bf16 v[104:107], a[28:31], v[48:51], v[104:107]
    buffer_load_dwordx4 v[212:215], v15, s[24:27], s51 offen offset:1024 sc1
    v_mul_f32 v130, v66, v66
    v_mul_f32 v131, v67, v67
    v_mfma_f32_16x16x32_bf16 v[112:115], a[32:35], v[48:51], v[112:115]
    ds_read_b64_tr_b16 v[38:39], v7 offset:9216
    v_mul_f32 v132, v68, v68
    v_mul_f32 v133, v69, v69
    v_mul_f32 v134, v70, v70
    v_mfma_f32_16x16x32_bf16 v[116:119], a[32:35], v[52:55], v[116:119]
    s_waitcnt lgkmcnt(4)
    v_mul_f32 v135, v71, v71
    v_mul_f32 v72, v64, v72
    v_mul_f32 v73, v65, v73
    v_mul_f32 v74, v66, v74
    v_mfma_f32_16x16x32_bf16 v[96:99], a[36:39], v[56:59], v[96:99]
    s_waitcnt vmcnt(6)
    s_barrier
    ds_read_b64_tr_b16 v[40:41], v6 offset:10240
    ds_read_b64_tr_b16 v[42:43], v6 offset:11264
    v_mfma_f32_16x16x32_bf16 v[100:103], a[36:39], v[60:63], v[100:103]
    ds_read_b64_tr_b16 v[44:45], v7 offset:10240
    v_mul_f32 v75, v67, v75
    v_mfma_f32_16x16x32_bf16 v[108:111], a[40:43], v[60:63], v[108:111]
    ds_read_b64_tr_b16 v[46:47], v7 offset:11264
    v_mul_f32 v76, v68, v76
    v_mfma_f32_16x16x32_bf16 v[104:107], a[40:43], v[56:59], v[104:107]
    ds_read_b128 v[16:19], v10 offset:1024
    v_mul_f32 v77, v69, v77
    v_mfma_f32_16x16x32_bf16 v[112:115], a[44:47], v[56:59], v[112:115]
    ds_read_b128 v[20:23], v8 offset:1024
    v_mul_f32 v78, v70, v78
    v_mfma_f32_16x16x32_bf16 v[116:119], a[44:47], v[60:63], v[116:119]
    s_waitcnt lgkmcnt(6)
    ds_read_b128 v[24:27], v11 offset:1024
    v_mul_f32 v79, v71, v79
    v_mfma_f32_16x16x32_bf16 v[96:99], a[48:51], v[32:35], v[96:99]
    ds_read_b64_tr_b16 v[48:49], v6 offset:12288
    s_waitcnt lgkmcnt(3)
    v_fma_f32 v128, v128, v17, v16
    v_fma_f32 v129, v129, v17, v16
    v_fma_f32 v130, v130, v17, v16
    v_mfma_f32_16x16x32_bf16 v[100:103], a[48:51], v[36:39], v[100:103]
    ds_read_b64_tr_b16 v[50:51], v6 offset:13312
    v_fma_f32 v131, v131, v17, v16
    s_waitcnt lgkmcnt(3)
    v_fma_f32 v132, v132, v21, v20
    v_mfma_f32_16x16x32_bf16 v[108:111], a[52:55], v[36:39], v[108:111]
    ds_read_b64_tr_b16 v[52:53], v7 offset:12288
    v_fma_f32 v133, v133, v21, v20
    v_fma_f32 v134, v134, v21, v20
    v_fma_f32 v135, v135, v21, v20
    v_mfma_f32_16x16x32_bf16 v[104:107], a[52:55], v[32:35], v[104:107]
    buffer_load_dwordx4 v[216:219], v15, s[24:27], s51 offen offset:2048 sc1
    v_mul_f32 v128, v128, v64
    v_mfma_f32_16x16x32_bf16 v[112:115], a[56:59], v[32:35], v[112:115]
    ds_read_b64_tr_b16 v[54:55], v7 offset:13312
    v_mul_f32 v129, v129, v65
    v_mul_f32 v130, v130, v66
    v_mul_f32 v131, v131, v67
    v_mfma_f32_16x16x32_bf16 v[116:119], a[56:59], v[36:39], v[116:119]
    v_mul_f32 v132, v132, v68
    v_mul_f32 v133, v133, v69
    v_mul_f32 v134, v134, v70
    v_mfma_f32_16x16x32_bf16 v[96:99], a[60:63], v[40:43], v[96:99]
    ds_read_b64_tr_b16 v[56:57], v6 offset:14336
    v_mul_f32 v135, v135, v71
    v_mfma_f32_16x16x32_bf16 v[100:103], a[60:63], v[44:47], v[100:103]
    ds_read_b64_tr_b16 v[58:59], v6 offset:15360
    v_exp_f32 v128, v128
    v_mfma_f32_16x16x32_bf16 v[108:111], a[64:67], v[44:47], v[108:111]
    ds_read_b64_tr_b16 v[60:61], v7 offset:14336
    v_exp_f32 v129, v129
    v_mfma_f32_16x16x32_bf16 v[104:107], a[64:67], v[40:43], v[104:107]
    buffer_load_dwordx4 v[220:223], v15, s[24:27], s51 offen offset:3072 sc1
    v_mfma_f32_16x16x32_bf16 v[112:115], a[68:71], v[40:43], v[112:115]
    s_add_u32 s51, s51, 4096
    ds_read_b64_tr_b16 v[62:63], v7 offset:15360
    v_exp_f32 v130, v130
    v_mfma_f32_16x16x32_bf16 v[116:119], a[68:71], v[44:47], v[116:119]
    s_waitcnt lgkmcnt(4)
    v_exp_f32 v131, v131
    v_mfma_f32_16x16x32_bf16 v[96:99], a[72:75], v[48:51], v[96:99]
    ds_read_b64_tr_b16 v[32:33], v6 offset:16384
    v_exp_f32 v132, v132
    v_mfma_f32_16x16x32_bf16 v[100:103], a[72:75], v[52:55], v[100:103]
    ds_read_b64_tr_b16 v[34:35], v6 offset:17408
    v_exp_f32 v133, v133
    v_mfma_f32_16x16x32_bf16 v[108:111], a[76:79], v[52:55], v[108:111]
    ds_read_b64_tr_b16 v[36:37], v7 offset:16384
    v_exp_f32 v134, v134
    v_mfma_f32_16x16x32_bf16 v[104:107], a[76:79], v[48:51], v[104:107]
    buffer_load_dwordx4 v[224:227], v15, s[24:27], s51 offen offset:0 sc1
    v_mfma_f32_16x16x32_bf16 v[112:115], a[80:83], v[48:51], v[112:115]
    ds_read_b64_tr_b16 v[38:39], v7 offset:17408
    v_exp_f32 v135, v135
    v_mfma_f32_16x16x32_bf16 v[116:119], a[80:83], v[52:55], v[116:119]
    s_waitcnt lgkmcnt(4)
    v_fma_f32 v128, v128, v18, v18
    v_fma_f32 v129, v129, v18, v18
    v_mfma_f32_16x16x32_bf16 v[96:99], a[84:87], v[56:59], v[96:99]
    ds_read_b64_tr_b16 v[40:41], v6 offset:18432
    v_fma_f32 v130, v130, v18, v18
    v_fma_f32 v131, v131, v18, v18
    v_fma_f32 v132, v132, v22, v22
    v_mfma_f32_16x16x32_bf16 v[100:103], a[84:87], v[60:63], v[100:103]
    ds_read_b64_tr_b16 v[42:43], v6 offset:19456
    v_fma_f32 v133, v133, v22, v22
    v_fma_f32 v134, v134, v22, v22
    v_mfma_f32_16x16x32_bf16 v[108:111], a[88:91], v[60:63], v[108:111]
    ds_read_b64_tr_b16 v[44:45], v7 offset:18432
    v_fma_f32 v135, v135, v22, v22
    v_rcp_f32 v128, v128
    v_mfma_f32_16x16x32_bf16 v[104:107], a[88:91], v[56:59], v[104:107]
    buffer_load_dwordx4 v[228:231], v15, s[24:27], s51 offen offset:1024 sc1
    v_rcp_f32 v129, v129
    v_mfma_f32_16x16x32_bf16 v[112:115], a[92:95], v[56:59], v[112:115]
    ds_read_b64_tr_b16 v[46:47], v7 offset:19456
    v_lshlrev_b32 v5, 7, v3
    v_lshl_add_u32 v5, v2, 28, v5
    v_mfma_f32_16x16x32_bf16 v[116:119], a[92:95], v[60:63], v[116:119]
    s_waitcnt lgkmcnt(4)
    v_min_u32 v0, 1, v2
    v_xor_b32 v0, 1, v0
    v_add_u32 v3, s74, v4
    v_mfma_f32_16x16x32_bf16 v[96:99], a[96:99], v[32:35], v[96:99]
    ds_read_b64_tr_b16 v[48:49], v6 offset:20480
    v_rcp_f32 v130, v130
    v_mfma_f32_16x16x32_bf16 v[100:103], a[96:99], v[36:39], v[100:103]
    ds_read_b64_tr_b16 v[50:51], v6 offset:21504
    v_rcp_f32 v131, v131
    v_mfma_f32_16x16x32_bf16 v[108:111], a[100:103], v[36:39], v[108:111]
    buffer_load_dword v9, v5, s[24:27], s62 offen sc1
    v_rcp_f32 v132, v132
    v_mfma_f32_16x16x32_bf16 v[104:107], a[100:103], v[32:35], v[104:107]
    ds_read_b64_tr_b16 v[52:53], v7 offset:20480
    v_rcp_f32 v133, v133
    v_mfma_f32_16x16x32_bf16 v[112:115], a[104:107], v[32:35], v[112:115]
    buffer_load_dwordx4 v[232:235], v15, s[24:27], s51 offen offset:2048 sc1
    v_mfma_f32_16x16x32_bf16 v[116:119], a[104:107], v[36:39], v[116:119]
    s_waitcnt lgkmcnt(3)
    ds_read_b64_tr_b16 v[54:55], v7 offset:21504
    v_rcp_f32 v134, v134
    v_mfma_f32_16x16x32_bf16 v[96:99], a[108:111], v[40:43], v[96:99]
    ds_read_b64_tr_b16 v[56:57], v6 offset:22528
    v_rcp_f32 v135, v135
    v_mfma_f32_16x16x32_bf16 v[100:103], a[108:111], v[44:47], v[100:103]
    ds_read_b64_tr_b16 v[58:59], v6 offset:23552
    v_mul_f32 v64, v72, v128
    v_mfma_f32_16x16x32_bf16 v[108:111], a[112:115], v[44:47], v[108:111]
    ds_read_b64_tr_b16 v[60:61], v7 offset:22528
    v_mul_f32 v65, v73, v129
    v_mul_f32 v66, v74, v130
    v_mfma_f32_16x16x32_bf16 v[104:107], a[112:115], v[40:43], v[104:107]
    buffer_load_dwordx4 v[236:239], v15, s[24:27], s51 offen offset:3072 sc1
    v_mfma_f32_16x16x32_bf16 v[112:115], a[116:119], v[40:43], v[112:115]
    s_add_u32 s51, s51, 4096
    ds_read_b64_tr_b16 v[62:63], v7 offset:23552
    v_mul_f32 v67, v75, v131
    v_mul_f32 v68, v76, v132
    v_mfma_f32_16x16x32_bf16 v[116:119], a[116:119], v[44:47], v[116:119]
    s_waitcnt lgkmcnt(4)
    v_mul_f32 v69, v77, v133
    v_mul_f32 v70, v78, v134
    v_mfma_f32_16x16x32_bf16 v[96:99], a[120:123], v[48:51], v[96:99]
    ds_read_b64_tr_b16 v[32:33], v6 offset:24576
    v_mul_f32 v71, v79, v135
    v_cvt_pk_bf16_f32 v136, v64, v65
    v_mfma_f32_16x16x32_bf16 v[100:103], a[120:123], v[52:55], v[100:103]
    ds_read_b64_tr_b16 v[34:35], v6 offset:25600
    v_cvt_pk_bf16_f32 v138, v68, v69
    v_mfma_f32_16x16x32_bf16 v[108:111], a[124:127], v[52:55], v[108:111]
    ds_read_b64_tr_b16 v[36:37], v7 offset:24576
    v_cvt_pk_bf16_f32 v137, v66, v67
    v_cvt_pk_bf16_f32 v139, v70, v71
    v_mfma_f32_16x16x32_bf16 v[104:107], a[124:127], v[48:51], v[104:107]
    buffer_load_dwordx4 v[240:243], v15, s[24:27], s51 offen offset:0 sc1
    v_mfma_f32_16x16x32_bf16 v[112:115], a[128:131], v[48:51], v[112:115]
    ds_read_b64_tr_b16 v[38:39], v7 offset:25600
    v_mul_f32 v128, v80, v80
    v_mul_f32 v129, v81, v81
    v_mfma_f32_16x16x32_bf16 v[116:119], a[128:131], v[52:55], v[116:119]
    s_waitcnt lgkmcnt(4)
    v_permlane16_swap_b32 v136, v138
    v_mfma_f32_16x16x32_bf16 v[96:99], a[132:135], v[56:59], v[96:99]
    ds_read_b64_tr_b16 v[40:41], v6 offset:26624
    v_permlane16_swap_b32 v137, v139
    v_mfma_f32_16x16x32_bf16 v[100:103], a[132:135], v[60:63], v[100:103]
    buffer_store_dwordx4 v[136:139], v12, s[32:35], s57 offen sc1
    v_mul_f32 v130, v82, v82
    v_mfma_f32_16x16x32_bf16 v[108:111], a[136:139], v[60:63], v[108:111]
    ds_read_b64_tr_b16 v[42:43], v6 offset:27648
    v_mul_f32 v131, v83, v83
    v_mul_f32 v84, v80, v84
    v_mfma_f32_16x16x32_bf16 v[104:107], a[136:139], v[56:59], v[104:107]
    ds_read_b64_tr_b16 v[44:45], v7 offset:26624
    v_mul_f32 v85, v81, v85
    v_mfma_f32_16x16x32_bf16 v[112:115], a[140:143], v[56:59], v[112:115]
    buffer_load_dwordx4 v[244:247], v15, s[24:27], s51 offen offset:1024 sc1
    v_mul_f32 v86, v82, v86
    v_mfma_f32_16x16x32_bf16 v[116:119], a[140:143], v[60:63], v[116:119]
    s_waitcnt lgkmcnt(3)
    ds_read_b64_tr_b16 v[46:47], v7 offset:27648
    v_mul_f32 v87, v83, v87
    v_fma_f32 v128, v128, v25, v24
    v_mfma_f32_16x16x32_bf16 v[96:99], a[144:147], v[32:35], v[96:99]
    ds_read_b64_tr_b16 v[48:49], v6 offset:28672
    v_fma_f32 v129, v129, v25, v24
    v_fma_f32 v130, v130, v25, v24
    v_mfma_f32_16x16x32_bf16 v[100:103], a[144:147], v[36:39], v[100:103]
    ds_read_b64_tr_b16 v[50:51], v6 offset:29696
    v_fma_f32 v131, v131, v25, v24
    v_mul_f32 v128, v128, v80
    v_mfma_f32_16x16x32_bf16 v[108:111], a[148:151], v[36:39], v[108:111]
    ds_read_b64_tr_b16 v[52:53], v7 offset:28672
    v_mul_f32 v129, v129, v81
    v_mul_f32 v130, v130, v82
    v_mfma_f32_16x16x32_bf16 v[104:107], a[148:151], v[32:35], v[104:107]
    buffer_load_dwordx4 v[248:251], v15, s[24:27], s51 offen offset:2048 sc1
    v_mfma_f32_16x16x32_bf16 v[112:115], a[152:155], v[32:35], v[112:115]
    ds_read_b64_tr_b16 v[54:55], v7 offset:29696
    v_mul_f32 v131, v131, v83
    v_exp_f32 v128, v128
    v_mfma_f32_16x16x32_bf16 v[116:119], a[152:155], v[36:39], v[116:119]
    s_waitcnt lgkmcnt(4)
    v_exp_f32 v129, v129
    v_mfma_f32_16x16x32_bf16 v[96:99], a[156:159], v[40:43], v[96:99]
    ds_read_b64_tr_b16 v[56:57], v6 offset:30720
    v_exp_f32 v130, v130
    v_mfma_f32_16x16x32_bf16 v[100:103], a[156:159], v[44:47], v[100:103]
    ds_read_b64_tr_b16 v[58:59], v6 offset:31744
    v_mfma_f32_16x16x32_bf16 v[108:111], a[160:163], v[44:47], v[108:111]
    ds_read_b64_tr_b16 v[60:61], v7 offset:30720
    v_exp_f32 v131, v131
    v_mfma_f32_16x16x32_bf16 v[104:107], a[160:163], v[40:43], v[104:107]
    buffer_load_dwordx4 v[252:255], v15, s[24:27], s51 offen offset:3072 sc1
    v_mfma_f32_16x16x32_bf16 v[112:115], a[164:167], v[40:43], v[112:115]
    s_add_u32 s51, s51, 4096
    ds_read_b64_tr_b16 v[62:63], v7 offset:31744
    v_fma_f32 v128, v128, v26, v26
    v_fma_f32 v129, v129, v26, v26
    v_mfma_f32_16x16x32_bf16 v[116:119], a[164:167], v[44:47], v[116:119]
    s_waitcnt lgkmcnt(4)
    v_fma_f32 v130, v130, v26, v26
    v_fma_f32 v131, v131, v26, v26
    v_mfma_f32_16x16x32_bf16 v[96:99], a[168:171], v[48:51], v[96:99]
    v_rcp_f32 v128, v128
    v_mfma_f32_16x16x32_bf16 v[100:103], a[168:171], v[52:55], v[100:103]
    v_rcp_f32 v129, v129
    v_mfma_f32_16x16x32_bf16 v[108:111], a[172:175], v[52:55], v[108:111]
    v_rcp_f32 v130, v130
    v_mfma_f32_16x16x32_bf16 v[104:107], a[172:175], v[48:51], v[104:107]
    v_mfma_f32_16x16x32_bf16 v[112:115], a[176:179], v[48:51], v[112:115]
    v_rcp_f32 v131, v131
    v_mfma_f32_16x16x32_bf16 v[116:119], a[176:179], v[52:55], v[116:119]
    s_waitcnt lgkmcnt(0)
    v_mul_f32 v80, v84, v128
    v_mul_f32 v81, v85, v129
    v_mfma_f32_16x16x32_bf16 v[96:99], a[180:183], v[56:59], v[96:99]
    v_mul_f32 v82, v86, v130
    v_mul_f32 v83, v87, v131
    v_mfma_f32_16x16x32_bf16 v[100:103], a[180:183], v[60:63], v[100:103]
    v_cvt_pk_bf16_f32 v140, v80, v81
    v_cvt_pk_bf16_f32 v141, v82, v83
    v_mfma_f32_16x16x32_bf16 v[108:111], a[184:187], v[60:63], v[108:111]
    v_xor_b32 v10, 0x200, v10
    v_xor_b32 v8, 0x200, v8
    v_xor_b32 v11, 0x200, v11
    v_mfma_f32_16x16x32_bf16 v[104:107], a[184:187], v[56:59], v[104:107]
    ds_read_b128 v[16:19], v10 offset:1024
    v_mfma_f32_16x16x32_bf16 v[112:115], a[188:191], v[56:59], v[112:115]
    ds_read_b128 v[20:23], v8 offset:1024
    v_mfma_f32_16x16x32_bf16 v[116:119], a[188:191], v[60:63], v[116:119]
    ds_read_b128 v[24:27], v11 offset:1024
    s_waitcnt vmcnt(7)
    v_cmp_ne_u32 vcc, v0, v9
    s_nop 0
    s_cmp_eq_u64 vcc, 0
    s_cselect_b32 s38, s34, 0
    s_nop 1
    v_permlane32_swap_b32 v112, v116
    v_permlane32_swap_b32 v113, v117
    v_permlane32_swap_b32 v114, v118
    v_permlane32_swap_b32 v115, v119
    v_pk_mul_f32 v[128:129], v[96:97], v[96:97]
    v_pk_mul_f32 v[130:131], v[98:99], v[98:99]
    v_pk_mul_f32 v[132:133], v[100:101], v[100:101]
    v_pk_mul_f32 v[134:135], v[102:103], v[102:103]
    s_waitcnt lgkmcnt(2)
    v_pk_fma_f32 v[128:129], v[128:129], v[16:17], v[16:17] op_sel:[0,1,0] op_sel_hi:[1,1,0]
    v_pk_fma_f32 v[130:131], v[130:131], v[16:17], v[16:17] op_sel:[0,1,0] op_sel_hi:[1,1,0]
    s_waitcnt lgkmcnt(1)
    v_pk_fma_f32 v[132:133], v[132:133], v[20:21], v[20:21] op_sel:[0,1,0] op_sel_hi:[1,1,0]
    v_pk_fma_f32 v[134:135], v[134:135], v[20:21], v[20:21] op_sel:[0,1,0] op_sel_hi:[1,1,0]
    v_pk_mul_f32 v[128:129], v[128:129], v[96:97]
    v_pk_mul_f32 v[130:131], v[130:131], v[98:99]
    v_pk_mul_f32 v[132:133], v[132:133], v[100:101]
    v_pk_mul_f32 v[134:135], v[134:135], v[102:103]
    v_exp_f32 v128, v128
    v_exp_f32 v129, v129
    v_exp_f32 v130, v130
    v_exp_f32 v131, v131
    v_exp_f32 v132, v132
    v_exp_f32 v133, v133
    v_exp_f32 v134, v134
    v_exp_f32 v135, v135
    v_pk_mul_f32 v[96:97], v[96:97], v[104:105]
    v_pk_mul_f32 v[98:99], v[98:99], v[106:107]
    v_pk_mul_f32 v[100:101], v[100:101], v[108:109]
    v_pk_mul_f32 v[102:103], v[102:103], v[110:111]
    v_pk_fma_f32 v[128:129], v[128:129], v[18:19], v[18:19] op_sel_hi:[1,0,0]
    v_pk_fma_f32 v[130:131], v[130:131], v[18:19], v[18:19] op_sel_hi:[1,0,0]
    v_pk_fma_f32 v[132:133], v[132:133], v[22:23], v[22:23] op_sel_hi:[1,0,0]
    v_pk_fma_f32 v[134:135], v[134:135], v[22:23], v[22:23] op_sel_hi:[1,0,0]
    v_rcp_f32 v128, v128
    v_rcp_f32 v129, v129
    v_rcp_f32 v130, v130
    v_rcp_f32 v131, v131
    v_rcp_f32 v132, v132
    v_rcp_f32 v133, v133
    v_rcp_f32 v134, v134
    v_rcp_f32 v135, v135
    v_pk_mul_f32 v[96:97], v[96:97], v[128:129]
    v_pk_mul_f32 v[98:99], v[98:99], v[130:131]
    v_pk_mul_f32 v[100:101], v[100:101], v[132:133]
    v_pk_mul_f32 v[102:103], v[102:103], v[134:135]
    v_cvt_pk_bf16_f32 v136, v96, v97
    v_cvt_pk_bf16_f32 v138, v100, v101
    v_cvt_pk_bf16_f32 v137, v98, v99
    v_cvt_pk_bf16_f32 v139, v102, v103
    v_pk_mul_f32 v[128:129], v[112:113], v[112:113]
    v_pk_mul_f32 v[130:131], v[114:115], v[114:115]
    v_permlane16_swap_b32 v136, v138
    v_permlane16_swap_b32 v137, v139
    buffer_store_dwordx4 v[136:139], v12, s[32:35], s58 offen sc1
    s_waitcnt lgkmcnt(0)
    v_pk_fma_f32 v[128:129], v[128:129], v[24:25], v[24:25] op_sel:[0,1,0] op_sel_hi:[1,1,0]
    v_pk_fma_f32 v[130:131], v[130:131], v[24:25], v[24:25] op_sel:[0,1,0] op_sel_hi:[1,1,0]
    v_pk_mul_f32 v[128:129], v[128:129], v[112:113]
    v_pk_mul_f32 v[130:131], v[130:131], v[114:115]
    v_exp_f32 v128, v128
    v_exp_f32 v129, v129
    v_exp_f32 v130, v130
    v_exp_f32 v131, v131
    v_pk_mul_f32 v[112:113], v[112:113], v[116:117]
    v_pk_mul_f32 v[114:115], v[114:115], v[118:119]
    v_pk_fma_f32 v[128:129], v[128:129], v[26:27], v[26:27] op_sel_hi:[1,0,0]
    v_pk_fma_f32 v[130:131], v[130:131], v[26:27], v[26:27] op_sel_hi:[1,0,0]
    v_rcp_f32 v128, v128
    v_rcp_f32 v129, v129
    v_rcp_f32 v130, v130
    v_rcp_f32 v131, v131
    v_pk_mul_f32 v[112:113], v[112:113], v[128:129]
    v_pk_mul_f32 v[114:115], v[114:115], v[130:131]
    v_cvt_pk_bf16_f32 v142, v112, v113
    v_cvt_pk_bf16_f32 v143, v114, v115
    s_nop 0
    v_permlane16_swap_b32 v140, v142
    v_permlane16_swap_b32 v141, v143
    buffer_store_dwordx4 v[140:143], v13, s[32:35], s58 offen sc1
L_join3:
    s_nop 3
    s_barrier
    buffer_load_dwordx4 a[0:3], v3, s[36:39], s75 offen offset:0 sc1
    s_add_u32 s75, s75, 262144
    buffer_load_dwordx4 a[4:7], v3, s[36:39], s75 offen offset:0 sc1
    s_add_u32 s75, s75, 262144
    buffer_load_dwordx4 a[8:11], v3, s[36:39], s75 offen offset:0 sc1
    s_add_u32 s75, s75, 262144
    buffer_load_dwordx4 a[12:15], v3, s[36:39], s75 offen offset:0 sc1
    s_add_u32 s75, s75, 262144
    buffer_load_dwordx4 a[16:19], v3, s[36:39], s75 offen offset:0 sc1
    s_add_u32 s75, s75, 262144
    buffer_load_dwordx4 a[20:23], v3, s[36:39], s75 offen offset:0 sc1
    s_add_u32 s75, s75, 262144
    buffer_load_dwordx4 a[24:27], v3, s[36:39], s75 offen offset:0 sc1
    s_add_u32 s75, s75, 262144
    buffer_load_dwordx4 a[28:31], v3, s[36:39], s75 offen offset:0 sc1
    s_add_u32 s75, s75, 262144
    s_mov_b32 s28, s18
    s_and_b32 s29, s19, 0xffff
    s_mov_b32 s30, 2097152
    s_lshr_b32 s65, s2, 5
    v_lshrrev_b32 v16, 3, v1
    v_bfe_u32 v17, v1, 1, 2
    s_lshl_b32 s46, s65, 2
    v_add_u32 v17, s46, v17
    v_sub_u32 v18, 31, v17
    v_min_u32 v18, v17, v18
    v_lshlrev_b32 v18, 17, v18
    v_lshrrev_b32 v17, 4, v17
    v_lshl_add_u32 v18, v17, 16, v18
    v_lshl_add_u32 v18, v16, 4, v18
    v_and_b32 v17, 1, v1
    v_lshl_add_u32 v8, v17, 15, v18
    s_lshl_b32 s66, s73, 9
    s_lshl_b32 s46, s40, 7
    s_add_u32 s66, s66, s46
    s_add_u32 s66, s66, 19480576
    v_mov_b32 v20, 0
    v_mov_b32 v21, 1
    s_add_u32 s41, s41, 0x8000
    s_lshr_b32 s46, s73, 2
    s_lshl_b32 s46, s46, 17
    s_and_b32 s44, s73, 3
    s_lshl_b32 s44, s44, 2
    s_add_u32 s44, s44, s40
    s_lshl_b32 s44, s44, 10
    s_add_u32 s67, s46, s44
    s_lshl_b32 s45, s65, 7
    s_add_u32 s67, s67, s45
    s_add_u32 s68, s67, 0x2000
    v_and_b32 v9, 7, v1
    v_lshlrev_b32 v9, 4, v9
    v_and_b32 v18, 3, v16
    v_lshl_add_u32 v9, v18, 15, v9
    v_lshrrev_b32 v18, 2, v16
    v_lshl_add_u32 v9, v18, 14, v9
    v_lshrrev_b32 v18, 5, v1
    v_lshl_add_u32 v10, v18, 6, v4
    s_mul_i32 s44, s40, 9472
    v_add_u32 v10, s44, v10
    v_bfe_u32 v18, v1, 2, 1
    v_mul_u32_u24 v11, 4736, v18
    v_bfe_u32 v18, v1, 1, 1
    v_mul_u32_u24 v18, 576, v18
    v_add_u32 v11, v11, v18
    v_lshl_add_u32 v11, v16, 4, v11
    v_lshl_add_u32 v11, v17, 3, v11
    s_lshl_b32 s44, s40, 7
    v_add_u32 v11, s44, v11
    v_add_u32 v12, 37888, v11
    s_waitcnt vmcnt(8)
    s_barrier
    s_cmp_lg_u32 s40, 0
    s_cbranch_scc1 L_ow16
    s_mov_b64 exec, 1
    buffer_store_dword v21, v20, s[24:27], s41 offen sc1
    s_mov_b64 exec, -1
L_ow16:
    s_cmp_lg_u32 s38, 0
    s_cbranch_scc1 L_sd17
    s_mov_b32 s46, 0
L_sp17:
    buffer_load_dword v6, v5, s[24:27], s62 offen sc1
    s_add_u32 s46, s46, 1
    s_waitcnt vmcnt(0)
    v_cmp_ne_u32 vcc, v0, v6
    s_cmp_gt_u32 s46, 400000
    s_cbranch_scc1 L_sg17
    s_cbranch_vccnz L_sp17
L_sg17:
    s_mov_b32 s75, 0
    buffer_load_dwordx4 a[0:3], v3, s[32:35], s75 offen offset:0 sc1
    s_add_u32 s75, s75, 262144
    buffer_load_dwordx4 a[4:7], v3, s[32:35], s75 offen offset:0 sc1
    s_add_u32 s75, s75, 262144
    buffer_load_dwordx4 a[8:11], v3, s[32:35], s75 offen offset:0 sc1
    s_add_u32 s75, s75, 262144
    buffer_load_dwordx4 a[12:15], v3, s[32:35], s75 offen offset:0 sc1
    s_add_u32 s75, s75, 262144
    buffer_load_dwordx4 a[16:19], v3, s[32:35], s75 offen offset:0 sc1
    s_add_u32 s75, s75, 262144
    buffer_load_dwordx4 a[20:23], v3, s[32:35], s75 offen offset:0 sc1
    s_add_u32 s75, s75, 262144
    buffer_load_dwordx4 a[24:27], v3, s[32:35], s75 offen offset:0 sc1
    s_add_u32 s75, s75, 262144
    buffer_load_dwordx4 a[28:31], v3, s[32:35], s75 offen offset:0 sc1
    s_add_u32 s75, s75, 262144
L_sd17:
    s_waitcnt vmcnt(7)
    v_mfma_f32_32x32x16_bf16 v[64:79], a[192:195], a[0:3], 0
    buffer_load_dwordx4 a[32:35], v3, s[32:35], s75 offen offset:0 sc1
    s_add_u32 s75, s75, 262144
    v_mfma_f32_32x32x16_bf16 v[80:95], a[196:199], a[0:3], 0
    s_waitcnt vmcnt(7)
    v_mfma_f32_32x32x16_bf16 v[64:79], a[200:203], a[4:7], v[64:79]
    buffer_load_dwordx4 a[36:39], v3, s[32:35], s75 offen offset:0 sc1
    s_add_u32 s75, s75, 262144
    v_mfma_f32_32x32x16_bf16 v[80:95], a[204:207], a[4:7], v[80:95]
    s_waitcnt vmcnt(7)
    v_mfma_f32_32x32x16_bf16 v[64:79], a[208:211], a[8:11], v[64:79]
    buffer_load_dwordx4 a[40:43], v3, s[32:35], s75 offen offset:0 sc1
    s_add_u32 s75, s75, 262144
    v_mfma_f32_32x32x16_bf16 v[80:95], a[212:215], a[8:11], v[80:95]
    s_waitcnt vmcnt(7)
    v_mfma_f32_32x32x16_bf16 v[64:79], a[216:219], a[12:15], v[64:79]
    buffer_load_dwordx4 a[44:47], v3, s[32:35], s75 offen offset:0 sc1
    s_add_u32 s75, s75, 262144
    v_mfma_f32_32x32x16_bf16 v[80:95], a[220:223], a[12:15], v[80:95]
    s_waitcnt vmcnt(7)
    v_mfma_f32_32x32x16_bf16 v[64:79], a[224:227], a[16:19], v[64:79]
    buffer_load_dwordx4 a[48:51], v3, s[32:35], s75 offen offset:0 sc1
    s_add_u32 s75, s75, 262144
    v_mfma_f32_32x32x16_bf16 v[80:95], a[228:231], a[16:19], v[80:95]
    s_waitcnt vmcnt(7)
    v_mfma_f32_32x32x16_bf16 v[64:79], a[232:235], a[20:23], v[64:79]
    buffer_load_dwordx4 a[52:55], v3, s[32:35], s75 offen offset:0 sc1
    s_add_u32 s75, s75, 262144
    v_mfma_f32_32x32x16_bf16 v[80:95], a[236:239], a[20:23], v[80:95]
    s_waitcnt vmcnt(7)
    v_mfma_f32_32x32x16_bf16 v[64:79], a[240:243], a[24:27], v[64:79]
    buffer_load_dwordx4 a[56:59], v3, s[32:35], s75 offen offset:0 sc1
    s_add_u32 s75, s75, 262144
    v_mfma_f32_32x32x16_bf16 v[80:95], a[244:247], a[24:27], v[80:95]
    s_waitcnt vmcnt(7)
    v_mfma_f32_32x32x16_bf16 v[64:79], a[248:251], a[28:31], v[64:79]
    buffer_load_dwordx4 a[60:63], v3, s[32:35], s75 offen offset:0 sc1
    s_add_u32 s75, s75, 262144
    v_mfma_f32_32x32x16_bf16 v[80:95], a[252:255], a[28:31], v[80:95]
    s_waitcnt vmcnt(7)
    v_mfma_f32_32x32x16_bf16 v[64:79], v[144:147], a[32:35], v[64:79]
    buffer_load_dwordx4 a[64:67], v3, s[32:35], s75 offen offset:0 sc1
    s_add_u32 s75, s75, 262144
    v_mfma_f32_32x32x16_bf16 v[80:95], v[148:151], a[32:35], v[80:95]
    s_waitcnt vmcnt(7)
    v_mfma_f32_32x32x16_bf16 v[64:79], v[152:155], a[36:39], v[64:79]
    buffer_load_dwordx4 a[68:71], v3, s[32:35], s75 offen offset:0 sc1
    s_add_u32 s75, s75, 262144
    v_mfma_f32_32x32x16_bf16 v[80:95], v[156:159], a[36:39], v[80:95]
    buffer_load_dword v6, v5, s[24:27], s63 offen sc1
    s_waitcnt vmcnt(8)
    v_mfma_f32_32x32x16_bf16 v[64:79], v[160:163], a[40:43], v[64:79]
    buffer_load_dwordx4 a[72:75], v3, s[32:35], s75 offen offset:0 sc1
    s_add_u32 s75, s75, 262144
    v_mfma_f32_32x32x16_bf16 v[80:95], v[164:167], a[40:43], v[80:95]
    s_waitcnt vmcnt(8)
    v_mfma_f32_32x32x16_bf16 v[64:79], v[168:171], a[44:47], v[64:79]
    buffer_load_dwordx4 a[76:79], v3, s[32:35], s75 offen offset:0 sc1
    s_add_u32 s75, s75, 262144
    v_mfma_f32_32x32x16_bf16 v[80:95], v[172:175], a[44:47], v[80:95]
    s_waitcnt vmcnt(8)
    v_mfma_f32_32x32x16_bf16 v[64:79], v[176:179], a[48:51], v[64:79]
    buffer_load_dwordx4 a[80:83], v3, s[32:35], s75 offen offset:0 sc1
    s_add_u32 s75, s75, 262144
    v_mfma_f32_32x32x16_bf16 v[80:95], v[180:183], a[48:51], v[80:95]
    s_waitcnt vmcnt(8)
    v_mfma_f32_32x32x16_bf16 v[64:79], v[184:187], a[52:55], v[64:79]
    buffer_load_dwordx4 a[84:87], v3, s[32:35], s75 offen offset:0 sc1
    s_mov_b32 s75, 0
    v_mfma_f32_32x32x16_bf16 v[80:95], v[188:191], a[52:55], v[80:95]
    s_waitcnt vmcnt(8)
    v_mfma_f32_32x32x16_bf16 v[64:79], v[192:195], a[56:59], v[64:79]
    buffer_load_dwordx4 v[32:35], v8, s[24:27], s66 offen offset:0 sc1
    v_mfma_f32_32x32x16_bf16 v[80:95], v[196:199], a[56:59], v[80:95]
    s_waitcnt vmcnt(8)
    v_mfma_f32_32x32x16_bf16 v[64:79], v[200:203], a[60:63], v[64:79]
    v_mfma_f32_32x32x16_bf16 v[80:95], v[204:207], a[60:63], v[80:95]
    s_waitcnt vmcnt(7)
    v_mfma_f32_32x32x16_bf16 v[64:79], v[208:211], a[64:67], v[64:79]
    s_waitcnt vmcnt(5)
    v_cmp_ne_u32 vcc, v0, v6
    s_nop 0
    s_cmp_eq_u64 vcc, 0
    s_cselect_b32 s38, s34, 0
    v_mfma_f32_32x32x16_bf16 v[80:95], v[212:215], a[64:67], v[80:95]
    buffer_load_dwordx4 a[88:91], v3, s[36:39], s75 offen offset:2048 sc1
    s_add_u32 s75, s75, 262144
    v_mfma_f32_32x32x16_bf16 v[64:79], v[216:219], a[68:71], v[64:79]
    buffer_load_dword v7, v5, s[24:27], s63 offen sc1
    v_mfma_f32_32x32x16_bf16 v[80:95], v[220:223], a[68:71], v[80:95]
    buffer_load_dwordx4 a[92:95], v3, s[36:39], s75 offen offset:2048 sc1
    s_add_u32 s75, s75, 262144
    s_waitcnt vmcnt(7)
    v_mfma_f32_32x32x16_bf16 v[64:79], v[224:227], a[72:75], v[64:79]
    v_mfma_f32_32x32x16_bf16 v[80:95], v[228:231], a[72:75], v[80:95]
    buffer_load_dwordx4 a[96:99], v3, s[36:39], s75 offen offset:2048 sc1
    s_add_u32 s75, s75, 262144
    s_waitcnt vmcnt(7)
    v_mfma_f32_32x32x16_bf16 v[64:79], v[232:235], a[76:79], v[64:79]
    v_mfma_f32_32x32x16_bf16 v[80:95], v[236:239], a[76:79], v[80:95]
    buffer_load_dwordx4 a[100:103], v3, s[36:39], s75 offen offset:2048 sc1
    s_add_u32 s75, s75, 262144
    s_waitcnt vmcnt(7)
    v_mfma_f32_32x32x16_bf16 v[64:79], v[240:243], a[80:83], v[64:79]
    v_mfma_f32_32x32x16_bf16 v[80:95], v[244:247], a[80:83], v[80:95]
    buffer_load_dwordx4 a[104:107], v3, s[36:39], s75 offen offset:2048 sc1
    s_add_u32 s75, s75, 262144
    s_waitcnt vmcnt(7)
    v_mfma_f32_32x32x16_bf16 v[64:79], v[248:251], a[84:87], v[64:79]
    v_mfma_f32_32x32x16_bf16 v[80:95], v[252:255], a[84:87], v[80:95]
    buffer_load_dwordx4 a[108:111], v3, s[36:39], s75 offen offset:2048 sc1
    s_add_u32 s75, s75, 262144
    s_nop 8
    ds_write_b128 v10, v[64:67] offset:0
    buffer_load_dwordx4 a[112:115], v3, s[36:39], s75 offen offset:2048 sc1
    s_add_u32 s75, s75, 262144
    ds_write_b128 v10, v[68:71] offset:1152
    buffer_load_dwordx4 a[116:119], v3, s[36:39], s75 offen offset:2048 sc1
    s_add_u32 s75, s75, 262144
    ds_write_b128 v10, v[72:75] offset:2304
    buffer_load_dwordx4 a[120:123], v3, s[36:39], s75 offen offset:2048 sc1
    s_add_u32 s75, s75, 262144
    ds_write_b128 v10, v[76:79] offset:3456
    buffer_load_dwordx4 a[124:127], v3, s[36:39], s75 offen offset:2048 sc1
    s_add_u32 s75, s75, 262144
    ds_write_b128 v10, v[80:83] offset:4736
    buffer_load_dwordx4 a[128:131], v3, s[36:39], s75 offen offset:2048 sc1
    s_add_u32 s75, s75, 262144
    ds_write_b128 v10, v[84:87] offset:5888
    ds_write_b128 v10, v[88:91] offset:7040
    ds_write_b128 v10, v[92:95] offset:8192
    s_waitcnt vmcnt(12)
    v_lshlrev_b32 v128, 16, v32
    v_and_b32 v130, 0xffff0000, v32
    v_lshlrev_b32 v132, 16, v33
    v_and_b32 v134, 0xffff0000, v33
    v_lshlrev_b32 v129, 16, v34
    v_and_b32 v131, 0xffff0000, v34
    v_lshlrev_b32 v133, 16, v35
    v_and_b32 v135, 0xffff0000, v35
    s_cmp_lg_u32 s38, 0
    s_cbranch_scc1 L_sd18
    s_mov_b32 s46, 0
    s_waitcnt vmcnt(10)
    v_cmp_ne_u32 vcc, v0, v7
    s_nop 0
    s_cbranch_vccz L_sg18
L_sp18:
    buffer_load_dword v6, v5, s[24:27], s63 offen sc1
    s_add_u32 s46, s46, 1
    s_waitcnt vmcnt(0)
    v_cmp_ne_u32 vcc, v0, v6
    s_cmp_gt_u32 s46, 400000
    s_cbranch_scc1 L_sg18
    s_cbranch_vccnz L_sp18
L_sg18:
    s_mov_b32 s75, 0
    buffer_load_dwordx4 a[88:91], v3, s[32:35], s75 offen offset:2048 sc1
    s_add_u32 s75, s75, 262144
    buffer_load_dwordx4 a[92:95], v3, s[32:35], s75 offen offset:2048 sc1
    s_add_u32 s75, s75, 262144
    buffer_load_dwordx4 a[96:99], v3, s[32:35], s75 offen offset:2048 sc1
    s_add_u32 s75, s75, 262144
    buffer_load_dwordx4 a[100:103], v3, s[32:35], s75 offen offset:2048 sc1
    s_add_u32 s75, s75, 262144
    buffer_load_dwordx4 a[104:107], v3, s[32:35], s75 offen offset:2048 sc1
    s_add_u32 s75, s75, 262144
    buffer_load_dwordx4 a[108:111], v3, s[32:35], s75 offen offset:2048 sc1
    s_add_u32 s75, s75, 262144
    buffer_load_dwordx4 a[112:115], v3, s[32:35], s75 offen offset:2048 sc1
    s_add_u32 s75, s75, 262144
    buffer_load_dwordx4 a[116:119], v3, s[32:35], s75 offen offset:2048 sc1
    s_add_u32 s75, s75, 262144
    buffer_load_dwordx4 a[120:123], v3, s[32:35], s75 offen offset:2048 sc1
    s_add_u32 s75, s75, 262144
    buffer_load_dwordx4 a[124:127], v3, s[32:35], s75 offen offset:2048 sc1
    s_add_u32 s75, s75, 262144
    buffer_load_dwordx4 a[128:131], v3, s[32:35], s75 offen offset:2048 sc1
    s_add_u32 s75, s75, 262144
L_sd18:
    s_waitcnt vmcnt(10)
    v_mfma_f32_32x32x16_bf16 v[96:111], a[192:195], a[88:91], 0
    buffer_load_dwordx4 a[132:135], v3, s[32:35], s75 offen offset:2048 sc1
    s_add_u32 s75, s75, 262144
    v_mfma_f32_32x32x16_bf16 v[112:127], a[196:199], a[88:91], 0
    s_waitcnt vmcnt(10)
    v_mfma_f32_32x32x16_bf16 v[96:111], a[200:203], a[92:95], v[96:111]
    buffer_load_dwordx4 a[136:139], v3, s[32:35], s75 offen offset:2048 sc1
    s_add_u32 s75, s75, 262144
    v_mfma_f32_32x32x16_bf16 v[112:127], a[204:207], a[92:95], v[112:127]
    s_waitcnt lgkmcnt(0)
    s_barrier
    s_waitcnt vmcnt(10)
    v_mfma_f32_32x32x16_bf16 v[96:111], a[208:211], a[96:99], v[96:111]
    buffer_load_dwordx4 a[140:143], v3, s[32:35], s75 offen offset:2048 sc1
    s_add_u32 s75, s75, 262144
    ds_read_b64 v[40:41], v11 offset:0
    ds_read_b64 v[42:43], v11 offset:1152
    v_mfma_f32_32x32x16_bf16 v[112:127], a[212:215], a[96:99], v[112:127]
    ds_read_b64 v[44:45], v11 offset:2304
    ds_read_b64 v[46:47], v11 offset:3456
    ds_read_b64 v[48:49], v11 offset:9472
    ds_read_b64 v[50:51], v11 offset:10624
    s_waitcnt vmcnt(10)
    v_mfma_f32_32x32x16_bf16 v[96:111], a[216:219], a[100:103], v[96:111]
    buffer_load_dwordx4 a[144:147], v3, s[32:35], s75 offen offset:2048 sc1
    s_add_u32 s75, s75, 262144
    ds_read_b64 v[52:53], v11 offset:11776
    ds_read_b64 v[54:55], v11 offset:12928
    v_mfma_f32_32x32x16_bf16 v[112:127], a[220:223], a[100:103], v[112:127]
    ds_read_b64 v[56:57], v11 offset:18944
    ds_read_b64 v[58:59], v11 offset:20096
    ds_read_b64 v[60:61], v11 offset:21248
    ds_read_b64 v[62:63], v11 offset:22400
    s_waitcnt vmcnt(10)
    v_mfma_f32_32x32x16_bf16 v[96:111], a[224:227], a[104:107], v[96:111]
    buffer_load_dwordx4 a[148:151], v3, s[32:35], s75 offen offset:2048 sc1
    s_add_u32 s75, s75, 262144
    ds_read_b64 v[136:137], v11 offset:28416
    ds_read_b64 v[138:139], v11 offset:29568
    v_mfma_f32_32x32x16_bf16 v[112:127], a[228:231], a[104:107], v[112:127]
    ds_read_b64 v[140:141], v11 offset:30720
    ds_read_b64 v[142:143], v11 offset:31872
    s_waitcnt lgkmcnt(15)
    v_add_f32 v128, v128, v40
    v_add_f32 v129, v129, v41
    s_waitcnt vmcnt(10)
    v_mfma_f32_32x32x16_bf16 v[96:111], a[232:235], a[108:111], v[96:111]
    buffer_load_dwordx4 a[152:155], v3, s[32:35], s75 offen offset:2048 sc1
    s_add_u32 s75, s75, 262144
    s_waitcnt lgkmcnt(14)
    v_add_f32 v130, v130, v42
    v_add_f32 v131, v131, v43
    v_mfma_f32_32x32x16_bf16 v[112:127], a[236:239], a[108:111], v[112:127]
    s_waitcnt lgkmcnt(13)
    v_add_f32 v132, v132, v44
    v_add_f32 v133, v133, v45
    s_waitcnt lgkmcnt(12)
    v_add_f32 v134, v134, v46
    v_add_f32 v135, v135, v47
    s_waitcnt vmcnt(10)
    v_mfma_f32_32x32x16_bf16 v[96:111], a[240:243], a[112:115], v[96:111]
    buffer_load_dwordx4 a[156:159], v3, s[32:35], s75 offen offset:2048 sc1
    s_add_u32 s75, s75, 262144
    s_waitcnt lgkmcnt(11)
    v_add_f32 v128, v128, v48
    v_add_f32 v129, v129, v49
    v_mfma_f32_32x32x16_bf16 v[112:127], a[244:247], a[112:115], v[112:127]
    s_waitcnt lgkmcnt(10)
    v_add_f32 v130, v130, v50
    v_add_f32 v131, v131, v51
    s_waitcnt lgkmcnt(9)
    v_add_f32 v132, v132, v52
    v_add_f32 v133, v133, v53
    s_waitcnt vmcnt(10)
    v_mfma_f32_32x32x16_bf16 v[96:111], a[248:251], a[116:119], v[96:111]
    buffer_load_dwordx4 a[160:163], v3, s[32:35], s75 offen offset:2048 sc1
    s_add_u32 s75, s75, 262144
    s_waitcnt lgkmcnt(8)
    v_add_f32 v134, v134, v54
    v_add_f32 v135, v135, v55
    v_mfma_f32_32x32x16_bf16 v[112:127], a[252:255], a[116:119], v[112:127]
    s_waitcnt lgkmcnt(7)
    v_add_f32 v128, v128, v56
    v_add_f32 v129, v129, v57
    s_waitcnt lgkmcnt(6)
    v_add_f32 v130, v130, v58
    v_add_f32 v131, v131, v59
    s_waitcnt vmcnt(10)
    v_mfma_f32_32x32x16_bf16 v[96:111], v[144:147], a[120:123], v[96:111]
    buffer_load_dwordx4 a[164:167], v3, s[32:35], s75 offen offset:2048 sc1
    s_add_u32 s75, s75, 262144
    s_waitcnt lgkmcnt(5)
    v_add_f32 v132, v132, v60
    v_add_f32 v133, v133, v61
    v_mfma_f32_32x32x16_bf16 v[112:127], v[148:151], a[120:123], v[112:127]
    s_waitcnt lgkmcnt(4)
    v_add_f32 v134, v134, v62
    v_add_f32 v135, v135, v63
    s_waitcnt lgkmcnt(3)
    v_add_f32 v128, v128, v136
    v_add_f32 v129, v129, v137
    s_waitcnt vmcnt(10)
    v_mfma_f32_32x32x16_bf16 v[96:111], v[152:155], a[124:127], v[96:111]
    buffer_load_dwordx4 a[168:171], v3, s[32:35], s75 offen offset:2048 sc1
    s_add_u32 s75, s75, 262144
    s_waitcnt lgkmcnt(2)
    v_add_f32 v130, v130, v138
    v_add_f32 v131, v131, v139
    v_mfma_f32_32x32x16_bf16 v[112:127], v[156:159], a[124:127], v[112:127]
    s_waitcnt lgkmcnt(1)
    v_add_f32 v132, v132, v140
    v_add_f32 v133, v133, v141
    s_waitcnt lgkmcnt(0)
    v_add_f32 v134, v134, v142
    v_add_f32 v135, v135, v143
    s_waitcnt vmcnt(10)
    v_mfma_f32_32x32x16_bf16 v[96:111], v[160:163], a[128:131], v[96:111]
    buffer_load_dwordx4 a[172:175], v3, s[32:35], s75 offen offset:2048 sc1
    s_mov_b32 s75, 0
    v_cvt_pk_bf16_f32 v32, v128, v130
    v_cvt_pk_bf16_f32 v33, v132, v134
    v_mfma_f32_32x32x16_bf16 v[112:127], v[164:167], a[128:131], v[112:127]
    v_cvt_pk_bf16_f32 v34, v129, v131
    v_cvt_pk_bf16_f32 v35, v133, v135
    buffer_store_dwordx4 v[32:35], v9, s[28:31], s67 offen sc1
    s_waitcnt vmcnt(11)
    v_mfma_f32_32x32x16_bf16 v[96:111], v[168:171], a[132:135], v[96:111]
    buffer_load_dwordx4 v[36:39], v8, s[24:27], s66 offen offset:1024 sc1
    v_mfma_f32_32x32x16_bf16 v[112:127], v[172:175], a[132:135], v[112:127]
    s_waitcnt vmcnt(11)
    v_mfma_f32_32x32x16_bf16 v[96:111], v[176:179], a[136:139], v[96:111]
    v_mfma_f32_32x32x16_bf16 v[112:127], v[180:183], a[136:139], v[112:127]
    s_waitcnt vmcnt(10)
    v_mfma_f32_32x32x16_bf16 v[96:111], v[184:187], a[140:143], v[96:111]
    v_mfma_f32_32x32x16_bf16 v[112:127], v[188:191], a[140:143], v[112:127]
    s_waitcnt vmcnt(9)
    v_mfma_f32_32x32x16_bf16 v[96:111], v[192:195], a[144:147], v[96:111]
    v_mfma_f32_32x32x16_bf16 v[112:127], v[196:199], a[144:147], v[112:127]
    s_waitcnt vmcnt(8)
    v_mfma_f32_32x32x16_bf16 v[96:111], v[200:203], a[148:151], v[96:111]
    v_mfma_f32_32x32x16_bf16 v[112:127], v[204:207], a[148:151], v[112:127]
    s_waitcnt vmcnt(7)
    v_mfma_f32_32x32x16_bf16 v[96:111], v[208:211], a[152:155], v[96:111]
    v_mfma_f32_32x32x16_bf16 v[112:127], v[212:215], a[152:155], v[112:127]
    s_waitcnt vmcnt(6)
    v_mfma_f32_32x32x16_bf16 v[96:111], v[216:219], a[156:159], v[96:111]
    v_mfma_f32_32x32x16_bf16 v[112:127], v[220:223], a[156:159], v[112:127]
    s_waitcnt vmcnt(5)
    v_mfma_f32_32x32x16_bf16 v[96:111], v[224:227], a[160:163], v[96:111]
    v_mfma_f32_32x32x16_bf16 v[112:127], v[228:231], a[160:163], v[112:127]
    s_waitcnt vmcnt(4)
    v_mfma_f32_32x32x16_bf16 v[96:111], v[232:235], a[164:167], v[96:111]
    v_mfma_f32_32x32x16_bf16 v[112:127], v[236:239], a[164:167], v[112:127]
    s_waitcnt vmcnt(3)
    v_mfma_f32_32x32x16_bf16 v[96:111], v[240:243], a[168:171], v[96:111]
    v_mfma_f32_32x32x16_bf16 v[112:127], v[244:247], a[168:171], v[112:127]
    s_waitcnt vmcnt(2)
    v_mfma_f32_32x32x16_bf16 v[96:111], v[248:251], a[172:175], v[96:111]
    v_mfma_f32_32x32x16_bf16 v[112:127], v[252:255], a[172:175], v[112:127]
    s_nop 10
    ds_write_b128 v10, v[96:99] offset:37888
    ds_write_b128 v10, v[100:103] offset:39040
    ds_write_b128 v10, v[104:107] offset:40192
    ds_write_b128 v10, v[108:111] offset:41344
    ds_write_b128 v10, v[112:115] offset:42624
    ds_write_b128 v10, v[116:119] offset:43776
    ds_write_b128 v10, v[120:123] offset:44928
    ds_write_b128 v10, v[124:127] offset:46080
    s_waitcnt vmcnt(0)
    v_lshlrev_b32 v128, 16, v36
    v_and_b32 v130, 0xffff0000, v36
    v_lshlrev_b32 v132, 16, v37
    v_and_b32 v134, 0xffff0000, v37
    v_lshlrev_b32 v129, 16, v38
    v_and_b32 v131, 0xffff0000, v38
    v_lshlrev_b32 v133, 16, v39
    v_and_b32 v135, 0xffff0000, v39
    s_waitcnt lgkmcnt(0)
    s_barrier
    ds_read_b64 v[40:41], v12 offset:0
    ds_read_b64 v[42:43], v12 offset:1152
    ds_read_b64 v[44:45], v12 offset:2304
    ds_read_b64 v[46:47], v12 offset:3456
    ds_read_b64 v[48:49], v12 offset:9472
    ds_read_b64 v[50:51], v12 offset:10624
    ds_read_b64 v[52:53], v12 offset:11776
    ds_read_b64 v[54:55], v12 offset:12928
    ds_read_b64 v[56:57], v12 offset:18944
    ds_read_b64 v[58:59], v12 offset:20096
    ds_read_b64 v[60:61], v12 offset:21248
    ds_read_b64 v[62:63], v12 offset:22400
    ds_read_b64 v[136:137], v12 offset:28416
    ds_read_b64 v[138:139], v12 offset:29568
    ds_read_b64 v[140:141], v12 offset:30720
    ds_read_b64 v[142:143], v12 offset:31872
    s_waitcnt lgkmcnt(15)
    v_pk_add_f32 v[128:129], v[128:129], v[40:41]
    s_waitcnt lgkmcnt(14)
    v_pk_add_f32 v[130:131], v[130:131], v[42:43]
    s_waitcnt lgkmcnt(13)
    v_pk_add_f32 v[132:133], v[132:133], v[44:45]
    s_waitcnt lgkmcnt(12)
    v_pk_add_f32 v[134:135], v[134:135], v[46:47]
    s_waitcnt lgkmcnt(11)
    v_pk_add_f32 v[128:129], v[128:129], v[48:49]
    s_waitcnt lgkmcnt(10)
    v_pk_add_f32 v[130:131], v[130:131], v[50:51]
    s_waitcnt lgkmcnt(9)
    v_pk_add_f32 v[132:133], v[132:133], v[52:53]
    s_waitcnt lgkmcnt(8)
    v_pk_add_f32 v[134:135], v[134:135], v[54:55]
    s_waitcnt lgkmcnt(7)
    v_pk_add_f32 v[128:129], v[128:129], v[56:57]
    s_waitcnt lgkmcnt(6)
    v_pk_add_f32 v[130:131], v[130:131], v[58:59]
    s_waitcnt lgkmcnt(5)
    v_pk_add_f32 v[132:133], v[132:133], v[60:61]
    s_waitcnt lgkmcnt(4)
    v_pk_add_f32 v[134:135], v[134:135], v[62:63]
    s_waitcnt lgkmcnt(3)
    v_pk_add_f32 v[128:129], v[128:129], v[136:137]
    s_waitcnt lgkmcnt(2)
    v_pk_add_f32 v[130:131], v[130:131], v[138:139]
    s_waitcnt lgkmcnt(1)
    v_pk_add_f32 v[132:133], v[132:133], v[140:141]
    s_waitcnt lgkmcnt(0)
    v_pk_add_f32 v[134:135], v[134:135], v[142:143]
    v_cvt_pk_bf16_f32 v36, v128, v130
    v_cvt_pk_bf16_f32 v37, v132, v134
    v_cvt_pk_bf16_f32 v38, v129, v131
    v_cvt_pk_bf16_f32 v39, v133, v135
    buffer_store_dwordx4 v[36:39], v9, s[28:31], s68 offen sc1
L_end:
    s_endpgm
L_p3h:
    v_bfe_u32 v16, v1, 2, 1
    v_lshlrev_b32 v16, 9, v16
    v_bfe_u32 v17, v1, 3, 1
    v_lshl_add_u32 v16, v17, 4, v16
    v_and_b32 v17, 3, v1
    v_lshl_add_u32 v16, v17, 2, v16
    buffer_load_dword v24, v16, s[24:27], s61 offen offset:160 sc1
    buffer_load_dword v25, v16, s[24:27], s61 offen offset:128 sc1
    buffer_load_dword v26, v16, s[24:27], s61 offen offset:32 sc1
    buffer_load_dword v27, v16, s[24:27], s61 offen offset:0 sc1
    buffer_load_dword v28, v16, s[24:27], s61 offen offset:416 sc1
    buffer_load_dword v29, v16, s[24:27], s61 offen offset:384 sc1
    buffer_load_dword v30, v16, s[24:27], s61 offen offset:288 sc1
    buffer_load_dword v31, v16, s[24:27], s61 offen offset:256 sc1
    s_barrier
    buffer_load_dwordx4 v5, s[24:27], m0 offen offset:0 sc1 lds
    buffer_load_dwordx4 v5, s[24:27], m0 offen offset:1024 sc1 lds
    buffer_load_dwordx4 v5, s[24:27], m0 offen offset:2048 sc1 lds
    buffer_load_dwordx4 v5, s[24:27], m0 offen offset:3072 sc1 lds
    s_add_u32 m0, m0, 8192
    s_nop 0
    buffer_load_dwordx4 v5, s[24:27], m0 offen offset:0 sc1 lds
    buffer_load_dwordx4 v5, s[24:27], m0 offen offset:1024 sc1 lds
    buffer_load_dwordx4 v5, s[24:27], m0 offen offset:2048 sc1 lds
    buffer_load_dwordx4 v5, s[24:27], m0 offen offset:3072 sc1 lds
    s_add_u32 m0, m0, 8192
    s_nop 0
    buffer_load_dwordx4 v5, s[24:27], m0 offen offset:0 sc1 lds
    buffer_load_dwordx4 v5, s[24:27], m0 offen offset:1024 sc1 lds
    buffer_load_dwordx4 v5, s[24:27], m0 offen offset:2048 sc1 lds
    buffer_load_dwordx4 v5, s[24:27], m0 offen offset:3072 sc1 lds
    s_add_u32 m0, m0, 8192
    v_and_b32 v13, 0x1f0, v4
    v_xor_b32 v13, 0x100, v13
    v_lshrrev_b32 v14, 5, v1
    v_lshl_add_u32 v13, v14, 15, v13
    v_xor_b32 v14, 0x8000, v13
    s_and_b32 s44, s2, 7
    s_lshl_b32 s44, s44, 2
    s_bfe_u32 s46, s2, 0x20003
    s_add_u32 s44, s44, s46
    s_lshr_b32 s45, s2, 5
    s_mov_b32 s51, 0
    s_lshl_b32 s45, s45, 2
    s_add_u32 s45, s45, s40
    s_mul_i32 s45, s45, 45056
    s_add_u32 s45, s45, 11419648
    v_add_u32 v15, s45, v4
    s_lshr_b32 s46, s44, 1
    s_lshl_b32 s45, s46, 11
    s_add_u32 s62, s45, 65536
    s_add_u32 s63, s62, 0x8000
    s_lshl_b32 s46, s46, 2
    s_and_b32 s44, s44, 1
    s_add_u32 s73, s46, s44
    s_lshl_b32 s46, s73, 10
    s_mul_i32 s47, s40, 65536
    s_add_u32 s46, s46, s47
    s_add_u32 s74, s46, 12992512
    s_mov_b32 s75, 0
    s_waitcnt vmcnt(8)
    s_barrier
    ds_read_b64_tr_b16 v[32:33], v6 offset:0
    ds_read_b64_tr_b16 v[34:35], v6 offset:1024
    ds_read_b64_tr_b16 v[36:37], v7 offset:0
    ds_read_b64_tr_b16 v[38:39], v7 offset:1024
    ds_read_b64_tr_b16 v[40:41], v6 offset:2048
    ds_read_b64_tr_b16 v[42:43], v6 offset:3072
    ds_read_b64_tr_b16 v[44:45], v7 offset:2048
    ds_read_b64_tr_b16 v[46:47], v7 offset:3072
    s_waitcnt lgkmcnt(4)
    v_mfma_f32_16x16x32_bf16 v[140:143], v[32:35], v[32:35], 0
    ds_read_b64_tr_b16 v[48:49], v6 offset:4096
    v_mfma_f32_16x16x32_bf16 v[64:67], a[0:3], v[32:35], 0
    ds_read_b64_tr_b16 v[50:51], v6 offset:5120
    v_mfma_f32_16x16x32_bf16 v[68:71], a[0:3], v[36:39], 0
    buffer_load_dwordx4 v5, s[24:27], m0 offen offset:0 sc1 lds
    v_mfma_f32_16x16x32_bf16 v[76:79], a[4:7], v[36:39], 0
    ds_read_b64_tr_b16 v[52:53], v7 offset:4096
    v_mfma_f32_16x16x32_bf16 v[72:75], a[4:7], v[32:35], 0
    buffer_load_dwordx4 v5, s[24:27], m0 offen offset:1024 sc1 lds
    v_mfma_f32_16x16x32_bf16 v[80:83], a[8:11], v[32:35], 0
    ds_read_b64_tr_b16 v[54:55], v7 offset:5120
    v_mfma_f32_16x16x32_bf16 v[84:87], a[8:11], v[36:39], 0
    s_waitcnt lgkmcnt(4)
    v_mfma_f32_16x16x32_bf16 v[140:143], v[40:43], v[40:43], v[140:143]
    ds_read_b64_tr_b16 v[56:57], v6 offset:6144
    v_mfma_f32_16x16x32_bf16 v[64:67], a[12:15], v[40:43], v[64:67]
    ds_read_b64_tr_b16 v[58:59], v6 offset:7168
    v_mfma_f32_16x16x32_bf16 v[68:71], a[12:15], v[44:47], v[68:71]
    buffer_load_dwordx4 v5, s[24:27], m0 offen offset:2048 sc1 lds
    v_mfma_f32_16x16x32_bf16 v[76:79], a[16:19], v[44:47], v[76:79]
    ds_read_b64_tr_b16 v[60:61], v7 offset:6144
    v_mfma_f32_16x16x32_bf16 v[72:75], a[16:19], v[40:43], v[72:75]
    buffer_load_dwordx4 v5, s[24:27], m0 offen offset:3072 sc1 lds
    v_mfma_f32_16x16x32_bf16 v[88:91], a[20:23], v[40:43], 0
    s_add_u32 m0, m0, 40960
    ds_read_b64_tr_b16 v[62:63], v7 offset:7168
    v_mfma_f32_16x16x32_bf16 v[92:95], a[20:23], v[44:47], 0
    s_waitcnt lgkmcnt(4)
    v_mfma_f32_16x16x32_bf16 v[140:143], v[48:51], v[48:51], v[140:143]
    s_waitcnt vmcnt(8)
    s_barrier
    ds_read_b64_tr_b16 v[32:33], v6 offset:8192
    v_mfma_f32_16x16x32_bf16 v[64:67], a[24:27], v[48:51], v[64:67]
    ds_read_b64_tr_b16 v[34:35], v6 offset:9216
    v_mfma_f32_16x16x32_bf16 v[68:71], a[24:27], v[52:55], v[68:71]
    ds_read_b64_tr_b16 v[36:37], v7 offset:8192
    v_mfma_f32_16x16x32_bf16 v[76:79], a[28:31], v[52:55], v[76:79]
    buffer_load_dwordx4 v5, s[24:27], m0 offen offset:0 sc1 lds
    v_mfma_f32_16x16x32_bf16 v[72:75], a[28:31], v[48:51], v[72:75]
    ds_read_b64_tr_b16 v[38:39], v7 offset:9216
    v_mfma_f32_16x16x32_bf16 v[80:83], a[32:35], v[48:51], v[80:83]
    v_mfma_f32_16x16x32_bf16 v[84:87], a[32:35], v[52:55], v[84:87]
    s_waitcnt lgkmcnt(4)
    v_mfma_f32_16x16x32_bf16 v[140:143], v[56:59], v[56:59], v[140:143]
    ds_read_b64_tr_b16 v[40:41], v6 offset:10240
    v_mfma_f32_16x16x32_bf16 v[64:67], a[36:39], v[56:59], v[64:67]
    ds_read_b64_tr_b16 v[42:43], v6 offset:11264
    v_mfma_f32_16x16x32_bf16 v[68:71], a[36:39], v[60:63], v[68:71]
    buffer_load_dwordx4 v5, s[24:27], m0 offen offset:1024 sc1 lds
    v_mfma_f32_16x16x32_bf16 v[76:79], a[40:43], v[60:63], v[76:79]
    ds_read_b64_tr_b16 v[44:45], v7 offset:10240
    v_mfma_f32_16x16x32_bf16 v[72:75], a[40:43], v[56:59], v[72:75]
    buffer_load_dwordx4 v5, s[24:27], m0 offen offset:2048 sc1 lds
    v_mfma_f32_16x16x32_bf16 v[88:91], a[44:47], v[56:59], v[88:91]
    ds_read_b64_tr_b16 v[46:47], v7 offset:11264
    v_mfma_f32_16x16x32_bf16 v[92:95], a[44:47], v[60:63], v[92:95]
    s_waitcnt lgkmcnt(4)
    v_mfma_f32_16x16x32_bf16 v[140:143], v[32:35], v[32:35], v[140:143]
    ds_read_b64_tr_b16 v[48:49], v6 offset:12288
    v_mfma_f32_16x16x32_bf16 v[64:67], a[48:51], v[32:35], v[64:67]
    ds_read_b64_tr_b16 v[50:51], v6 offset:13312
    v_mfma_f32_16x16x32_bf16 v[68:71], a[48:51], v[36:39], v[68:71]
    ds_read_b64_tr_b16 v[52:53], v7 offset:12288
    v_mfma_f32_16x16x32_bf16 v[76:79], a[52:55], v[36:39], v[76:79]
    buffer_load_dwordx4 v5, s[24:27], m0 offen offset:3072 sc1 lds
    v_mfma_f32_16x16x32_bf16 v[72:75], a[52:55], v[32:35], v[72:75]
    s_add_u32 m0, m0, 8192
    ds_read_b64_tr_b16 v[54:55], v7 offset:13312
    v_mfma_f32_16x16x32_bf16 v[80:83], a[56:59], v[32:35], v[80:83]
    v_mfma_f32_16x16x32_bf16 v[84:87], a[56:59], v[36:39], v[84:87]
    s_waitcnt lgkmcnt(4)
    v_mfma_f32_16x16x32_bf16 v[140:143], v[40:43], v[40:43], v[140:143]
    ds_read_b64_tr_b16 v[56:57], v6 offset:14336
    v_mfma_f32_16x16x32_bf16 v[64:67], a[60:63], v[40:43], v[64:67]
    ds_read_b64_tr_b16 v[58:59], v6 offset:15360
    v_mfma_f32_16x16x32_bf16 v[68:71], a[60:63], v[44:47], v[68:71]
    buffer_load_dwordx4 v5, s[24:27], m0 offen offset:0 sc1 lds
    v_mfma_f32_16x16x32_bf16 v[76:79], a[64:67], v[44:47], v[76:79]
    ds_read_b64_tr_b16 v[60:61], v7 offset:14336
    v_mfma_f32_16x16x32_bf16 v[72:75], a[64:67], v[40:43], v[72:75]
    buffer_load_dwordx4 v5, s[24:27], m0 offen offset:1024 sc1 lds
    v_mfma_f32_16x16x32_bf16 v[88:91], a[68:71], v[40:43], v[88:91]
    ds_read_b64_tr_b16 v[62:63], v7 offset:15360
    v_mfma_f32_16x16x32_bf16 v[92:95], a[68:71], v[44:47], v[92:95]
    s_waitcnt lgkmcnt(4)
    v_mfma_f32_16x16x32_bf16 v[140:143], v[48:51], v[48:51], v[140:143]
    s_waitcnt vmcnt(10)
    s_barrier
    ds_read_b64_tr_b16 v[32:33], v6 offset:16384
    v_mfma_f32_16x16x32_bf16 v[64:67], a[72:75], v[48:51], v[64:67]
    ds_read_b64_tr_b16 v[34:35], v6 offset:17408
    v_mfma_f32_16x16x32_bf16 v[68:71], a[72:75], v[52:55], v[68:71]
    ds_read_b64_tr_b16 v[36:37], v7 offset:16384
    v_mfma_f32_16x16x32_bf16 v[76:79], a[76:79], v[52:55], v[76:79]
    buffer_load_dwordx4 v5, s[24:27], m0 offen offset:2048 sc1 lds
    v_mfma_f32_16x16x32_bf16 v[72:75], a[76:79], v[48:51], v[72:75]
    ds_read_b64_tr_b16 v[38:39], v7 offset:17408
    v_mfma_f32_16x16x32_bf16 v[80:83], a[80:83], v[48:51], v[80:83]
    v_mfma_f32_16x16x32_bf16 v[84:87], a[80:83], v[52:55], v[84:87]
    s_waitcnt lgkmcnt(4)
    v_mfma_f32_16x16x32_bf16 v[140:143], v[56:59], v[56:59], v[140:143]
    ds_read_b64_tr_b16 v[40:41], v6 offset:18432
    v_mfma_f32_16x16x32_bf16 v[64:67], a[84:87], v[56:59], v[64:67]
    ds_read_b64_tr_b16 v[42:43], v6 offset:19456
    v_mfma_f32_16x16x32_bf16 v[68:71], a[84:87], v[60:63], v[68:71]
    buffer_load_dwordx4 v5, s[24:27], m0 offen offset:3072 sc1 lds
    v_mfma_f32_16x16x32_bf16 v[76:79], a[88:91], v[60:63], v[76:79]
    s_add_u32 m0, m0, 8192
    ds_read_b64_tr_b16 v[44:45], v7 offset:18432
    v_mfma_f32_16x16x32_bf16 v[72:75], a[88:91], v[56:59], v[72:75]
    buffer_load_dwordx4 v5, s[24:27], m0 offen offset:0 sc1 lds
    v_mfma_f32_16x16x32_bf16 v[88:91], a[92:95], v[56:59], v[88:91]
    ds_read_b64_tr_b16 v[46:47], v7 offset:19456
    v_mfma_f32_16x16x32_bf16 v[92:95], a[92:95], v[60:63], v[92:95]
    s_waitcnt lgkmcnt(4)
    v_mfma_f32_16x16x32_bf16 v[140:143], v[32:35], v[32:35], v[140:143]
    ds_read_b64_tr_b16 v[48:49], v6 offset:20480
    v_mfma_f32_16x16x32_bf16 v[64:67], a[96:99], v[32:35], v[64:67]
    ds_read_b64_tr_b16 v[50:51], v6 offset:21504
    v_mfma_f32_16x16x32_bf16 v[68:71], a[96:99], v[36:39], v[68:71]
    ds_read_b64_tr_b16 v[52:53], v7 offset:20480
    v_mfma_f32_16x16x32_bf16 v[76:79], a[100:103], v[36:39], v[76:79]
    buffer_load_dwordx4 v5, s[24:27], m0 offen offset:1024 sc1 lds
    v_mfma_f32_16x16x32_bf16 v[72:75], a[100:103], v[32:35], v[72:75]
    ds_read_b64_tr_b16 v[54:55], v7 offset:21504
    v_mfma_f32_16x16x32_bf16 v[80:83], a[104:107], v[32:35], v[80:83]
    v_mfma_f32_16x16x32_bf16 v[84:87], a[104:107], v[36:39], v[84:87]
    s_waitcnt lgkmcnt(4)
    v_mfma_f32_16x16x32_bf16 v[140:143], v[40:43], v[40:43], v[140:143]
    ds_read_b64_tr_b16 v[56:57], v6 offset:22528
    v_mfma_f32_16x16x32_bf16 v[64:67], a[108:111], v[40:43], v[64:67]
    ds_read_b64_tr_b16 v[58:59], v6 offset:23552
    v_mfma_f32_16x16x32_bf16 v[68:71], a[108:111], v[44:47], v[68:71]
    buffer_load_dwordx4 v5, s[24:27], m0 offen offset:2048 sc1 lds
    v_mfma_f32_16x16x32_bf16 v[76:79], a[112:115], v[44:47], v[76:79]
    ds_read_b64_tr_b16 v[60:61], v7 offset:22528
    v_mfma_f32_16x16x32_bf16 v[72:75], a[112:115], v[40:43], v[72:75]
    buffer_load_dwordx4 v5, s[24:27], m0 offen offset:3072 sc1 lds
    v_mfma_f32_16x16x32_bf16 v[88:91], a[116:119], v[40:43], v[88:91]
    s_add_u32 m0, m0, 8192
    ds_read_b64_tr_b16 v[62:63], v7 offset:23552
    v_mfma_f32_16x16x32_bf16 v[92:95], a[116:119], v[44:47], v[92:95]
    s_waitcnt lgkmcnt(4)
    v_mfma_f32_16x16x32_bf16 v[140:143], v[48:51], v[48:51], v[140:143]
    s_waitcnt vmcnt(12)
    s_barrier
    ds_read_b64_tr_b16 v[32:33], v6 offset:24576
    v_mfma_f32_16x16x32_bf16 v[64:67], a[120:123], v[48:51], v[64:67]
    ds_read_b64_tr_b16 v[34:35], v6 offset:25600
    v_mfma_f32_16x16x32_bf16 v[68:71], a[120:123], v[52:55], v[68:71]
    ds_read_b64_tr_b16 v[36:37], v7 offset:24576
    v_mfma_f32_16x16x32_bf16 v[76:79], a[124:127], v[52:55], v[76:79]
    buffer_load_dwordx4 v5, s[24:27], m0 offen offset:0 sc1 lds
    v_mfma_f32_16x16x32_bf16 v[72:75], a[124:127], v[48:51], v[72:75]
    ds_read_b64_tr_b16 v[38:39], v7 offset:25600
    v_mfma_f32_16x16x32_bf16 v[80:83], a[128:131], v[48:51], v[80:83]
    v_mfma_f32_16x16x32_bf16 v[84:87], a[128:131], v[52:55], v[84:87]
    s_waitcnt lgkmcnt(4)
    v_mfma_f32_16x16x32_bf16 v[140:143], v[56:59], v[56:59], v[140:143]
    ds_read_b64_tr_b16 v[40:41], v6 offset:26624
    v_mfma_f32_16x16x32_bf16 v[64:67], a[132:135], v[56:59], v[64:67]
    ds_read_b64_tr_b16 v[42:43], v6 offset:27648
    v_mfma_f32_16x16x32_bf16 v[68:71], a[132:135], v[60:63], v[68:71]
    buffer_load_dwordx4 v5, s[24:27], m0 offen offset:1024 sc1 lds
    v_mfma_f32_16x16x32_bf16 v[76:79], a[136:139], v[60:63], v[76:79]
    ds_read_b64_tr_b16 v[44:45], v7 offset:26624
    v_mfma_f32_16x16x32_bf16 v[72:75], a[136:139], v[56:59], v[72:75]
    buffer_load_dwordx4 v5, s[24:27], m0 offen offset:2048 sc1 lds
    v_mfma_f32_16x16x32_bf16 v[88:91], a[140:143], v[56:59], v[88:91]
    ds_read_b64_tr_b16 v[46:47], v7 offset:27648
    v_mfma_f32_16x16x32_bf16 v[92:95], a[140:143], v[60:63], v[92:95]
    s_waitcnt lgkmcnt(4)
    v_mfma_f32_16x16x32_bf16 v[140:143], v[32:35], v[32:35], v[140:143]
    ds_read_b64_tr_b16 v[48:49], v6 offset:28672
    v_mfma_f32_16x16x32_bf16 v[64:67], a[144:147], v[32:35], v[64:67]
    ds_read_b64_tr_b16 v[50:51], v6 offset:29696
    v_mfma_f32_16x16x32_bf16 v[68:71], a[144:147], v[36:39], v[68:71]
    ds_read_b64_tr_b16 v[52:53], v7 offset:28672
    v_mfma_f32_16x16x32_bf16 v[76:79], a[148:151], v[36:39], v[76:79]
    buffer_load_dwordx4 v5, s[24:27], m0 offen offset:3072 sc1 lds
    v_mfma_f32_16x16x32_bf16 v[72:75], a[148:151], v[32:35], v[72:75]
    ds_read_b64_tr_b16 v[54:55], v7 offset:29696
    v_mfma_f32_16x16x32_bf16 v[80:83], a[152:155], v[32:35], v[80:83]
    v_mfma_f32_16x16x32_bf16 v[84:87], a[152:155], v[36:39], v[84:87]
    s_waitcnt lgkmcnt(4)
    v_mfma_f32_16x16x32_bf16 v[140:143], v[40:43], v[40:43], v[140:143]
    ds_read_b64_tr_b16 v[56:57], v6 offset:30720
    v_mfma_f32_16x16x32_bf16 v[64:67], a[156:159], v[40:43], v[64:67]
    ds_read_b64_tr_b16 v[58:59], v6 offset:31744
    v_mfma_f32_16x16x32_bf16 v[68:71], a[156:159], v[44:47], v[68:71]
    ds_read_b64_tr_b16 v[60:61], v7 offset:30720
    v_mfma_f32_16x16x32_bf16 v[76:79], a[160:163], v[44:47], v[76:79]
    buffer_load_dwordx4 a[192:195], v15, s[24:27], s51 offen offset:0 sc1
    v_mfma_f32_16x16x32_bf16 v[72:75], a[160:163], v[40:43], v[72:75]
    ds_read_b64_tr_b16 v[62:63], v7 offset:31744
    v_mfma_f32_16x16x32_bf16 v[88:91], a[164:167], v[40:43], v[88:91]
    v_mfma_f32_16x16x32_bf16 v[92:95], a[164:167], v[44:47], v[92:95]
    s_waitcnt lgkmcnt(4)
    v_xor_b32 v6, 0x8000, v6
    v_xor_b32 v7, 0x8000, v7
    v_mfma_f32_16x16x32_bf16 v[140:143], v[48:51], v[48:51], v[140:143]
    ds_read_b64_tr_b16 v[32:33], v6 offset:0
    v_mfma_f32_16x16x32_bf16 v[64:67], a[168:171], v[48:51], v[64:67]
    ds_read_b64_tr_b16 v[34:35], v6 offset:1024
    v_mfma_f32_16x16x32_bf16 v[68:71], a[168:171], v[52:55], v[68:71]
    ds_read_b64_tr_b16 v[36:37], v7 offset:0
    v_mfma_f32_16x16x32_bf16 v[76:79], a[172:175], v[52:55], v[76:79]
    buffer_load_dwordx4 a[196:199], v15, s[24:27], s51 offen offset:1024 sc1
    v_mfma_f32_16x16x32_bf16 v[72:75], a[172:175], v[48:51], v[72:75]
    ds_read_b64_tr_b16 v[38:39], v7 offset:1024
    v_mfma_f32_16x16x32_bf16 v[80:83], a[176:179], v[48:51], v[80:83]
    v_mfma_f32_16x16x32_bf16 v[84:87], a[176:179], v[52:55], v[84:87]
    s_waitcnt lgkmcnt(4)
    v_mfma_f32_16x16x32_bf16 v[140:143], v[56:59], v[56:59], v[140:143]
    ds_read_b64_tr_b16 v[40:41], v6 offset:2048
    v_mfma_f32_16x16x32_bf16 v[64:67], a[180:183], v[56:59], v[64:67]
    ds_read_b64_tr_b16 v[42:43], v6 offset:3072
    v_mfma_f32_16x16x32_bf16 v[68:71], a[180:183], v[60:63], v[68:71]
    ds_read_b64_tr_b16 v[44:45], v7 offset:2048
    v_mfma_f32_16x16x32_bf16 v[76:79], a[184:187], v[60:63], v[76:79]
    buffer_load_dwordx4 a[200:203], v15, s[24:27], s51 offen offset:2048 sc1
    v_mfma_f32_16x16x32_bf16 v[72:75], a[184:187], v[56:59], v[72:75]
    ds_read_b64_tr_b16 v[46:47], v7 offset:3072
    v_mfma_f32_16x16x32_bf16 v[88:91], a[188:191], v[56:59], v[88:91]
    v_mfma_f32_16x16x32_bf16 v[92:95], a[188:191], v[60:63], v[92:95]
    s_waitcnt lgkmcnt(4)
    v_mfma_f32_16x16x32_bf16 v[96:99], a[0:3], v[32:35], 0
    ds_read_b64_tr_b16 v[48:49], v6 offset:4096
    v_cndmask_b32 v140, v140, v141, s[64:65]
    v_mfma_f32_16x16x32_bf16 v[100:103], a[0:3], v[36:39], 0
    ds_read_b64_tr_b16 v[50:51], v6 offset:5120
    v_cndmask_b32 v140, v140, v142, s[66:67]
    v_mfma_f32_16x16x32_bf16 v[108:111], a[4:7], v[36:39], 0
    ds_read_b64_tr_b16 v[52:53], v7 offset:4096
    v_cndmask_b32 v140, v140, v143, s[68:69]
    v_mov_b32 v142, 0x3b27c5ac
    v_mfma_f32_16x16x32_bf16 v[104:107], a[4:7], v[32:35], 0
    buffer_load_dwordx4 a[204:207], v15, s[24:27], s51 offen offset:3072 sc1
    v_mfma_f32_16x16x32_bf16 v[112:115], a[8:11], v[32:35], 0
    s_add_u32 s51, s51, 4096
    ds_read_b64_tr_b16 v[54:55], v7 offset:5120
    v_fmac_f32 v142, 0.5, v140
    v_mfma_f32_16x16x32_bf16 v[116:119], a[8:11], v[36:39], 0
    s_waitcnt lgkmcnt(4)
    v_rsq_f32 v143, v142
    v_mfma_f32_16x16x32_bf16 v[96:99], a[12:15], v[40:43], v[96:99]
    ds_read_b64_tr_b16 v[56:57], v6 offset:6144
    v_mul_f32 v140, 0xc0135761, v143
    v_mfma_f32_16x16x32_bf16 v[100:103], a[12:15], v[44:47], v[100:103]
    ds_read_b64_tr_b16 v[58:59], v6 offset:7168
    v_mul_f32 v143, v143, v143
    v_mfma_f32_16x16x32_bf16 v[108:111], a[16:19], v[44:47], v[108:111]
    ds_read_b64_tr_b16 v[60:61], v7 offset:6144
    v_mul_f32 v141, 0x3d372713, v140
    v_mfma_f32_16x16x32_bf16 v[104:107], a[16:19], v[40:43], v[104:107]
    buffer_load_dwordx4 a[208:211], v15, s[24:27], s51 offen offset:0 sc1
    v_mfma_f32_16x16x32_bf16 v[120:123], a[20:23], v[40:43], 0
    ds_read_b64_tr_b16 v[62:63], v7 offset:7168
    v_mul_f32 v141, v141, v143
    v_mfma_f32_16x16x32_bf16 v[124:127], a[20:23], v[44:47], 0
    s_waitcnt lgkmcnt(4)
    ds_write_b128 v9, v[140:143] offset:0
    v_mfma_f32_16x16x32_bf16 v[96:99], a[24:27], v[48:51], v[96:99]
    ds_read_b64_tr_b16 v[32:33], v6 offset:8192
    v_mul_f32 v128, v64, v64
    v_mul_f32 v129, v65, v65
    v_mul_f32 v130, v66, v66
    v_mfma_f32_16x16x32_bf16 v[100:103], a[24:27], v[52:55], v[100:103]
    ds_read_b64_tr_b16 v[34:35], v6 offset:9216
    v_mul_f32 v131, v67, v67
    v_mul_f32 v132, v68, v68
    v_mfma_f32_16x16x32_bf16 v[108:111], a[28:31], v[52:55], v[108:111]
    ds_read_b64_tr_b16 v[36:37], v7 offset:8192
    v_mul_f32 v133, v69, v69
    v_mul_f32 v134, v70, v70
    v_mul_f32 v135, v71, v71
    v_mfma_f32_16x16x32_bf16 v[104:107], a[28:31], v[48:51], v[104:107]
    buffer_load_dwordx4 a[212:215], v15, s[24:27], s51 offen offset:1024 sc1
    v_mul_f32 v72, v64, v72
    v_mul_f32 v73, v65, v73
    v_mfma_f32_16x16x32_bf16 v[112:115], a[32:35], v[48:51], v[112:115]
    ds_read_b64_tr_b16 v[38:39], v7 offset:9216
    v_mul_f32 v74, v66, v74
    v_mul_f32 v75, v67, v75
    v_mfma_f32_16x16x32_bf16 v[116:119], a[32:35], v[52:55], v[116:119]
    s_waitcnt lgkmcnt(5)
    v_mul_f32 v76, v68, v76
    v_mul_f32 v77, v69, v77
    v_mul_f32 v78, v70, v78
    v_mul_f32 v79, v71, v79
    v_mfma_f32_16x16x32_bf16 v[96:99], a[36:39], v[56:59], v[96:99]
    s_waitcnt lgkmcnt(4)
    s_waitcnt vmcnt(6)
    s_barrier
    ds_read_b64_tr_b16 v[40:41], v6 offset:10240
    v_mfma_f32_16x16x32_bf16 v[100:103], a[36:39], v[60:63], v[100:103]
    ds_read_b64_tr_b16 v[42:43], v6 offset:11264
    v_mfma_f32_16x16x32_bf16 v[108:111], a[40:43], v[60:63], v[108:111]
    ds_read_b64_tr_b16 v[44:45], v7 offset:10240
    v_mfma_f32_16x16x32_bf16 v[104:107], a[40:43], v[56:59], v[104:107]
    ds_read_b64_tr_b16 v[46:47], v7 offset:11264
    v_mfma_f32_16x16x32_bf16 v[120:123], a[44:47], v[56:59], v[120:123]
    ds_read_b128 v[16:19], v10 offset:0
    v_mfma_f32_16x16x32_bf16 v[124:127], a[44:47], v[60:63], v[124:127]
    s_waitcnt lgkmcnt(5)
    ds_read_b128 v[20:23], v8 offset:0
    v_mfma_f32_16x16x32_bf16 v[96:99], a[48:51], v[32:35], v[96:99]
    ds_read_b64_tr_b16 v[48:49], v6 offset:12288
    s_waitcnt lgkmcnt(2)
    v_fma_f32 v128, v128, v17, v16
    v_fma_f32 v129, v129, v17, v16
    v_fma_f32 v130, v130, v17, v16
    v_mfma_f32_16x16x32_bf16 v[100:103], a[48:51], v[36:39], v[100:103]
    ds_read_b64_tr_b16 v[50:51], v6 offset:13312
    v_fma_f32 v131, v131, v17, v16
    s_waitcnt lgkmcnt(2)
    v_fma_f32 v132, v132, v21, v20
    v_fma_f32 v133, v133, v21, v20
    v_mfma_f32_16x16x32_bf16 v[108:111], a[52:55], v[36:39], v[108:111]
    ds_read_b64_tr_b16 v[52:53], v7 offset:12288
    v_fma_f32 v134, v134, v21, v20
    v_fma_f32 v135, v135, v21, v20
    v_mul_f32 v128, v128, v64
    v_mfma_f32_16x16x32_bf16 v[104:107], a[52:55], v[32:35], v[104:107]
    ds_read_b64_tr_b16 v[54:55], v7 offset:13312
    v_mul_f32 v129, v129, v65
    v_mul_f32 v130, v130, v66
    v_mul_f32 v131, v131, v67
    v_mfma_f32_16x16x32_bf16 v[112:115], a[56:59], v[32:35], v[112:115]
    v_mul_f32 v132, v132, v68
    v_mul_f32 v133, v133, v69
    v_mul_f32 v134, v134, v70
    v_mul_f32 v135, v135, v71
    v_mfma_f32_16x16x32_bf16 v[116:119], a[56:59], v[36:39], v[116:119]
    v_exp_f32 v128, v128
    v_exp_f32 v129, v129
    v_mfma_f32_16x16x32_bf16 v[96:99], a[60:63], v[40:43], v[96:99]
    ds_read_b64_tr_b16 v[56:57], v6 offset:14336
    v_exp_f32 v130, v130
    v_mfma_f32_16x16x32_bf16 v[100:103], a[60:63], v[44:47], v[100:103]
    ds_read_b64_tr_b16 v[58:59], v6 offset:15360
    v_exp_f32 v131, v131
    v_mfma_f32_16x16x32_bf16 v[108:111], a[64:67], v[44:47], v[108:111]
    ds_read_b64_tr_b16 v[60:61], v7 offset:14336
    v_exp_f32 v132, v132
    v_mfma_f32_16x16x32_bf16 v[104:107], a[64:67], v[40:43], v[104:107]
    buffer_load_dwordx4 a[216:219], v15, s[24:27], s51 offen offset:2048 sc1
    v_mfma_f32_16x16x32_bf16 v[120:123], a[68:71], v[40:43], v[120:123]
    ds_read_b64_tr_b16 v[62:63], v7 offset:15360
    v_exp_f32 v133, v133
    v_mfma_f32_16x16x32_bf16 v[124:127], a[68:71], v[44:47], v[124:127]
    s_waitcnt lgkmcnt(4)
    v_exp_f32 v134, v134
    v_mfma_f32_16x16x32_bf16 v[96:99], a[72:75], v[48:51], v[96:99]
    ds_read_b64_tr_b16 v[32:33], v6 offset:16384
    v_exp_f32 v135, v135
    v_mfma_f32_16x16x32_bf16 v[100:103], a[72:75], v[52:55], v[100:103]
    ds_read_b64_tr_b16 v[34:35], v6 offset:17408
    v_fma_f32 v128, v128, v18, v18
    v_mfma_f32_16x16x32_bf16 v[108:111], a[76:79], v[52:55], v[108:111]
    ds_read_b64_tr_b16 v[36:37], v7 offset:16384
    v_fma_f32 v129, v129, v18, v18
    v_mfma_f32_16x16x32_bf16 v[104:107], a[76:79], v[48:51], v[104:107]
    buffer_load_dwordx4 a[220:223], v15, s[24:27], s51 offen offset:3072 sc1
    v_mfma_f32_16x16x32_bf16 v[112:115], a[80:83], v[48:51], v[112:115]
    s_add_u32 s51, s51, 4096
    ds_read_b64_tr_b16 v[38:39], v7 offset:17408
    v_fma_f32 v130, v130, v18, v18
    v_fma_f32 v131, v131, v18, v18
    v_mfma_f32_16x16x32_bf16 v[116:119], a[80:83], v[52:55], v[116:119]
    s_waitcnt lgkmcnt(4)
    v_fma_f32 v132, v132, v22, v22
    v_fma_f32 v133, v133, v22, v22
    v_mfma_f32_16x16x32_bf16 v[96:99], a[84:87], v[56:59], v[96:99]
    ds_read_b64_tr_b16 v[40:41], v6 offset:18432
    v_fma_f32 v134, v134, v22, v22
    v_fma_f32 v135, v135, v22, v22
    v_mfma_f32_16x16x32_bf16 v[100:103], a[84:87], v[60:63], v[100:103]
    ds_read_b64_tr_b16 v[42:43], v6 offset:19456
    v_rcp_f32 v128, v128
    v_mfma_f32_16x16x32_bf16 v[108:111], a[88:91], v[60:63], v[108:111]
    ds_read_b64_tr_b16 v[44:45], v7 offset:18432
    v_rcp_f32 v129, v129
    v_mfma_f32_16x16x32_bf16 v[104:107], a[88:91], v[56:59], v[104:107]
    buffer_load_dwordx4 a[224:227], v15, s[24:27], s51 offen offset:0 sc1
    v_mfma_f32_16x16x32_bf16 v[120:123], a[92:95], v[56:59], v[120:123]
    ds_read_b64_tr_b16 v[46:47], v7 offset:19456
    v_rcp_f32 v130, v130
    v_mfma_f32_16x16x32_bf16 v[124:127], a[92:95], v[60:63], v[124:127]
    s_waitcnt lgkmcnt(4)
    v_rcp_f32 v131, v131
    v_mfma_f32_16x16x32_bf16 v[96:99], a[96:99], v[32:35], v[96:99]
    ds_read_b64_tr_b16 v[48:49], v6 offset:20480
    v_rcp_f32 v132, v132
    v_mfma_f32_16x16x32_bf16 v[100:103], a[96:99], v[36:39], v[100:103]
    ds_read_b64_tr_b16 v[50:51], v6 offset:21504
    v_mfma_f32_16x16x32_bf16 v[108:111], a[100:103], v[36:39], v[108:111]
    ds_read_b64_tr_b16 v[52:53], v7 offset:20480
    v_rcp_f32 v133, v133
    v_mfma_f32_16x16x32_bf16 v[104:107], a[100:103], v[32:35], v[104:107]
    buffer_load_dwordx4 a[228:231], v15, s[24:27], s51 offen offset:1024 sc1
    v_mfma_f32_16x16x32_bf16 v[112:115], a[104:107], v[32:35], v[112:115]
    ds_read_b64_tr_b16 v[54:55], v7 offset:21504
    v_rcp_f32 v134, v134
    v_mfma_f32_16x16x32_bf16 v[116:119], a[104:107], v[36:39], v[116:119]
    s_waitcnt lgkmcnt(4)
    v_rcp_f32 v135, v135
    v_mfma_f32_16x16x32_bf16 v[96:99], a[108:111], v[40:43], v[96:99]
    ds_read_b64_tr_b16 v[56:57], v6 offset:22528
    v_mul_f32 v64, v72, v128
    v_mul_f32 v65, v73, v129
    v_mfma_f32_16x16x32_bf16 v[100:103], a[108:111], v[44:47], v[100:103]
    ds_read_b64_tr_b16 v[58:59], v6 offset:23552
    v_mul_f32 v66, v74, v130
    v_mfma_f32_16x16x32_bf16 v[108:111], a[112:115], v[44:47], v[108:111]
    ds_read_b64_tr_b16 v[60:61], v7 offset:22528
    v_mul_f32 v67, v75, v131
    v_mul_f32 v68, v76, v132
    v_mfma_f32_16x16x32_bf16 v[104:107], a[112:115], v[40:43], v[104:107]
    buffer_load_dwordx4 a[232:235], v15, s[24:27], s51 offen offset:2048 sc1
    v_mfma_f32_16x16x32_bf16 v[120:123], a[116:119], v[40:43], v[120:123]
    ds_read_b64_tr_b16 v[62:63], v7 offset:23552
    v_mul_f32 v69, v77, v133
    v_mul_f32 v70, v78, v134
    v_mfma_f32_16x16x32_bf16 v[124:127], a[116:119], v[44:47], v[124:127]
    s_waitcnt lgkmcnt(4)
    v_mul_f32 v71, v79, v135
    v_cvt_pk_bf16_f32 v136, v64, v65
    v_mfma_f32_16x16x32_bf16 v[96:99], a[120:123], v[48:51], v[96:99]
    ds_read_b64_tr_b16 v[32:33], v6 offset:24576
    v_cvt_pk_bf16_f32 v138, v68, v69
    v_cvt_pk_bf16_f32 v137, v66, v67
    v_mfma_f32_16x16x32_bf16 v[100:103], a[120:123], v[52:55], v[100:103]
    ds_read_b64_tr_b16 v[34:35], v6 offset:25600
    v_cvt_pk_bf16_f32 v139, v70, v71
    v_mfma_f32_16x16x32_bf16 v[108:111], a[124:127], v[52:55], v[108:111]
    ds_read_b64_tr_b16 v[36:37], v7 offset:24576
    v_add_f32 v80, v80, v24
    v_add_f32 v81, v81, v24
    v_mfma_f32_16x16x32_bf16 v[104:107], a[124:127], v[48:51], v[104:107]
    buffer_load_dwordx4 a[236:239], v15, s[24:27], s51 offen offset:3072 sc1
    v_mfma_f32_16x16x32_bf16 v[112:115], a[128:131], v[48:51], v[112:115]
    s_add_u32 s51, s51, 4096
    ds_read_b64_tr_b16 v[38:39], v7 offset:25600
    v_add_f32 v82, v82, v24
    v_add_f32 v83, v83, v24
    v_mfma_f32_16x16x32_bf16 v[116:119], a[128:131], v[52:55], v[116:119]
    s_waitcnt lgkmcnt(4)
    v_permlane16_swap_b32 v136, v138
    v_mfma_f32_16x16x32_bf16 v[96:99], a[132:135], v[56:59], v[96:99]
    ds_read_b64_tr_b16 v[40:41], v6 offset:26624
    v_permlane16_swap_b32 v137, v139
    v_mfma_f32_16x16x32_bf16 v[100:103], a[132:135], v[60:63], v[100:103]
    buffer_store_dwordx4 v[136:139], v12, s[32:35], s55 offen sc1
    v_mfma_f32_16x16x32_bf16 v[108:111], a[136:139], v[60:63], v[108:111]
    ds_read_b64_tr_b16 v[42:43], v6 offset:27648
    v_add_f32 v128, v80, v88
    v_sub_f32 v132, v80, v88
    v_mfma_f32_16x16x32_bf16 v[104:107], a[136:139], v[56:59], v[104:107]
    ds_read_b64_tr_b16 v[44:45], v7 offset:26624
    v_add_f32 v129, v81, v89
    v_sub_f32 v133, v81, v89
    v_mfma_f32_16x16x32_bf16 v[120:123], a[140:143], v[56:59], v[120:123]
    buffer_load_dwordx4 a[240:243], v15, s[24:27], s51 offen offset:0 sc1
    v_mfma_f32_16x16x32_bf16 v[124:127], a[140:143], v[60:63], v[124:127]
    s_waitcnt lgkmcnt(3)
    ds_read_b64_tr_b16 v[46:47], v7 offset:27648
    v_add_f32 v130, v82, v90
    v_sub_f32 v134, v82, v90
    v_mfma_f32_16x16x32_bf16 v[96:99], a[144:147], v[32:35], v[96:99]
    ds_read_b64_tr_b16 v[48:49], v6 offset:28672
    v_add_f32 v131, v83, v91
    v_sub_f32 v135, v83, v91
    v_mfma_f32_16x16x32_bf16 v[100:103], a[144:147], v[36:39], v[100:103]
    ds_read_b64_tr_b16 v[50:51], v6 offset:29696
    v_cvt_pk_bf16_f32 v80, v128, v129
    v_mfma_f32_16x16x32_bf16 v[108:111], a[148:151], v[36:39], v[108:111]
    ds_read_b64_tr_b16 v[52:53], v7 offset:28672
    v_cvt_pk_bf16_f32 v81, v130, v131
    v_cvt_pk_bf16_f32 v90, v135, v134
    v_mfma_f32_16x16x32_bf16 v[104:107], a[148:151], v[32:35], v[104:107]
    buffer_load_dwordx4 a[244:247], v15, s[24:27], s51 offen offset:1024 sc1
    v_mfma_f32_16x16x32_bf16 v[112:115], a[152:155], v[32:35], v[112:115]
    ds_read_b64_tr_b16 v[54:55], v7 offset:29696
    v_cvt_pk_bf16_f32 v91, v133, v132
    v_add_f32 v84, v84, v25
    v_mfma_f32_16x16x32_bf16 v[116:119], a[152:155], v[36:39], v[116:119]
    s_waitcnt lgkmcnt(4)
    v_add_f32 v85, v85, v25
    v_add_f32 v86, v86, v25
    v_mfma_f32_16x16x32_bf16 v[96:99], a[156:159], v[40:43], v[96:99]
    ds_read_b64_tr_b16 v[56:57], v6 offset:30720
    v_add_f32 v87, v87, v25
    v_add_f32 v128, v84, v92
    v_mfma_f32_16x16x32_bf16 v[100:103], a[156:159], v[44:47], v[100:103]
    ds_read_b64_tr_b16 v[58:59], v6 offset:31744
    v_sub_f32 v132, v84, v92
    v_add_f32 v129, v85, v93
    v_mfma_f32_16x16x32_bf16 v[108:111], a[160:163], v[44:47], v[108:111]
    ds_read_b64_tr_b16 v[60:61], v7 offset:30720
    v_sub_f32 v133, v85, v93
    v_add_f32 v130, v86, v94
    v_mfma_f32_16x16x32_bf16 v[104:107], a[160:163], v[40:43], v[104:107]
    buffer_load_dwordx4 a[248:251], v15, s[24:27], s51 offen offset:2048 sc1
    v_mfma_f32_16x16x32_bf16 v[120:123], a[164:167], v[40:43], v[120:123]
    ds_read_b64_tr_b16 v[62:63], v7 offset:31744
    v_sub_f32 v134, v86, v94
    v_add_f32 v131, v87, v95
    v_mfma_f32_16x16x32_bf16 v[124:127], a[164:167], v[44:47], v[124:127]
    s_waitcnt lgkmcnt(4)
    v_xor_b32 v6, 0x18000, v6
    v_xor_b32 v7, 0x18000, v7
    v_sub_f32 v135, v87, v95
    v_mfma_f32_16x16x32_bf16 v[96:99], a[168:171], v[48:51], v[96:99]
    ds_read_b64_tr_b16 v[32:33], v6 offset:0
    v_cvt_pk_bf16_f32 v82, v128, v129
    v_cvt_pk_bf16_f32 v83, v130, v131
    v_mfma_f32_16x16x32_bf16 v[100:103], a[168:171], v[52:55], v[100:103]
    ds_read_b64_tr_b16 v[34:35], v6 offset:1024
    v_cvt_pk_bf16_f32 v88, v135, v134
    v_mfma_f32_16x16x32_bf16 v[108:111], a[172:175], v[52:55], v[108:111]
    ds_read_b64_tr_b16 v[36:37], v7 offset:0
    v_cvt_pk_bf16_f32 v89, v133, v132
    v_permlane16_swap_b32 v80, v82
    v_mfma_f32_16x16x32_bf16 v[104:107], a[172:175], v[48:51], v[104:107]
    buffer_load_dwordx4 a[252:255], v15, s[24:27], s51 offen offset:3072 sc1
    v_mfma_f32_16x16x32_bf16 v[112:115], a[176:179], v[48:51], v[112:115]
    s_add_u32 s51, s51, 4096
    ds_read_b64_tr_b16 v[38:39], v7 offset:1024
    v_permlane16_swap_b32 v81, v83
    v_mfma_f32_16x16x32_bf16 v[116:119], a[176:179], v[52:55], v[116:119]
    s_waitcnt lgkmcnt(4)
    buffer_store_dwordx4 v[80:83], v13, s[24:27], s59 offen offset:512 sc1
    v_mfma_f32_16x16x32_bf16 v[96:99], a[180:183], v[56:59], v[96:99]
    ds_read_b64_tr_b16 v[40:41], v6 offset:2048
    v_permlane16_swap_b32 v90, v88
    v_mfma_f32_16x16x32_bf16 v[100:103], a[180:183], v[60:63], v[100:103]
    ds_read_b64_tr_b16 v[42:43], v6 offset:3072
    v_mfma_f32_16x16x32_bf16 v[108:111], a[184:187], v[60:63], v[108:111]
    ds_read_b64_tr_b16 v[44:45], v7 offset:2048
    v_permlane16_swap_b32 v91, v89
    v_mfma_f32_16x16x32_bf16 v[104:107], a[184:187], v[56:59], v[104:107]
    buffer_store_dwordx4 v[88:91], v14, s[24:27], s60 offen offset:512 sc1
    v_mfma_f32_16x16x32_bf16 v[120:123], a[188:191], v[56:59], v[120:123]
    ds_read_b64_tr_b16 v[46:47], v7 offset:3072
    v_xor_b32 v10, 0x200, v10
    v_xor_b32 v8, 0x200, v8
    v_mfma_f32_16x16x32_bf16 v[124:127], a[188:191], v[60:63], v[124:127]
    s_waitcnt lgkmcnt(4)
    ds_read_b128 v[16:19], v10 offset:0
    ds_read_b128 v[20:23], v8 offset:0
    v_mfma_f32_16x16x32_bf16 v[140:143], v[32:35], v[32:35], 0
    ds_read_b64_tr_b16 v[48:49], v6 offset:4096
    v_mul_f32 v128, v96, v96
    v_mfma_f32_16x16x32_bf16 v[64:67], a[0:3], v[32:35], 0
    ds_read_b64_tr_b16 v[50:51], v6 offset:5120
    v_mul_f32 v129, v97, v97
    v_mul_f32 v130, v98, v98
    v_mfma_f32_16x16x32_bf16 v[68:71], a[0:3], v[36:39], 0
    ds_read_b64_tr_b16 v[52:53], v7 offset:4096
    v_mul_f32 v131, v99, v99
    v_mfma_f32_16x16x32_bf16 v[76:79], a[4:7], v[36:39], 0
    buffer_load_dwordx4 v[144:147], v15, s[24:27], s51 offen offset:0 sc1
    v_mfma_f32_16x16x32_bf16 v[72:75], a[4:7], v[32:35], 0
    ds_read_b64_tr_b16 v[54:55], v7 offset:5120
    v_mul_f32 v132, v100, v100
    v_mfma_f32_16x16x32_bf16 v[80:83], a[8:11], v[32:35], 0
    v_mul_f32 v133, v101, v101
    v_mul_f32 v134, v102, v102
    v_mul_f32 v135, v103, v103
    v_mfma_f32_16x16x32_bf16 v[84:87], a[8:11], v[36:39], 0
    s_waitcnt lgkmcnt(6)
    v_mul_f32 v104, v96, v104
    v_mul_f32 v105, v97, v105
    v_mfma_f32_16x16x32_bf16 v[140:143], v[40:43], v[40:43], v[140:143]
    ds_read_b64_tr_b16 v[56:57], v6 offset:6144
    v_mul_f32 v106, v98, v106
    v_mfma_f32_16x16x32_bf16 v[64:67], a[12:15], v[40:43], v[64:67]
    ds_read_b64_tr_b16 v[58:59], v6 offset:7168
    v_mul_f32 v107, v99, v107
    v_mul_f32 v108, v100, v108
    v_mfma_f32_16x16x32_bf16 v[68:71], a[12:15], v[44:47], v[68:71]
    ds_read_b64_tr_b16 v[60:61], v7 offset:6144
    v_mul_f32 v109, v101, v109
    v_mfma_f32_16x16x32_bf16 v[76:79], a[16:19], v[44:47], v[76:79]
    buffer_load_dwordx4 v[148:151], v15, s[24:27], s51 offen offset:1024 sc1
    v_mfma_f32_16x16x32_bf16 v[72:75], a[16:19], v[40:43], v[72:75]
    ds_read_b64_tr_b16 v[62:63], v7 offset:7168
    v_mul_f32 v110, v102, v110
    v_mfma_f32_16x16x32_bf16 v[88:91], a[20:23], v[40:43], 0
    v_mul_f32 v111, v103, v111
    s_waitcnt lgkmcnt(9)
    v_fma_f32 v128, v128, v17, v16
    v_fma_f32 v129, v129, v17, v16
    v_mfma_f32_16x16x32_bf16 v[92:95], a[20:23], v[44:47], 0
    s_waitcnt lgkmcnt(4)
    v_fma_f32 v130, v130, v17, v16
    v_fma_f32 v131, v131, v17, v16
    v_mfma_f32_16x16x32_bf16 v[140:143], v[48:51], v[48:51], v[140:143]
    ds_read_b64_tr_b16 v[32:33], v6 offset:8192
    v_fma_f32 v132, v132, v21, v20
    v_mfma_f32_16x16x32_bf16 v[64:67], a[24:27], v[48:51], v[64:67]
    ds_read_b64_tr_b16 v[34:35], v6 offset:9216
    v_fma_f32 v133, v133, v21, v20
    v_fma_f32 v134, v134, v21, v20
    v_mfma_f32_16x16x32_bf16 v[68:71], a[24:27], v[52:55], v[68:71]
    ds_read_b64_tr_b16 v[36:37], v7 offset:8192
    v_fma_f32 v135, v135, v21, v20
    v_mfma_f32_16x16x32_bf16 v[76:79], a[28:31], v[52:55], v[76:79]
    buffer_load_dwordx4 v[152:155], v15, s[24:27], s51 offen offset:2048 sc1
    v_mfma_f32_16x16x32_bf16 v[72:75], a[28:31], v[48:51], v[72:75]
    ds_read_b64_tr_b16 v[38:39], v7 offset:9216
    v_mul_f32 v128, v128, v96
    v_mfma_f32_16x16x32_bf16 v[80:83], a[32:35], v[48:51], v[80:83]
    v_mul_f32 v129, v129, v97
    v_mul_f32 v130, v130, v98
    v_mul_f32 v131, v131, v99
    v_mfma_f32_16x16x32_bf16 v[84:87], a[32:35], v[52:55], v[84:87]
    s_waitcnt lgkmcnt(4)
    v_mul_f32 v132, v132, v100
    v_mul_f32 v133, v133, v101
    v_mfma_f32_16x16x32_bf16 v[140:143], v[56:59], v[56:59], v[140:143]
    ds_read_b64_tr_b16 v[40:41], v6 offset:10240
    v_mul_f32 v134, v134, v102
    v_mfma_f32_16x16x32_bf16 v[64:67], a[36:39], v[56:59], v[64:67]
    ds_read_b64_tr_b16 v[42:43], v6 offset:11264
    v_mul_f32 v135, v135, v103
    v_mfma_f32_16x16x32_bf16 v[68:71], a[36:39], v[60:63], v[68:71]
    ds_read_b64_tr_b16 v[44:45], v7 offset:10240
    v_exp_f32 v128, v128
    v_mfma_f32_16x16x32_bf16 v[76:79], a[40:43], v[60:63], v[76:79]
    buffer_load_dwordx4 v[156:159], v15, s[24:27], s51 offen offset:3072 sc1
    v_mfma_f32_16x16x32_bf16 v[72:75], a[40:43], v[56:59], v[72:75]
    s_add_u32 s51, s51, 4096
    ds_read_b64_tr_b16 v[46:47], v7 offset:11264
    v_exp_f32 v129, v129
    v_mfma_f32_16x16x32_bf16 v[88:91], a[44:47], v[56:59], v[88:91]
    v_exp_f32 v130, v130
    v_mfma_f32_16x16x32_bf16 v[92:95], a[44:47], v[60:63], v[92:95]
    s_waitcnt lgkmcnt(4)
    v_exp_f32 v131, v131
    v_mfma_f32_16x16x32_bf16 v[140:143], v[32:35], v[32:35], v[140:143]
    ds_read_b64_tr_b16 v[48:49], v6 offset:12288
    v_exp_f32 v132, v132
    v_mfma_f32_16x16x32_bf16 v[64:67], a[48:51], v[32:35], v[64:67]
    ds_read_b64_tr_b16 v[50:51], v6 offset:13312
    v_mfma_f32_16x16x32_bf16 v[68:71], a[48:51], v[36:39], v[68:71]
    ds_read_b64_tr_b16 v[52:53], v7 offset:12288
    v_exp_f32 v133, v133
    v_mfma_f32_16x16x32_bf16 v[76:79], a[52:55], v[36:39], v[76:79]
    buffer_load_dwordx4 v[160:163], v15, s[24:27], s51 offen offset:0 sc1
    v_mfma_f32_16x16x32_bf16 v[72:75], a[52:55], v[32:35], v[72:75]
    ds_read_b64_tr_b16 v[54:55], v7 offset:13312
    v_exp_f32 v134, v134
    v_mfma_f32_16x16x32_bf16 v[80:83], a[56:59], v[32:35], v[80:83]
    v_exp_f32 v135, v135
    v_mfma_f32_16x16x32_bf16 v[84:87], a[56:59], v[36:39], v[84:87]
    s_waitcnt lgkmcnt(4)
    v_fma_f32 v128, v128, v18, v18
    v_fma_f32 v129, v129, v18, v18
    v_mfma_f32_16x16x32_bf16 v[140:143], v[40:43], v[40:43], v[140:143]
    ds_read_b64_tr_b16 v[56:57], v6 offset:14336
    v_fma_f32 v130, v130, v18, v18
    v_mfma_f32_16x16x32_bf16 v[64:67], a[60:63], v[40:43], v[64:67]
    ds_read_b64_tr_b16 v[58:59], v6 offset:15360
    v_fma_f32 v131, v131, v18, v18
    v_fma_f32 v132, v132, v22, v22
    v_mfma_f32_16x16x32_bf16 v[68:71], a[60:63], v[44:47], v[68:71]
    ds_read_b64_tr_b16 v[60:61], v7 offset:14336
    v_fma_f32 v133, v133, v22, v22
    v_mfma_f32_16x16x32_bf16 v[76:79], a[64:67], v[44:47], v[76:79]
    buffer_load_dwordx4 v[164:167], v15, s[24:27], s51 offen offset:1024 sc1
    v_mfma_f32_16x16x32_bf16 v[72:75], a[64:67], v[40:43], v[72:75]
    ds_read_b64_tr_b16 v[62:63], v7 offset:15360
    v_fma_f32 v134, v134, v22, v22
    v_mfma_f32_16x16x32_bf16 v[88:91], a[68:71], v[40:43], v[88:91]
    v_fma_f32 v135, v135, v22, v22
    v_rcp_f32 v128, v128
    v_mfma_f32_16x16x32_bf16 v[92:95], a[68:71], v[44:47], v[92:95]
    s_waitcnt lgkmcnt(4)
    v_rcp_f32 v129, v129
    v_mfma_f32_16x16x32_bf16 v[140:143], v[48:51], v[48:51], v[140:143]
    ds_read_b64_tr_b16 v[32:33], v6 offset:16384
    v_rcp_f32 v130, v130
    v_mfma_f32_16x16x32_bf16 v[64:67], a[72:75], v[48:51], v[64:67]
    ds_read_b64_tr_b16 v[34:35], v6 offset:17408
    v_mfma_f32_16x16x32_bf16 v[68:71], a[72:75], v[52:55], v[68:71]
    ds_read_b64_tr_b16 v[36:37], v7 offset:16384
    v_rcp_f32 v131, v131
    v_mfma_f32_16x16x32_bf16 v[76:79], a[76:79], v[52:55], v[76:79]
    buffer_load_dwordx4 v[168:171], v15, s[24:27], s51 offen offset:2048 sc1
    v_mfma_f32_16x16x32_bf16 v[72:75], a[76:79], v[48:51], v[72:75]
    ds_read_b64_tr_b16 v[38:39], v7 offset:17408
    v_rcp_f32 v132, v132
    v_mfma_f32_16x16x32_bf16 v[80:83], a[80:83], v[48:51], v[80:83]
    v_rcp_f32 v133, v133
    v_mfma_f32_16x16x32_bf16 v[84:87], a[80:83], v[52:55], v[84:87]
    s_waitcnt lgkmcnt(4)
    v_rcp_f32 v134, v134
    v_mfma_f32_16x16x32_bf16 v[140:143], v[56:59], v[56:59], v[140:143]
    ds_read_b64_tr_b16 v[40:41], v6 offset:18432
    v_rcp_f32 v135, v135
    v_mfma_f32_16x16x32_bf16 v[64:67], a[84:87], v[56:59], v[64:67]
    ds_read_b64_tr_b16 v[42:43], v6 offset:19456
    v_mul_f32 v96, v104, v128
    v_mfma_f32_16x16x32_bf16 v[68:71], a[84:87], v[60:63], v[68:71]
    ds_read_b64_tr_b16 v[44:45], v7 offset:18432
    v_mul_f32 v97, v105, v129
    v_mfma_f32_16x16x32_bf16 v[76:79], a[88:91], v[60:63], v[76:79]
    buffer_load_dwordx4 v[172:175], v15, s[24:27], s51 offen offset:3072 sc1
    v_mul_f32 v98, v106, v130
    v_mfma_f32_16x16x32_bf16 v[72:75], a[88:91], v[56:59], v[72:75]
    s_add_u32 s51, s51, 4096
    ds_read_b64_tr_b16 v[46:47], v7 offset:19456
    v_mul_f32 v99, v107, v131
    v_mfma_f32_16x16x32_bf16 v[88:91], a[92:95], v[56:59], v[88:91]
    v_mul_f32 v100, v108, v132
    v_mul_f32 v101, v109, v133
    v_mul_f32 v102, v110, v134
    v_mfma_f32_16x16x32_bf16 v[92:95], a[92:95], v[60:63], v[92:95]
    s_waitcnt lgkmcnt(4)
    v_mul_f32 v103, v111, v135
    v_cvt_pk_bf16_f32 v136, v96, v97
    v_mfma_f32_16x16x32_bf16 v[140:143], v[32:35], v[32:35], v[140:143]
    ds_read_b64_tr_b16 v[48:49], v6 offset:20480
    v_cvt_pk_bf16_f32 v138, v100, v101
    v_mfma_f32_16x16x32_bf16 v[64:67], a[96:99], v[32:35], v[64:67]
    ds_read_b64_tr_b16 v[50:51], v6 offset:21504
    v_cvt_pk_bf16_f32 v137, v98, v99
    v_mfma_f32_16x16x32_bf16 v[68:71], a[96:99], v[36:39], v[68:71]
    ds_read_b64_tr_b16 v[52:53], v7 offset:20480
    v_cvt_pk_bf16_f32 v139, v102, v103
    v_mfma_f32_16x16x32_bf16 v[76:79], a[100:103], v[36:39], v[76:79]
    buffer_load_dwordx4 v[176:179], v15, s[24:27], s51 offen offset:0 sc1
    v_add_f32 v112, v112, v26
    v_mfma_f32_16x16x32_bf16 v[72:75], a[100:103], v[32:35], v[72:75]
    ds_read_b64_tr_b16 v[54:55], v7 offset:21504
    v_add_f32 v113, v113, v26
    v_mfma_f32_16x16x32_bf16 v[80:83], a[104:107], v[32:35], v[80:83]
    v_add_f32 v114, v114, v26
    v_add_f32 v115, v115, v26
    v_mfma_f32_16x16x32_bf16 v[84:87], a[104:107], v[36:39], v[84:87]
    s_waitcnt lgkmcnt(4)
    v_permlane16_swap_b32 v136, v138
    v_mfma_f32_16x16x32_bf16 v[140:143], v[40:43], v[40:43], v[140:143]
    ds_read_b64_tr_b16 v[56:57], v6 offset:22528
    v_permlane16_swap_b32 v137, v139
    v_mfma_f32_16x16x32_bf16 v[64:67], a[108:111], v[40:43], v[64:67]
    buffer_store_dwordx4 v[136:139], v12, s[32:35], s56 offen sc1
    v_mfma_f32_16x16x32_bf16 v[68:71], a[108:111], v[44:47], v[68:71]
    ds_read_b64_tr_b16 v[58:59], v6 offset:23552
    v_add_f32 v128, v112, v120
    v_mfma_f32_16x16x32_bf16 v[76:79], a[112:115], v[44:47], v[76:79]
    ds_read_b64_tr_b16 v[60:61], v7 offset:22528
    v_sub_f32 v132, v112, v120
    v_mfma_f32_16x16x32_bf16 v[72:75], a[112:115], v[40:43], v[72:75]
    ds_read_b64_tr_b16 v[62:63], v7 offset:23552
    v_add_f32 v129, v113, v121
    v_mfma_f32_16x16x32_bf16 v[88:91], a[116:119], v[40:43], v[88:91]
    v_sub_f32 v133, v113, v121
    v_add_f32 v130, v114, v122
    v_sub_f32 v134, v114, v122
    v_mfma_f32_16x16x32_bf16 v[92:95], a[116:119], v[44:47], v[92:95]
    s_waitcnt lgkmcnt(4)
    v_add_f32 v131, v115, v123
    v_sub_f32 v135, v115, v123
    v_mfma_f32_16x16x32_bf16 v[140:143], v[48:51], v[48:51], v[140:143]
    ds_read_b64_tr_b16 v[32:33], v6 offset:24576
    v_cvt_pk_bf16_f32 v112, v128, v129
    v_mfma_f32_16x16x32_bf16 v[64:67], a[120:123], v[48:51], v[64:67]
    ds_read_b64_tr_b16 v[34:35], v6 offset:25600
    v_cvt_pk_bf16_f32 v113, v130, v131
    v_cvt_pk_bf16_f32 v122, v135, v134
    v_mfma_f32_16x16x32_bf16 v[68:71], a[120:123], v[52:55], v[68:71]
    ds_read_b64_tr_b16 v[36:37], v7 offset:24576
    v_cvt_pk_bf16_f32 v123, v133, v132
    v_mfma_f32_16x16x32_bf16 v[76:79], a[124:127], v[52:55], v[76:79]
    buffer_load_dwordx4 v[180:183], v15, s[24:27], s51 offen offset:1024 sc1
    v_mfma_f32_16x16x32_bf16 v[72:75], a[124:127], v[48:51], v[72:75]
    ds_read_b64_tr_b16 v[38:39], v7 offset:25600
    v_add_f32 v116, v116, v27
    v_mfma_f32_16x16x32_bf16 v[80:83], a[128:131], v[48:51], v[80:83]
    v_add_f32 v117, v117, v27
    v_add_f32 v118, v118, v27
    v_add_f32 v119, v119, v27
    v_mfma_f32_16x16x32_bf16 v[84:87], a[128:131], v[52:55], v[84:87]
    s_waitcnt lgkmcnt(4)
    v_add_f32 v128, v116, v124
    v_sub_f32 v132, v116, v124
    v_mfma_f32_16x16x32_bf16 v[140:143], v[56:59], v[56:59], v[140:143]
    ds_read_b64_tr_b16 v[40:41], v6 offset:26624
    v_add_f32 v129, v117, v125
    v_mfma_f32_16x16x32_bf16 v[64:67], a[132:135], v[56:59], v[64:67]
    ds_read_b64_tr_b16 v[42:43], v6 offset:27648
    v_sub_f32 v133, v117, v125
    v_add_f32 v130, v118, v126
    v_mfma_f32_16x16x32_bf16 v[68:71], a[132:135], v[60:63], v[68:71]
    ds_read_b64_tr_b16 v[44:45], v7 offset:26624
    v_sub_f32 v134, v118, v126
    v_mfma_f32_16x16x32_bf16 v[76:79], a[136:139], v[60:63], v[76:79]
    buffer_load_dwordx4 v[184:187], v15, s[24:27], s51 offen offset:2048 sc1
    v_mfma_f32_16x16x32_bf16 v[72:75], a[136:139], v[56:59], v[72:75]
    ds_read_b64_tr_b16 v[46:47], v7 offset:27648
    v_add_f32 v131, v119, v127
    v_mfma_f32_16x16x32_bf16 v[88:91], a[140:143], v[56:59], v[88:91]
    v_sub_f32 v135, v119, v127
    v_cvt_pk_bf16_f32 v114, v128, v129
    v_cvt_pk_bf16_f32 v115, v130, v131
    v_mfma_f32_16x16x32_bf16 v[92:95], a[140:143], v[60:63], v[92:95]
    s_waitcnt lgkmcnt(4)
    v_cvt_pk_bf16_f32 v120, v135, v134
    v_cvt_pk_bf16_f32 v121, v133, v132
    v_mfma_f32_16x16x32_bf16 v[140:143], v[32:35], v[32:35], v[140:143]
    ds_read_b64_tr_b16 v[48:49], v6 offset:28672
    v_permlane16_swap_b32 v112, v114
    v_mfma_f32_16x16x32_bf16 v[64:67], a[144:147], v[32:35], v[64:67]
    ds_read_b64_tr_b16 v[50:51], v6 offset:29696
    v_permlane16_swap_b32 v113, v115
    v_mfma_f32_16x16x32_bf16 v[68:71], a[144:147], v[36:39], v[68:71]
    buffer_store_dwordx4 v[112:115], v13, s[24:27], s59 offen offset:0 sc1
    v_mfma_f32_16x16x32_bf16 v[76:79], a[148:151], v[36:39], v[76:79]
    ds_read_b64_tr_b16 v[52:53], v7 offset:28672
    v_permlane16_swap_b32 v122, v120
    v_mfma_f32_16x16x32_bf16 v[72:75], a[148:151], v[32:35], v[72:75]
    buffer_load_dwordx4 v[188:191], v15, s[24:27], s51 offen offset:3072 sc1
    v_mfma_f32_16x16x32_bf16 v[80:83], a[152:155], v[32:35], v[80:83]
    s_add_u32 s51, s51, 4096
    ds_read_b64_tr_b16 v[54:55], v7 offset:29696
    v_permlane16_swap_b32 v123, v121
    v_mfma_f32_16x16x32_bf16 v[84:87], a[152:155], v[36:39], v[84:87]
    s_waitcnt lgkmcnt(4)
    buffer_store_dwordx4 v[120:123], v14, s[24:27], s60 offen offset:0 sc1
    v_mfma_f32_16x16x32_bf16 v[140:143], v[40:43], v[40:43], v[140:143]
    ds_read_b64_tr_b16 v[56:57], v6 offset:30720
    v_mfma_f32_16x16x32_bf16 v[64:67], a[156:159], v[40:43], v[64:67]
    ds_read_b64_tr_b16 v[58:59], v6 offset:31744
    v_mfma_f32_16x16x32_bf16 v[68:71], a[156:159], v[44:47], v[68:71]
    ds_read_b64_tr_b16 v[60:61], v7 offset:30720
    v_mfma_f32_16x16x32_bf16 v[76:79], a[160:163], v[44:47], v[76:79]
    buffer_load_dwordx4 v[192:195], v15, s[24:27], s51 offen offset:0 sc1
    v_mfma_f32_16x16x32_bf16 v[72:75], a[160:163], v[40:43], v[72:75]
    ds_read_b64_tr_b16 v[62:63], v7 offset:31744
    v_mfma_f32_16x16x32_bf16 v[88:91], a[164:167], v[40:43], v[88:91]
    v_mfma_f32_16x16x32_bf16 v[92:95], a[164:167], v[44:47], v[92:95]
    s_waitcnt lgkmcnt(4)
    v_xor_b32 v6, 0x8000, v6
    v_xor_b32 v7, 0x8000, v7
    v_mfma_f32_16x16x32_bf16 v[140:143], v[48:51], v[48:51], v[140:143]
    ds_read_b64_tr_b16 v[32:33], v6 offset:0
    v_mfma_f32_16x16x32_bf16 v[64:67], a[168:171], v[48:51], v[64:67]
    ds_read_b64_tr_b16 v[34:35], v6 offset:1024
    v_mfma_f32_16x16x32_bf16 v[68:71], a[168:171], v[52:55], v[68:71]
    ds_read_b64_tr_b16 v[36:37], v7 offset:0
    v_mfma_f32_16x16x32_bf16 v[76:79], a[172:175], v[52:55], v[76:79]
    buffer_load_dwordx4 v[196:199], v15, s[24:27], s51 offen offset:1024 sc1
    v_mfma_f32_16x16x32_bf16 v[72:75], a[172:175], v[48:51], v[72:75]
    ds_read_b64_tr_b16 v[38:39], v7 offset:1024
    v_mfma_f32_16x16x32_bf16 v[80:83], a[176:179], v[48:51], v[80:83]
    v_mfma_f32_16x16x32_bf16 v[84:87], a[176:179], v[52:55], v[84:87]
    s_waitcnt lgkmcnt(4)
    v_mfma_f32_16x16x32_bf16 v[140:143], v[56:59], v[56:59], v[140:143]
    ds_read_b64_tr_b16 v[40:41], v6 offset:2048
    v_mfma_f32_16x16x32_bf16 v[64:67], a[180:183], v[56:59], v[64:67]
    ds_read_b64_tr_b16 v[42:43], v6 offset:3072
    v_mfma_f32_16x16x32_bf16 v[68:71], a[180:183], v[60:63], v[68:71]
    ds_read_b64_tr_b16 v[44:45], v7 offset:2048
    v_mfma_f32_16x16x32_bf16 v[76:79], a[184:187], v[60:63], v[76:79]
    buffer_load_dwordx4 v[200:203], v15, s[24:27], s51 offen offset:2048 sc1
    v_mfma_f32_16x16x32_bf16 v[72:75], a[184:187], v[56:59], v[72:75]
    ds_read_b64_tr_b16 v[46:47], v7 offset:3072
    v_mfma_f32_16x16x32_bf16 v[88:91], a[188:191], v[56:59], v[88:91]
    v_mfma_f32_16x16x32_bf16 v[92:95], a[188:191], v[60:63], v[92:95]
    s_waitcnt lgkmcnt(4)
    v_mfma_f32_16x16x32_bf16 v[96:99], a[0:3], v[32:35], 0
    ds_read_b64_tr_b16 v[48:49], v6 offset:4096
    v_cndmask_b32 v140, v140, v141, s[64:65]
    v_mfma_f32_16x16x32_bf16 v[100:103], a[0:3], v[36:39], 0
    ds_read_b64_tr_b16 v[50:51], v6 offset:5120
    v_cndmask_b32 v140, v140, v142, s[66:67]
    v_mfma_f32_16x16x32_bf16 v[108:111], a[4:7], v[36:39], 0
    ds_read_b64_tr_b16 v[52:53], v7 offset:4096
    v_cndmask_b32 v140, v140, v143, s[68:69]
    v_mov_b32 v142, 0x3b27c5ac
    v_mfma_f32_16x16x32_bf16 v[104:107], a[4:7], v[32:35], 0
    buffer_load_dwordx4 v[204:207], v15, s[24:27], s51 offen offset:3072 sc1
    v_mfma_f32_16x16x32_bf16 v[112:115], a[8:11], v[32:35], 0
    s_add_u32 s51, s51, 4096
    ds_read_b64_tr_b16 v[54:55], v7 offset:5120
    v_fmac_f32 v142, 0.5, v140
    v_mfma_f32_16x16x32_bf16 v[116:119], a[8:11], v[36:39], 0
    s_waitcnt lgkmcnt(4)
    v_rsq_f32 v143, v142
    v_mfma_f32_16x16x32_bf16 v[96:99], a[12:15], v[40:43], v[96:99]
    ds_read_b64_tr_b16 v[56:57], v6 offset:6144
    v_mul_f32 v140, 0xc0135761, v143
    v_mfma_f32_16x16x32_bf16 v[100:103], a[12:15], v[44:47], v[100:103]
    ds_read_b64_tr_b16 v[58:59], v6 offset:7168
    v_mul_f32 v143, v143, v143
    v_mul_f32 v141, 0x3d372713, v140
    v_mfma_f32_16x16x32_bf16 v[108:111], a[16:19], v[44:47], v[108:111]
    ds_read_b64_tr_b16 v[60:61], v7 offset:6144
    v_mul_f32 v141, v141, v143
    v_mfma_f32_16x16x32_bf16 v[104:107], a[16:19], v[40:43], v[104:107]
    ds_write_b128 v9, v[140:143] offset:1024
    v_mfma_f32_16x16x32_bf16 v[120:123], a[20:23], v[40:43], 0
    buffer_load_dwordx4 v[208:211], v15, s[24:27], s51 offen offset:0 sc1
    v_xor_b32 v10, 0x200, v10
    v_mfma_f32_16x16x32_bf16 v[124:127], a[20:23], v[44:47], 0
    s_waitcnt lgkmcnt(4)
    ds_read_b64_tr_b16 v[62:63], v7 offset:7168
    v_xor_b32 v8, 0x200, v8
    v_mfma_f32_16x16x32_bf16 v[96:99], a[24:27], v[48:51], v[96:99]
    ds_read_b64_tr_b16 v[32:33], v6 offset:8192
    v_mul_f32 v128, v64, v64
    v_mul_f32 v129, v65, v65
    v_mul_f32 v130, v66, v66
    v_mfma_f32_16x16x32_bf16 v[100:103], a[24:27], v[52:55], v[100:103]
    ds_read_b64_tr_b16 v[34:35], v6 offset:9216
    v_mul_f32 v131, v67, v67
    v_mul_f32 v132, v68, v68
    v_mfma_f32_16x16x32_bf16 v[108:111], a[28:31], v[52:55], v[108:111]
    ds_read_b64_tr_b16 v[36:37], v7 offset:8192
    v_mul_f32 v133, v69, v69
    v_mul_f32 v134, v70, v70
    v_mul_f32 v135, v71, v71
    v_mfma_f32_16x16x32_bf16 v[104:107], a[28:31], v[48:51], v[104:107]
    buffer_load_dwordx4 v[212:215], v15, s[24:27], s51 offen offset:1024 sc1
    v_mul_f32 v72, v64, v72
    v_mul_f32 v73, v65, v73
    v_mfma_f32_16x16x32_bf16 v[112:115], a[32:35], v[48:51], v[112:115]
    ds_read_b64_tr_b16 v[38:39], v7 offset:9216
    v_mul_f32 v74, v66, v74
    v_mul_f32 v75, v67, v75
    v_mfma_f32_16x16x32_bf16 v[116:119], a[32:35], v[52:55], v[116:119]
    s_waitcnt lgkmcnt(4)
    v_mul_f32 v76, v68, v76
    v_mul_f32 v77, v69, v77
    v_mul_f32 v78, v70, v78
    v_mul_f32 v79, v71, v79
    v_mfma_f32_16x16x32_bf16 v[96:99], a[36:39], v[56:59], v[96:99]
    s_waitcnt vmcnt(6)
    s_barrier
    v_mov_b32 v24, 0
    v_mov_b32 v25, 1
    s_mov_b64 exec, 1
    buffer_store_dword v25, v24, s[24:27], s41 offen sc1
    s_mov_b64 exec, -1
    ds_read_b64_tr_b16 v[40:41], v6 offset:10240
    v_mfma_f32_16x16x32_bf16 v[100:103], a[36:39], v[60:63], v[100:103]
    ds_read_b64_tr_b16 v[42:43], v6 offset:11264
    v_mfma_f32_16x16x32_bf16 v[108:111], a[40:43], v[60:63], v[108:111]
    ds_read_b64_tr_b16 v[44:45], v7 offset:10240
    v_mfma_f32_16x16x32_bf16 v[104:107], a[40:43], v[56:59], v[104:107]
    ds_read_b64_tr_b16 v[46:47], v7 offset:11264
    v_mfma_f32_16x16x32_bf16 v[120:123], a[44:47], v[56:59], v[120:123]
    ds_read_b128 v[16:19], v10 offset:1024
    v_mfma_f32_16x16x32_bf16 v[124:127], a[44:47], v[60:63], v[124:127]
    s_waitcnt lgkmcnt(5)
    ds_read_b128 v[20:23], v8 offset:1024
    v_mfma_f32_16x16x32_bf16 v[96:99], a[48:51], v[32:35], v[96:99]
    ds_read_b64_tr_b16 v[48:49], v6 offset:12288
    s_waitcnt lgkmcnt(2)
    v_fma_f32 v128, v128, v17, v16
    v_fma_f32 v129, v129, v17, v16
    v_fma_f32 v130, v130, v17, v16
    v_mfma_f32_16x16x32_bf16 v[100:103], a[48:51], v[36:39], v[100:103]
    ds_read_b64_tr_b16 v[50:51], v6 offset:13312
    v_fma_f32 v131, v131, v17, v16
    s_waitcnt lgkmcnt(2)
    v_fma_f32 v132, v132, v21, v20
    v_fma_f32 v133, v133, v21, v20
    v_fma_f32 v134, v134, v21, v20
    v_mfma_f32_16x16x32_bf16 v[108:111], a[52:55], v[36:39], v[108:111]
    ds_read_b64_tr_b16 v[52:53], v7 offset:12288
    v_fma_f32 v135, v135, v21, v20
    v_mul_f32 v128, v128, v64
    v_mul_f32 v129, v129, v65
    v_mfma_f32_16x16x32_bf16 v[104:107], a[52:55], v[32:35], v[104:107]
    buffer_load_dwordx4 v[216:219], v15, s[24:27], s51 offen offset:2048 sc1
    v_mul_f32 v130, v130, v66
    v_mul_f32 v131, v131, v67
    v_mfma_f32_16x16x32_bf16 v[112:115], a[56:59], v[32:35], v[112:115]
    ds_read_b64_tr_b16 v[54:55], v7 offset:13312
    v_mul_f32 v132, v132, v68
    v_mul_f32 v133, v133, v69
    v_mul_f32 v134, v134, v70
    v_mul_f32 v135, v135, v71
    v_mfma_f32_16x16x32_bf16 v[116:119], a[56:59], v[36:39], v[116:119]
    v_exp_f32 v128, v128
    v_exp_f32 v129, v129
    v_mfma_f32_16x16x32_bf16 v[96:99], a[60:63], v[40:43], v[96:99]
    ds_read_b64_tr_b16 v[56:57], v6 offset:14336
    v_exp_f32 v130, v130
    v_mfma_f32_16x16x32_bf16 v[100:103], a[60:63], v[44:47], v[100:103]
    ds_read_b64_tr_b16 v[58:59], v6 offset:15360
    v_exp_f32 v131, v131
    v_mfma_f32_16x16x32_bf16 v[108:111], a[64:67], v[44:47], v[108:111]
    ds_read_b64_tr_b16 v[60:61], v7 offset:14336
    v_exp_f32 v132, v132
    v_mfma_f32_16x16x32_bf16 v[104:107], a[64:67], v[40:43], v[104:107]
    buffer_load_dwordx4 v[220:223], v15, s[24:27], s51 offen offset:3072 sc1
    v_mfma_f32_16x16x32_bf16 v[120:123], a[68:71], v[40:43], v[120:123]
    s_add_u32 s51, s51, 4096
    ds_read_b64_tr_b16 v[62:63], v7 offset:15360
    v_exp_f32 v133, v133
    v_mfma_f32_16x16x32_bf16 v[124:127], a[68:71], v[44:47], v[124:127]
    s_waitcnt lgkmcnt(4)
    v_exp_f32 v134, v134
    v_mfma_f32_16x16x32_bf16 v[96:99], a[72:75], v[48:51], v[96:99]
    ds_read_b64_tr_b16 v[32:33], v6 offset:16384
    v_exp_f32 v135, v135
    v_mfma_f32_16x16x32_bf16 v[100:103], a[72:75], v[52:55], v[100:103]
    ds_read_b64_tr_b16 v[34:35], v6 offset:17408
    v_fma_f32 v128, v128, v18, v18
    v_mfma_f32_16x16x32_bf16 v[108:111], a[76:79], v[52:55], v[108:111]
    ds_read_b64_tr_b16 v[36:37], v7 offset:16384
    v_fma_f32 v129, v129, v18, v18
    v_mfma_f32_16x16x32_bf16 v[104:107], a[76:79], v[48:51], v[104:107]
    buffer_load_dwordx4 v[224:227], v15, s[24:27], s51 offen offset:0 sc1
    v_mfma_f32_16x16x32_bf16 v[112:115], a[80:83], v[48:51], v[112:115]
    ds_read_b64_tr_b16 v[38:39], v7 offset:17408
    v_fma_f32 v130, v130, v18, v18
    v_fma_f32 v131, v131, v18, v18
    v_mfma_f32_16x16x32_bf16 v[116:119], a[80:83], v[52:55], v[116:119]
    s_waitcnt lgkmcnt(4)
    v_fma_f32 v132, v132, v22, v22
    v_fma_f32 v133, v133, v22, v22
    v_mfma_f32_16x16x32_bf16 v[96:99], a[84:87], v[56:59], v[96:99]
    ds_read_b64_tr_b16 v[40:41], v6 offset:18432
    v_fma_f32 v134, v134, v22, v22
    v_fma_f32 v135, v135, v22, v22
    v_mfma_f32_16x16x32_bf16 v[100:103], a[84:87], v[60:63], v[100:103]
    ds_read_b64_tr_b16 v[42:43], v6 offset:19456
    v_rcp_f32 v128, v128
    v_rcp_f32 v129, v129
    v_mfma_f32_16x16x32_bf16 v[108:111], a[88:91], v[60:63], v[108:111]
    ds_read_b64_tr_b16 v[44:45], v7 offset:18432
    v_rcp_f32 v130, v130
    v_mfma_f32_16x16x32_bf16 v[104:107], a[88:91], v[56:59], v[104:107]
    buffer_load_dwordx4 v[228:231], v15, s[24:27], s51 offen offset:1024 sc1
    v_rcp_f32 v131, v131
    v_mfma_f32_16x16x32_bf16 v[120:123], a[92:95], v[56:59], v[120:123]
    ds_read_b64_tr_b16 v[46:47], v7 offset:19456
    v_lshlrev_b32 v5, 7, v3
    v_lshl_add_u32 v5, v2, 28, v5
    v_mfma_f32_16x16x32_bf16 v[124:127], a[92:95], v[60:63], v[124:127]
    s_waitcnt lgkmcnt(4)
    v_min_u32 v0, 1, v2
    v_xor_b32 v0, 1, v0
    v_add_u32 v3, s74, v4
    v_mfma_f32_16x16x32_bf16 v[96:99], a[96:99], v[32:35], v[96:99]
    ds_read_b64_tr_b16 v[48:49], v6 offset:20480
    v_rcp_f32 v132, v132
    v_mfma_f32_16x16x32_bf16 v[100:103], a[96:99], v[36:39], v[100:103]
    ds_read_b64_tr_b16 v[50:51], v6 offset:21504
    v_rcp_f32 v133, v133
    v_mfma_f32_16x16x32_bf16 v[108:111], a[100:103], v[36:39], v[108:111]
    buffer_load_dword v9, v5, s[24:27], s62 offen sc1
    v_mfma_f32_16x16x32_bf16 v[104:107], a[100:103], v[32:35], v[104:107]
    ds_read_b64_tr_b16 v[52:53], v7 offset:20480
    v_rcp_f32 v134, v134
    v_mfma_f32_16x16x32_bf16 v[112:115], a[104:107], v[32:35], v[112:115]
    buffer_load_dwordx4 v[232:235], v15, s[24:27], s51 offen offset:2048 sc1
    v_mfma_f32_16x16x32_bf16 v[116:119], a[104:107], v[36:39], v[116:119]
    s_waitcnt lgkmcnt(3)
    ds_read_b64_tr_b16 v[54:55], v7 offset:21504
    v_rcp_f32 v135, v135
    v_mfma_f32_16x16x32_bf16 v[96:99], a[108:111], v[40:43], v[96:99]
    ds_read_b64_tr_b16 v[56:57], v6 offset:22528
    v_mul_f32 v64, v72, v128
    v_mul_f32 v65, v73, v129
    v_mfma_f32_16x16x32_bf16 v[100:103], a[108:111], v[44:47], v[100:103]
    ds_read_b64_tr_b16 v[58:59], v6 offset:23552
    v_mul_f32 v66, v74, v130
    v_mfma_f32_16x16x32_bf16 v[108:111], a[112:115], v[44:47], v[108:111]
    ds_read_b64_tr_b16 v[60:61], v7 offset:22528
    v_mul_f32 v67, v75, v131
    v_mul_f32 v68, v76, v132
    v_mfma_f32_16x16x32_bf16 v[104:107], a[112:115], v[40:43], v[104:107]
    buffer_load_dwordx4 v[236:239], v15, s[24:27], s51 offen offset:3072 sc1
    v_mfma_f32_16x16x32_bf16 v[120:123], a[116:119], v[40:43], v[120:123]
    s_add_u32 s51, s51, 4096
    ds_read_b64_tr_b16 v[62:63], v7 offset:23552
    v_mul_f32 v69, v77, v133
    v_mul_f32 v70, v78, v134
    v_mfma_f32_16x16x32_bf16 v[124:127], a[116:119], v[44:47], v[124:127]
    s_waitcnt lgkmcnt(4)
    v_mul_f32 v71, v79, v135
    v_cvt_pk_bf16_f32 v136, v64, v65
    v_mfma_f32_16x16x32_bf16 v[96:99], a[120:123], v[48:51], v[96:99]
    ds_read_b64_tr_b16 v[32:33], v6 offset:24576
    v_cvt_pk_bf16_f32 v138, v68, v69
    v_cvt_pk_bf16_f32 v137, v66, v67
    v_mfma_f32_16x16x32_bf16 v[100:103], a[120:123], v[52:55], v[100:103]
    ds_read_b64_tr_b16 v[34:35], v6 offset:25600
    v_cvt_pk_bf16_f32 v139, v70, v71
    v_mfma_f32_16x16x32_bf16 v[108:111], a[124:127], v[52:55], v[108:111]
    ds_read_b64_tr_b16 v[36:37], v7 offset:24576
    v_add_f32 v80, v80, v28
    v_add_f32 v81, v81, v28
    v_mfma_f32_16x16x32_bf16 v[104:107], a[124:127], v[48:51], v[104:107]
    buffer_load_dwordx4 v[240:243], v15, s[24:27], s51 offen offset:0 sc1
    v_mfma_f32_16x16x32_bf16 v[112:115], a[128:131], v[48:51], v[112:115]
    ds_read_b64_tr_b16 v[38:39], v7 offset:25600
    v_add_f32 v82, v82, v28
    v_add_f32 v83, v83, v28
    v_mfma_f32_16x16x32_bf16 v[116:119], a[128:131], v[52:55], v[116:119]
    s_waitcnt lgkmcnt(4)
    v_permlane16_swap_b32 v136, v138
    v_mfma_f32_16x16x32_bf16 v[96:99], a[132:135], v[56:59], v[96:99]
    ds_read_b64_tr_b16 v[40:41], v6 offset:26624
    v_permlane16_swap_b32 v137, v139
    v_mfma_f32_16x16x32_bf16 v[100:103], a[132:135], v[60:63], v[100:103]
    buffer_store_dwordx4 v[136:139], v12, s[32:35], s57 offen sc1
    v_mfma_f32_16x16x32_bf16 v[108:111], a[136:139], v[60:63], v[108:111]
    ds_read_b64_tr_b16 v[42:43], v6 offset:27648
    v_add_f32 v128, v80, v88
    v_sub_f32 v132, v80, v88
    v_mfma_f32_16x16x32_bf16 v[104:107], a[136:139], v[56:59], v[104:107]
    ds_read_b64_tr_b16 v[44:45], v7 offset:26624
    v_add_f32 v129, v81, v89
    v_sub_f32 v133, v81, v89
    v_mfma_f32_16x16x32_bf16 v[120:123], a[140:143], v[56:59], v[120:123]
    buffer_load_dwordx4 v[244:247], v15, s[24:27], s51 offen offset:1024 sc1
    v_mfma_f32_16x16x32_bf16 v[124:127], a[140:143], v[60:63], v[124:127]
    s_waitcnt lgkmcnt(3)
    ds_read_b64_tr_b16 v[46:47], v7 offset:27648
    v_add_f32 v130, v82, v90
    v_sub_f32 v134, v82, v90
    v_mfma_f32_16x16x32_bf16 v[96:99], a[144:147], v[32:35], v[96:99]
    ds_read_b64_tr_b16 v[48:49], v6 offset:28672
    v_add_f32 v131, v83, v91
    v_sub_f32 v135, v83, v91
    v_mfma_f32_16x16x32_bf16 v[100:103], a[144:147], v[36:39], v[100:103]
    ds_read_b64_tr_b16 v[50:51], v6 offset:29696
    v_cvt_pk_bf16_f32 v80, v128, v129
    v_mfma_f32_16x16x32_bf16 v[108:111], a[148:151], v[36:39], v[108:111]
    ds_read_b64_tr_b16 v[52:53], v7 offset:28672
    v_cvt_pk_bf16_f32 v81, v130, v131
    v_cvt_pk_bf16_f32 v90, v135, v134
    v_mfma_f32_16x16x32_bf16 v[104:107], a[148:151], v[32:35], v[104:107]
    buffer_load_dwordx4 v[248:251], v15, s[24:27], s51 offen offset:2048 sc1
    v_mfma_f32_16x16x32_bf16 v[112:115], a[152:155], v[32:35], v[112:115]
    ds_read_b64_tr_b16 v[54:55], v7 offset:29696
    v_cvt_pk_bf16_f32 v91, v133, v132
    v_add_f32 v84, v84, v29
    v_mfma_f32_16x16x32_bf16 v[116:119], a[152:155], v[36:39], v[116:119]
    s_waitcnt lgkmcnt(4)
    v_add_f32 v85, v85, v29
    v_add_f32 v86, v86, v29
    v_mfma_f32_16x16x32_bf16 v[96:99], a[156:159], v[40:43], v[96:99]
    ds_read_b64_tr_b16 v[56:57], v6 offset:30720
    v_add_f32 v87, v87, v29
    v_add_f32 v128, v84, v92
    v_mfma_f32_16x16x32_bf16 v[100:103], a[156:159], v[44:47], v[100:103]
    ds_read_b64_tr_b16 v[58:59], v6 offset:31744
    v_sub_f32 v132, v84, v92
    v_mfma_f32_16x16x32_bf16 v[108:111], a[160:163], v[44:47], v[108:111]
    ds_read_b64_tr_b16 v[60:61], v7 offset:30720
    v_add_f32 v129, v85, v93
    v_sub_f32 v133, v85, v93
    v_mfma_f32_16x16x32_bf16 v[104:107], a[160:163], v[40:43], v[104:107]
    buffer_load_dwordx4 v[252:255], v15, s[24:27], s51 offen offset:3072 sc1
    v_mfma_f32_16x16x32_bf16 v[120:123], a[164:167], v[40:43], v[120:123]
    s_add_u32 s51, s51, 4096
    ds_read_b64_tr_b16 v[62:63], v7 offset:31744
    v_add_f32 v130, v86, v94
    v_sub_f32 v134, v86, v94
    v_mfma_f32_16x16x32_bf16 v[124:127], a[164:167], v[44:47], v[124:127]
    s_waitcnt lgkmcnt(4)
    v_add_f32 v131, v87, v95
    v_sub_f32 v135, v87, v95
    v_mfma_f32_16x16x32_bf16 v[96:99], a[168:171], v[48:51], v[96:99]
    v_cvt_pk_bf16_f32 v82, v128, v129
    v_cvt_pk_bf16_f32 v83, v130, v131
    v_mfma_f32_16x16x32_bf16 v[100:103], a[168:171], v[52:55], v[100:103]
    v_cvt_pk_bf16_f32 v88, v135, v134
    v_mfma_f32_16x16x32_bf16 v[108:111], a[172:175], v[52:55], v[108:111]
    v_cvt_pk_bf16_f32 v89, v133, v132
    v_permlane16_swap_b32 v80, v82
    v_mfma_f32_16x16x32_bf16 v[104:107], a[172:175], v[48:51], v[104:107]
    v_mfma_f32_16x16x32_bf16 v[112:115], a[176:179], v[48:51], v[112:115]
    v_permlane16_swap_b32 v81, v83
    v_mfma_f32_16x16x32_bf16 v[116:119], a[176:179], v[52:55], v[116:119]
    s_waitcnt lgkmcnt(0)
    buffer_store_dwordx4 v[80:83], v13, s[24:27], s59 offen offset:1536 sc1
    v_mfma_f32_16x16x32_bf16 v[96:99], a[180:183], v[56:59], v[96:99]
    v_permlane16_swap_b32 v90, v88
    v_mfma_f32_16x16x32_bf16 v[100:103], a[180:183], v[60:63], v[100:103]
    v_permlane16_swap_b32 v91, v89
    v_mfma_f32_16x16x32_bf16 v[108:111], a[184:187], v[60:63], v[108:111]
    buffer_store_dwordx4 v[88:91], v14, s[24:27], s60 offen offset:1536 sc1
    v_xor_b32 v10, 0x200, v10
    v_mfma_f32_16x16x32_bf16 v[104:107], a[184:187], v[56:59], v[104:107]
    v_xor_b32 v8, 0x200, v8
    v_mfma_f32_16x16x32_bf16 v[120:123], a[188:191], v[56:59], v[120:123]
    ds_read_b128 v[16:19], v10 offset:1024
    v_mfma_f32_16x16x32_bf16 v[124:127], a[188:191], v[60:63], v[124:127]
    ds_read_b128 v[20:23], v8 offset:1024
    s_waitcnt vmcnt(9)
    v_cmp_ne_u32 vcc, v0, v9
    s_nop 0
    s_cmp_eq_u64 vcc, 0
    s_cselect_b32 s38, s34, 0
    v_pk_mul_f32 v[128:129], v[96:97], v[96:97]
    v_pk_mul_f32 v[130:131], v[98:99], v[98:99]
    v_pk_mul_f32 v[132:133], v[100:101], v[100:101]
    v_pk_mul_f32 v[134:135], v[102:103], v[102:103]
    s_waitcnt lgkmcnt(1)
    v_pk_fma_f32 v[128:129], v[128:129], v[16:17], v[16:17] op_sel:[0,1,0] op_sel_hi:[1,1,0]
    v_pk_fma_f32 v[130:131], v[130:131], v[16:17], v[16:17] op_sel:[0,1,0] op_sel_hi:[1,1,0]
    s_waitcnt lgkmcnt(0)
    v_pk_fma_f32 v[132:133], v[132:133], v[20:21], v[20:21] op_sel:[0,1,0] op_sel_hi:[1,1,0]
    v_pk_fma_f32 v[134:135], v[134:135], v[20:21], v[20:21] op_sel:[0,1,0] op_sel_hi:[1,1,0]
    v_pk_mul_f32 v[128:129], v[128:129], v[96:97]
    v_pk_mul_f32 v[130:131], v[130:131], v[98:99]
    v_pk_mul_f32 v[132:133], v[132:133], v[100:101]
    v_pk_mul_f32 v[134:135], v[134:135], v[102:103]
    v_exp_f32 v128, v128
    v_exp_f32 v129, v129
    v_exp_f32 v130, v130
    v_exp_f32 v131, v131
    v_exp_f32 v132, v132
    v_exp_f32 v133, v133
    v_exp_f32 v134, v134
    v_exp_f32 v135, v135
    v_pk_mul_f32 v[96:97], v[96:97], v[104:105]
    v_pk_mul_f32 v[98:99], v[98:99], v[106:107]
    v_pk_mul_f32 v[100:101], v[100:101], v[108:109]
    v_pk_mul_f32 v[102:103], v[102:103], v[110:111]
    v_pk_fma_f32 v[128:129], v[128:129], v[18:19], v[18:19] op_sel_hi:[1,0,0]
    v_pk_fma_f32 v[130:131], v[130:131], v[18:19], v[18:19] op_sel_hi:[1,0,0]
    v_pk_fma_f32 v[132:133], v[132:133], v[22:23], v[22:23] op_sel_hi:[1,0,0]
    v_pk_fma_f32 v[134:135], v[134:135], v[22:23], v[22:23] op_sel_hi:[1,0,0]
    v_rcp_f32 v128, v128
    v_rcp_f32 v129, v129
    v_rcp_f32 v130, v130
    v_rcp_f32 v131, v131
    v_rcp_f32 v132, v132
    v_rcp_f32 v133, v133
    v_rcp_f32 v134, v134
    v_rcp_f32 v135, v135
    v_pk_mul_f32 v[96:97], v[96:97], v[128:129]
    v_pk_mul_f32 v[98:99], v[98:99], v[130:131]
    v_pk_mul_f32 v[100:101], v[100:101], v[132:133]
    v_pk_mul_f32 v[102:103], v[102:103], v[134:135]
    v_cvt_pk_bf16_f32 v136, v96, v97
    v_cvt_pk_bf16_f32 v138, v100, v101
    v_cvt_pk_bf16_f32 v137, v98, v99
    v_cvt_pk_bf16_f32 v139, v102, v103
    v_add_f32 v112, v112, v30
    v_add_f32 v113, v113, v30
    v_add_f32 v114, v114, v30
    v_add_f32 v115, v115, v30
    v_permlane16_swap_b32 v136, v138
    v_permlane16_swap_b32 v137, v139
    buffer_store_dwordx4 v[136:139], v12, s[32:35], s58 offen sc1
    v_add_f32 v128, v112, v120
    v_sub_f32 v132, v112, v120
    v_add_f32 v129, v113, v121
    v_sub_f32 v133, v113, v121
    v_add_f32 v130, v114, v122
    v_sub_f32 v134, v114, v122
    v_add_f32 v131, v115, v123
    v_sub_f32 v135, v115, v123
    v_cvt_pk_bf16_f32 v112, v128, v129
    v_cvt_pk_bf16_f32 v113, v130, v131
    v_cvt_pk_bf16_f32 v122, v135, v134
    v_cvt_pk_bf16_f32 v123, v133, v132
    v_add_f32 v116, v116, v31
    v_add_f32 v117, v117, v31
    v_add_f32 v118, v118, v31
    v_add_f32 v119, v119, v31
    v_add_f32 v128, v116, v124
    v_sub_f32 v132, v116, v124
    v_add_f32 v129, v117, v125
    v_sub_f32 v133, v117, v125
    v_add_f32 v130, v118, v126
    v_sub_f32 v134, v118, v126
    v_add_f32 v131, v119, v127
    v_sub_f32 v135, v119, v127
    v_cvt_pk_bf16_f32 v114, v128, v129
    v_cvt_pk_bf16_f32 v115, v130, v131
    v_cvt_pk_bf16_f32 v120, v135, v134
    v_cvt_pk_bf16_f32 v121, v133, v132
    v_permlane16_swap_b32 v112, v114
    v_permlane16_swap_b32 v113, v115
    buffer_store_dwordx4 v[112:115], v13, s[24:27], s59 offen offset:1024 sc1
    v_permlane16_swap_b32 v122, v120
    v_permlane16_swap_b32 v123, v121
    buffer_store_dwordx4 v[120:123], v14, s[24:27], s60 offen offset:1024 sc1
    s_branch L_join3
L_notz:
    s_and_b32 s61, s2, 1
    s_bfe_u32 s60, s2, 0x60001
    s_and_b32 s44, s60, 3
    s_lshl_b32 s44, s44, 1
    s_bfe_u32 s45, s60, 0x10002
    s_add_u32 s44, s44, s45
    s_andn2_b32 s45, s60, 7
    s_add_u32 s44, s44, s45
    s_cmp_lt_u32 s60, 40
    s_cselect_b32 s60, s44, s60
    s_bfe_u32 s44, s2, 0x20001
    s_mul_i32 s44, s44, 11
    s_bfe_u32 s45, s2, 0x40003
    s_add_u32 s60, s44, s45
    s_mul_i32 s44, s40, 11008
    s_lshl_b32 s45, s60, 6
    s_add_u32 s66, s44, s45
    v_lshrrev_b32 v10, 2, v1
    v_mul_u32_u24 v30, 44032, v10
    v_and_b32 v11, 3, v1
    v_and_b32 v12, 1, v2
    v_lshlrev_b32 v12, 1, v12
    v_xor_b32 v13, v11, v12
    v_lshl_add_u32 v30, v13, 4, v30
    s_lshl_b32 s67, s40, 13
    s_mov_b32 s38, 1409024
    s_mov_b32 s39, 0x20000
    s_bfe_u32 s64, s2, 0x40003
    s_lshl_b32 s64, s64, 2
    s_add_u32 s64, s64, s40
    s_mul_i32 s64, s64, 33024
    s_bfe_u32 s46, s2, 0x20001
    s_mul_i32 s46, s46, 704
    s_add_u32 s64, s64, s46
    s_add_u32 s65, s64, 22016
    v_and_b32 v14, 7, v1
    v_lshlrev_b32 v14, 7, v14
    v_min_u32 v14, 700, v14
    v_lshrrev_b32 v15, 3, v1
    v_mul_u32_u24 v15, 2752, v15
    v_add_u32 v14, v14, v15
    s_waitcnt lgkmcnt(0)
    s_cmp_eq_u32 s61, 0
    s_cselect_b32 s36, s12, s14
    s_cselect_b32 s37, s13, s15
    s_and_b32 s37, s37, 0xffff
    s_mov_b32 exec_lo, 0x7f7f7f7f
    s_mov_b32 exec_hi, 0x7f7f7f7f
    buffer_load_dword v5, v14, s[36:39], s64 offen
    s_mov_b32 exec_hi, 0
    buffer_load_dword v248, v14, s[36:39], s65 offen
    s_mov_b64 exec, -1
    s_mov_b32 s28, s16
    s_and_b32 s29, s17, 0xffff
    s_mov_b32 s30, 1409024
    s_mov_b32 s31, 0x20000
    s_sub_u32 s44, s2, 128
    s_lshl_b32 s44, s44, 14
    s_lshr_b32 s45, s40, 1
    s_lshl_b32 s45, s45, 13
    s_add_u32 s44, s44, s45
    s_and_b32 s45, s40, 1
    s_lshl_b32 s45, s45, 9
    s_add_u32 s69, s44, s45
    s_add_u32 s70, s69, 4096
    v_lshlrev_b32 v13, 3, v1
    buffer_load_dwordx2 v[128:129], v13, s[28:31], s69 offen offset:0 nt
    buffer_load_dwordx2 v[130:131], v13, s[28:31], s69 offen offset:1024 nt
    buffer_load_dwordx2 v[132:133], v13, s[28:31], s69 offen offset:2048 nt
    buffer_load_dwordx2 v[134:135], v13, s[28:31], s69 offen offset:3072 nt
    buffer_load_dwordx2 v[136:137], v13, s[28:31], s70 offen offset:0 nt
    buffer_load_dwordx2 v[138:139], v13, s[28:31], s70 offen offset:1024 nt
    buffer_load_dwordx2 v[140:141], v13, s[28:31], s70 offen offset:2048 nt
    buffer_load_dwordx2 v[142:143], v13, s[28:31], s70 offen offset:3072 nt
    v_mov_b32 v249, v30
    s_mov_b32 s24, s22
    s_and_b32 s25, s23, 0xffff
    s_mov_b32 s26, 22626304
    s_mov_b32 s27, 0x20000
    v_lshlrev_b32 v31, 6, v10
    v_lshl_add_u32 v31, v12, 4, v31
    v_lshl_add_u32 v31, v11, 3, v31
    v_add_u32 v30, s67, v31
    v_xor_b32 v31, 32, v30
    v_mul_u32_u24 v6, 4160, v2
    v_lshl_add_u32 v6, v3, 4, v6
    s_lshl_b32 s44, s40, 8
    s_add_u32 s44, s44, 32768
    v_add_u32 v6, s44, v6
    s_mul_i32 s44, s40, 4160
    s_add_u32 s44, s44, 32768
    v_add_u32 v7, s44, v4
    s_lshl_b32 s44, s60, 2
    v_lshrrev_b32 v12, 3, v3
    v_and_b32 v13, 7, v3
    v_lshlrev_b32 v13, 4, v13
    v_lshl_add_u32 v13, v2, 8, v13
    s_lshl_b32 s45, s40, 12
    s_add_u32 s68, s45, 7487488
    v_mov_b32 v19, s61
    v_add_u32 v14, s44, v12
    v_mul_u32_u24 v15, 373, v14
    v_lshrrev_b32 v15, 12, v15
    v_add_u32 v14, v14, v15
    v_mul_u32_u24 v15, 171, v14
    v_lshrrev_b32 v15, 9, v15
    v_mul_u32_u24 v15, 3, v15
    v_sub_u32 v16, v14, v15
    v_cmp_eq_u32 vcc, 2, v16
    v_add_u32 v15, s61, v15
    s_add_u32 s44, s44, 2
    v_cndmask_b32 v15, v15, v14, vcc
    v_cndmask_b32 v16, v16, v19, vcc
    v_mul_u32_u24 v15, 16384, v15
    v_add_u32 v8, v15, v13
    v_lshl_add_u32 v8, v16, 7, v8
    v_add_u32 v14, s44, v12
    v_mul_u32_u24 v15, 373, v14
    v_lshrrev_b32 v15, 12, v15
    v_add_u32 v14, v14, v15
    v_mul_u32_u24 v15, 171, v14
    v_lshrrev_b32 v15, 9, v15
    v_mul_u32_u24 v15, 3, v15
    v_sub_u32 v16, v14, v15
    v_cmp_eq_u32 vcc, 2, v16
    v_add_u32 v15, s61, v15
    s_add_u32 s44, s44, 2
    v_cndmask_b32 v15, v15, v14, vcc
    v_cndmask_b32 v16, v16, v19, vcc
    v_mul_u32_u24 v15, 16384, v15
    v_add_u32 v9, v15, v13
    v_lshl_add_u32 v9, v16, 7, v9
    s_lshl_b32 s44, s40, 13
    s_add_u32 s44, s44, 6144
    s_add_u32 s46, s42, s44
    s_addc_u32 s47, s43, 0
    v_mov_b32 v27, s47
    v_add_co_u32 v26, vcc, s46, v4
    s_nop 1
    v_addc_co_u32 v27, vcc, 0, v27, vcc
    s_add_u32 s46, s42, 38912
    s_addc_u32 s47, s43, 0
    v_mov_b32 v29, s47
    v_add_co_u32 v28, vcc, s46, v4
    s_nop 1
    v_addc_co_u32 v29, vcc, 0, v29, vcc
    s_and_b32 s44, s2, 1
    s_lshl_b32 s44, s44, 3
    s_bfe_u32 s45, s2, 0x30003
    s_add_u32 s48, s44, s45
    s_bfe_u32 s44, s2, 0x20001
    s_lshl_b32 s44, s44, 2
    s_lshr_b32 s46, s2, 6
    s_add_u32 s49, s44, s46
    s_lshl_b32 s46, s46, 1
    s_mov_b32 s53, 0
    s_lshl_b32 s46, s48, 11
    s_lshl_b32 s47, s49, 7
    s_add_u32 s41, s46, s47
    s_add_u32 s41, s41, 65536
    v_mov_b32 v250, 0
    s_and_b32 s74, s2, 7
    s_lshl_b32 s74, s74, 8
    s_add_u32 s75, s74, 4096
    s_and_b32 s44, s2, 1
    s_mul_i32 s44, s44, 44
    s_bfe_u32 s45, s2, 0x20001
    s_mul_i32 s45, s45, 11
    s_add_u32 s44, s44, s45
    s_bfe_u32 s45, s2, 0x40003
    s_add_u32 s44, s44, s45
    s_sub_u32 s45, s2, 160
    s_cmp_ge_u32 s2, 248
    s_cselect_b32 s44, s45, s44
    s_cselect_b32 s46, 0, s2
    s_lshl_b32 s44, s44, 7
    s_add_u32 s71, s44, 20480
    s_cmp_lt_u32 s2, 128
    s_cselect_b32 s71, 0, s71
    s_cmp_ge_u32 s46, 216
    s_cselect_b32 s71, 0, s71
    v_mov_b32 v251, 1
    s_mov_b32 s63, 0x80008000
    s_mul_i32 s44, s49, 11
    s_add_u32 s45, s44, 10
    s_lshr_b32 s44, s44, 2
    s_lshr_b32 s45, s45, 2
    v_and_b32 v23, 3, v1
    v_add_u32 v23, s44, v23
    v_min_u32 v23, s45, v23
    v_bfe_u32 v240, v1, 2, 1
    v_mul_u32_u24 v240, 44, v240
    v_add_u32 v23, v23, v240
    s_lshr_b32 s44, s49, 1
    s_add_u32 s44, s44, 88
    v_mov_b32 v240, s44
    v_cmp_gt_u32 vcc, 8, v1
    s_nop 1
    v_cndmask_b32 v23, v240, v23, vcc
    v_lshlrev_b32 v23, 7, v23
    v_add_u32 v23, 20480, v23
    s_add_u32 s45, s40, 0
    s_and_b32 s45, s45, 3
    s_lshl_b32 s45, s45, 11
    v_add_u32 v16, s45, v4
    s_add_u32 s45, s40, 1
    s_and_b32 s45, s45, 3
    s_lshl_b32 s45, s45, 11
    v_add_u32 v17, s45, v4
    s_add_u32 s45, s40, 2
    s_and_b32 s45, s45, 3
    s_lshl_b32 s45, s45, 11
    v_add_u32 v18, s45, v4
    s_add_u32 s45, s40, 3
    s_and_b32 s45, s45, 3
    s_lshl_b32 s45, s45, 11
    v_add_u32 v19, s45, v4
    s_and_b32 s58, s2, 0xf6
    s_bfe_u32 s45, s2, 0x10003
    s_add_u32 s58, s58, s45
    s_and_b32 s45, s2, 1
    s_lshl_b32 s45, s45, 3
    s_add_u32 s58, s58, s45
    s_lshl_b32 s44, s58, 6
    s_lshl_b32 s45, s40, 19
    s_add_u32 s44, s44, s45
    s_add_u32 s55, s44, 131072
    s_add_u32 s56, s55, 0x10000
    s_lshr_b32 s44, s58, 4
    s_sub_u32 s45, 32, s44
    s_cmp_eq_u32 s44, 0
    s_cselect_b32 s45, 16, s45
    s_bitcmp1_b32 s58, 3
    s_cselect_b32 s44, s45, s44
    s_and_b32 s45, s58, 7
    s_lshl_b32 s45, s45, 5
    s_add_u32 s44, s44, s45
    s_sub_u32 s44, s44, 1
    s_and_b32 s44, s44, 255
    s_lshl_b32 s44, s44, 7
    s_lshl_b32 s45, s40, 16
    s_add_u32 s44, s44, s45
    s_add_u32 s59, s44, 2752512
    s_add_u32 s60, s59, 0x100000
    v_and_b32 v15, 7, v1
    v_lshlrev_b32 v15, 4, v15
    v_bfe_u32 v14, v1, 3, 1
    v_lshl_add_u32 v15, v14, 15, v15
    v_lshl_add_u32 v15, v2, 18, v15
    s_lshl_b32 s45, s40, 12
    s_add_u32 s61, s45, 5373952
    v_lshrrev_b32 v21, 2, v3
    v_lshlrev_b32 v21, 7, v21
    v_lshl_add_u32 v21, v2, 10, v21
    v_and_b32 v22, 3, v1
    v_lshlrev_b32 v14, 4, v22
    v_lshl_add_u32 v14, v21, 7, v14
    v_lshl_add_u32 v22, v22, 4, v21
    s_mov_b32 s63, 0x80008000
    v_cmp_gt_u32 vcc, 8, v3
    v_and_b32 v176, 7, v3
    v_lshlrev_b32 v176, 5, v176
    v_mov_b32 v177, 0x80008000
    v_cndmask_b32 v178, 0, v177, vcc
    v_cndmask_b32 v179, v177, 0, vcc
    v_lshl_add_u32 v180, v2, 3, 1
    v_cvt_f32_u32 v180, v180
    v_mul_f32 v180, 0x3a800000, v180
    v_add_f32 v181, 0x3b000000, v180
    v_add_f32 v182, 0x3b800000, v180
    v_add_f32 v183, 0x3bc00000, v180
    s_lshl_b32 s46, s40, 2
    v_cndmask_b32 v177, -1.0, 1.0, vcc
    s_sub_u32 s47, 32, s46
    v_mov_b32 v184, s47
    v_mov_b32 v185, s46
    v_cndmask_b32 v184, v184, v185, vcc
    v_add_u32 v184, v184, v176
    v_cvt_f32_u32 v184, v184
    v_mul_f32 v186, v184, v180
    v_fract_f32 v186, v186
    v_mul_f32 v187, v184, v181
    v_fract_f32 v187, v187
    v_mul_f32 v188, v184, v182
    v_fract_f32 v188, v188
    v_mul_f32 v189, v184, v183
    v_fract_f32 v189, v189
    v_sin_f32 v190, v186
    v_cos_f32 v186, v186
    v_sin_f32 v191, v187
    v_cos_f32 v187, v187
    v_sin_f32 v192, v188
    v_cos_f32 v188, v188
    v_sin_f32 v193, v189
    v_cos_f32 v189, v189
    v_cvt_pk_bf16_f32 v144, v186, v187
    v_cvt_pk_bf16_f32 v148, -v190, -v191
    v_cvt_pk_bf16_f32 v145, v188, v189
    v_cvt_pk_bf16_f32 v149, -v192, -v193
    v_xor_b32 v146, v148, v178
    v_xor_b32 v150, v144, v179
    v_xor_b32 v147, v149, v178
    v_xor_b32 v151, v145, v179
    v_add_f32 v184, v184, v177
    v_mul_f32 v186, v184, v180
    v_fract_f32 v186, v186
    v_mul_f32 v187, v184, v181
    v_fract_f32 v187, v187
    v_mul_f32 v188, v184, v182
    v_fract_f32 v188, v188
    v_mul_f32 v189, v184, v183
    v_fract_f32 v189, v189
    v_sin_f32 v190, v186
    v_cos_f32 v186, v186
    v_sin_f32 v191, v187
    v_cos_f32 v187, v187
    v_sin_f32 v192, v188
    v_cos_f32 v188, v188
    v_sin_f32 v193, v189
    v_cos_f32 v189, v189
    v_cvt_pk_bf16_f32 v152, v186, v187
    v_cvt_pk_bf16_f32 v156, -v190, -v191
    v_cvt_pk_bf16_f32 v153, v188, v189
    v_cvt_pk_bf16_f32 v157, -v192, -v193
    v_xor_b32 v154, v156, v178
    v_xor_b32 v158, v152, v179
    v_xor_b32 v155, v157, v178
    v_xor_b32 v159, v153, v179
    v_add_f32 v184, v184, v177
    v_mul_f32 v186, v184, v180
    v_fract_f32 v186, v186
    v_mul_f32 v187, v184, v181
    v_fract_f32 v187, v187
    v_mul_f32 v188, v184, v182
    v_fract_f32 v188, v188
    v_mul_f32 v189, v184, v183
    v_fract_f32 v189, v189
    v_sin_f32 v190, v186
    v_cos_f32 v186, v186
    v_sin_f32 v191, v187
    v_cos_f32 v187, v187
    v_sin_f32 v192, v188
    v_cos_f32 v188, v188
    v_sin_f32 v193, v189
    v_cos_f32 v189, v189
    v_cvt_pk_bf16_f32 v160, v186, v187
    v_cvt_pk_bf16_f32 v164, -v190, -v191
    v_cvt_pk_bf16_f32 v161, v188, v189
    v_cvt_pk_bf16_f32 v165, -v192, -v193
    v_xor_b32 v162, v164, v178
    v_xor_b32 v166, v160, v179
    v_xor_b32 v163, v165, v178
    v_xor_b32 v167, v161, v179
    v_add_f32 v184, v184, v177
    v_mul_f32 v186, v184, v180
    v_fract_f32 v186, v186
    v_mul_f32 v187, v184, v181
    v_fract_f32 v187, v187
    v_mul_f32 v188, v184, v182
    v_fract_f32 v188, v188
    v_mul_f32 v189, v184, v183
    v_fract_f32 v189, v189
    v_sin_f32 v190, v186
    v_cos_f32 v186, v186
    v_sin_f32 v191, v187
    v_cos_f32 v187, v187
    v_sin_f32 v192, v188
    v_cos_f32 v188, v188
    v_sin_f32 v193, v189
    v_cos_f32 v189, v189
    v_cvt_pk_bf16_f32 v168, v186, v187
    v_cvt_pk_bf16_f32 v172, -v190, -v191
    v_cvt_pk_bf16_f32 v169, v188, v189
    v_cvt_pk_bf16_f32 v173, -v192, -v193
    v_xor_b32 v170, v172, v178
    v_xor_b32 v174, v168, v179
    v_xor_b32 v171, v173, v178
    v_xor_b32 v175, v169, v179
    s_cmp_lg_u32 s40, 0
    s_cbranch_scc1 L_ow19
    v_cmp_gt_u32 vcc, 8, v3
    v_add_u32 v184, 16, v176
    v_cmp_eq_u32 s[46:47], 0, v3
    v_cndmask_b32 v184, v184, v176, vcc
    v_mov_b32 v185, 0x100
    v_mov_b32 v194, 0x3f3504f3
    v_mov_b32 v195, 0x00000000
    v_cndmask_b32 v184, v184, v185, s[46:47]
    v_cndmask_b32 v194, 1.0, v194, s[46:47]
    v_cndmask_b32 v195, 0, v195, s[46:47]
    v_cvt_f32_u32 v184, v184
    v_fma_f32 v186, v184, v180, v195
    v_fract_f32 v186, v186
    v_fma_f32 v187, v184, v181, v195
    v_fract_f32 v187, v187
    v_fma_f32 v188, v184, v182, v195
    v_fract_f32 v188, v188
    v_fma_f32 v189, v184, v183, v195
    v_fract_f32 v189, v189
    v_sin_f32 v190, v186
    v_cos_f32 v186, v186
    v_sin_f32 v191, v187
    v_cos_f32 v187, v187
    v_sin_f32 v192, v188
    v_cos_f32 v188, v188
    v_sin_f32 v193, v189
    v_cos_f32 v189, v189
    v_mul_f32 v186, v186, v194
    v_mul_f32 v187, v187, v194
    v_mul_f32 v188, v188, v194
    v_mul_f32 v189, v189, v194
    v_mul_f32 v190, v190, v194
    v_mul_f32 v191, v191, v194
    v_mul_f32 v192, v192, v194
    v_mul_f32 v193, v193, v194
    v_cvt_pk_bf16_f32 v144, v186, v187
    v_cvt_pk_bf16_f32 v148, -v190, -v191
    v_cvt_pk_bf16_f32 v145, v188, v189
    v_cvt_pk_bf16_f32 v149, -v192, -v193
    v_cndmask_b32 v146, v144, 0, vcc
    v_cndmask_b32 v144, 0, v144, vcc
    v_cndmask_b32 v147, v145, 0, vcc
    v_cndmask_b32 v145, 0, v145, vcc
    v_cndmask_b32 v150, v148, 0, vcc
    v_cndmask_b32 v148, 0, v148, vcc
    v_cndmask_b32 v151, v149, 0, vcc
    v_cndmask_b32 v149, 0, v149, vcc
    s_nop 4
    s_mov_b64 exec, -1
L_ow19:
    v_accvgpr_write_b32 a208, v144
    v_accvgpr_write_b32 a209, v145
    v_accvgpr_write_b32 a210, v146
    v_accvgpr_write_b32 a211, v147
    v_accvgpr_write_b32 a212, v148
    v_accvgpr_write_b32 a213, v149
    v_accvgpr_write_b32 a214, v150
    v_accvgpr_write_b32 a215, v151
    v_accvgpr_write_b32 a216, v152
    v_accvgpr_write_b32 a217, v153
    v_accvgpr_write_b32 a218, v154
    v_accvgpr_write_b32 a219, v155
    v_accvgpr_write_b32 a220, v156
    v_accvgpr_write_b32 a221, v157
    v_accvgpr_write_b32 a222, v158
    v_accvgpr_write_b32 a223, v159
    v_accvgpr_write_b32 a224, v160
    v_accvgpr_write_b32 a225, v161
    v_accvgpr_write_b32 a226, v162
    v_accvgpr_write_b32 a227, v163
    v_accvgpr_write_b32 a228, v164
    v_accvgpr_write_b32 a229, v165
    v_accvgpr_write_b32 a230, v166
    v_accvgpr_write_b32 a231, v167
    v_accvgpr_write_b32 a232, v168
    v_accvgpr_write_b32 a233, v169
    v_accvgpr_write_b32 a234, v170
    v_accvgpr_write_b32 a235, v171
    v_accvgpr_write_b32 a236, v172
    v_accvgpr_write_b32 a237, v173
    v_accvgpr_write_b32 a238, v174
    v_accvgpr_write_b32 a239, v175
    s_add_u32 m0, s67, 0
    s_add_u32 s44, s66, 0
    buffer_load_dwordx4 v249, s[36:39], s44 offen lds
    s_add_u32 m0, s67, 1024
    s_add_u32 s44, s66, 704512
    buffer_load_dwordx4 v249, s[36:39], s44 offen lds
    s_add_u32 m0, s67, 2048
    s_add_u32 s44, s66, 2752
    buffer_load_dwordx4 v249, s[36:39], s44 offen lds
    s_add_u32 m0, s67, 3072
    s_add_u32 s44, s66, 707264
    buffer_load_dwordx4 v249, s[36:39], s44 offen lds
    s_add_u32 m0, s67, 4096
    s_add_u32 s44, s66, 5504
    buffer_load_dwordx4 v249, s[36:39], s44 offen lds
    s_add_u32 m0, s67, 5120
    s_add_u32 s44, s66, 710016
    buffer_load_dwordx4 v249, s[36:39], s44 offen lds
    s_add_u32 m0, s67, 6144
    s_add_u32 s44, s66, 8256
    buffer_load_dwordx4 v249, s[36:39], s44 offen lds
    s_add_u32 m0, s67, 7168
    s_add_u32 s44, s66, 712768
    buffer_load_dwordx4 v249, s[36:39], s44 offen lds
    s_waitcnt vmcnt(6)
    ds_read_b64_tr_b16 v[32:33], v30 offset:0
    ds_read_b64_tr_b16 v[34:35], v30 offset:1024
    ds_read_b64_tr_b16 v[36:37], v31 offset:0
    ds_read_b64_tr_b16 v[38:39], v31 offset:1024
    s_waitcnt vmcnt(4)
    ds_read_b64_tr_b16 v[40:41], v30 offset:2048
    ds_read_b64_tr_b16 v[42:43], v30 offset:3072
    ds_read_b64_tr_b16 v[44:45], v31 offset:2048
    ds_read_b64_tr_b16 v[46:47], v31 offset:3072
    s_waitcnt vmcnt(2)
    ds_read_b64_tr_b16 v[48:49], v30 offset:4096
    ds_read_b64_tr_b16 v[50:51], v30 offset:5120
    ds_read_b64_tr_b16 v[52:53], v31 offset:4096
    ds_read_b64_tr_b16 v[54:55], v31 offset:5120
    s_waitcnt vmcnt(0)
    ds_read_b64_tr_b16 v[56:57], v30 offset:6144
    ds_read_b64_tr_b16 v[58:59], v30 offset:7168
    ds_read_b64_tr_b16 v[60:61], v31 offset:6144
    ds_read_b64_tr_b16 v[62:63], v31 offset:7168
    s_waitcnt lgkmcnt(14)
    v_mfma_f32_16x16x32_bf16 v[64:67], a[200:203], v[32:35], 0
    global_load_dwordx4 v[146:149], v[26:27], off offset:-4096
    v_mfma_f32_16x16x32_bf16 v[80:83], a[204:207], v[32:35], 0
    s_waitcnt lgkmcnt(12)
    v_mfma_f32_16x16x32_bf16 v[96:99], a[200:203], v[36:39], 0
    global_load_dwordx4 v[152:155], v[26:27], off offset:-3072
    v_mfma_f32_16x16x32_bf16 v[112:115], a[204:207], v[36:39], 0
    s_waitcnt lgkmcnt(10)
    v_mfma_f32_16x16x32_bf16 v[68:71], a[200:203], v[40:43], 0
    global_load_dwordx4 v[158:161], v[26:27], off offset:-2048
    v_mfma_f32_16x16x32_bf16 v[84:87], a[204:207], v[40:43], 0
    s_waitcnt lgkmcnt(8)
    v_mfma_f32_16x16x32_bf16 v[100:103], a[200:203], v[44:47], 0
    global_load_dwordx4 v[164:167], v[26:27], off offset:-1024
    v_mfma_f32_16x16x32_bf16 v[116:119], a[204:207], v[44:47], 0
    s_waitcnt lgkmcnt(6)
    v_mfma_f32_16x16x32_bf16 v[72:75], a[200:203], v[48:51], 0
    global_load_dwordx4 v[194:197], v[28:29], off offset:-4096
    v_mfma_f32_16x16x32_bf16 v[88:91], a[204:207], v[48:51], 0
    s_waitcnt lgkmcnt(4)
    v_mfma_f32_16x16x32_bf16 v[104:107], a[200:203], v[52:55], 0
    global_load_dwordx4 v[200:203], v[28:29], off offset:-3072
    v_mfma_f32_16x16x32_bf16 v[120:123], a[204:207], v[52:55], 0
    s_waitcnt lgkmcnt(2)
    v_mfma_f32_16x16x32_bf16 v[76:79], a[200:203], v[56:59], 0
    global_load_dwordx4 v[206:209], v[28:29], off offset:-2048
    v_mfma_f32_16x16x32_bf16 v[92:95], a[204:207], v[56:59], 0
    s_waitcnt lgkmcnt(0)
    v_mfma_f32_16x16x32_bf16 v[108:111], a[200:203], v[60:63], 0
    global_load_dwordx4 v[212:215], v[28:29], off offset:-1024
    v_mfma_f32_16x16x32_bf16 v[124:127], a[204:207], v[60:63], 0
    v_cvt_pk_bf16_f32 v32, v64, v68
    s_nop 0
    v_cvt_pk_bf16_f32 v33, v72, v76
    global_load_dwordx4 v[218:221], v[28:29], off offset:0
    v_cvt_pk_bf16_f32 v34, v80, v84
    v_cvt_pk_bf16_f32 v35, v88, v92
    ds_write_b128 v6, v[32:35] offset:0
    v_cvt_pk_bf16_f32 v36, v65, v69
    v_cvt_pk_bf16_f32 v37, v73, v77
    v_cvt_pk_bf16_f32 v38, v81, v85
    v_cvt_pk_bf16_f32 v39, v89, v93
    global_load_dwordx4 v[224:227], v[28:29], off offset:1024
    ds_write_b128 v6, v[36:39] offset:1040
    v_cvt_pk_bf16_f32 v40, v66, v70
    v_cvt_pk_bf16_f32 v41, v74, v78
    v_cvt_pk_bf16_f32 v42, v82, v86
    v_cvt_pk_bf16_f32 v43, v90, v94
    ds_write_b128 v6, v[40:43] offset:2080
    v_cvt_pk_bf16_f32 v44, v67, v71
    global_load_dwordx4 v[230:233], v[28:29], off offset:2048
    v_cvt_pk_bf16_f32 v45, v75, v79
    v_cvt_pk_bf16_f32 v46, v83, v87
    v_cvt_pk_bf16_f32 v47, v91, v95
    ds_write_b128 v6, v[44:47] offset:3120
    v_cvt_pk_bf16_f32 v48, v96, v100
    v_cvt_pk_bf16_f32 v49, v104, v108
    v_cvt_pk_bf16_f32 v50, v112, v116
    global_load_dwordx4 v[236:239], v[28:29], off offset:3072
    v_cvt_pk_bf16_f32 v51, v120, v124
    ds_write_b128 v6, v[48:51] offset:16640
    v_cvt_pk_bf16_f32 v52, v97, v101
    v_cvt_pk_bf16_f32 v53, v105, v109
    v_cvt_pk_bf16_f32 v54, v113, v117
    v_cvt_pk_bf16_f32 v55, v121, v125
    ds_write_b128 v6, v[52:55] offset:17680
    global_load_dwordx4 v[170:173], v[26:27], off offset:0
    v_cvt_pk_bf16_f32 v56, v98, v102
    v_cvt_pk_bf16_f32 v57, v106, v110
    v_cvt_pk_bf16_f32 v58, v114, v118
    v_cvt_pk_bf16_f32 v59, v122, v126
    ds_write_b128 v6, v[56:59] offset:18720
    v_cvt_pk_bf16_f32 v60, v99, v103
    v_cvt_pk_bf16_f32 v61, v107, v111
    global_load_dwordx4 v[176:179], v[26:27], off offset:1024
    v_cvt_pk_bf16_f32 v62, v115, v119
    v_cvt_pk_bf16_f32 v63, v123, v127
    ds_write_b128 v6, v[60:63] offset:19760
    global_load_dwordx4 v[182:185], v[26:27], off offset:2048
    global_load_dwordx4 v[188:191], v[26:27], off offset:3072
    s_waitcnt lgkmcnt(0)
    s_barrier
    ds_read_b128 v[32:35], v7 offset:0
    ds_read_b128 v[36:39], v7 offset:1040
    ds_read_b128 v[40:43], v7 offset:2080
    ds_read_b128 v[44:47], v7 offset:3120
    ds_read_b128 v[48:51], v7 offset:16640
    ds_read_b128 v[52:55], v7 offset:17680
    ds_read_b128 v[56:59], v7 offset:18720
    ds_read_b128 v[60:63], v7 offset:19760
    v_mov_b32 v250, 0
    global_load_dword v254, v250, s[20:21] sc1
    s_waitcnt lgkmcnt(7)
    v_mfma_f32_16x16x32_bf16 v[64:67], a[208:211], v[32:35], 0
    v_mfma_f32_16x16x32_bf16 v[68:71], a[212:215], v[32:35], 0
    s_waitcnt lgkmcnt(6)
    v_mfma_f32_16x16x32_bf16 v[72:75], a[216:219], v[36:39], 0
    v_mfma_f32_16x16x32_bf16 v[76:79], a[220:223], v[36:39], 0
    s_waitcnt lgkmcnt(5)
    v_mfma_f32_16x16x32_bf16 v[80:83], a[224:227], v[40:43], 0
    v_mfma_f32_16x16x32_bf16 v[84:87], a[228:231], v[40:43], 0
    s_waitcnt lgkmcnt(4)
    v_mfma_f32_16x16x32_bf16 v[88:91], a[232:235], v[44:47], 0
    v_mfma_f32_16x16x32_bf16 v[92:95], a[236:239], v[44:47], 0
    s_waitcnt lgkmcnt(3)
    v_mfma_f32_16x16x32_bf16 v[96:99], a[208:211], v[48:51], 0
    v_mfma_f32_16x16x32_bf16 v[100:103], a[212:215], v[48:51], 0
    s_waitcnt lgkmcnt(2)
    v_mfma_f32_16x16x32_bf16 v[104:107], a[216:219], v[52:55], 0
    v_mfma_f32_16x16x32_bf16 v[108:111], a[220:223], v[52:55], 0
    s_waitcnt lgkmcnt(1)
    v_mfma_f32_16x16x32_bf16 v[112:115], a[224:227], v[56:59], 0
    v_mfma_f32_16x16x32_bf16 v[116:119], a[228:231], v[56:59], 0
    s_waitcnt lgkmcnt(0)
    v_mfma_f32_16x16x32_bf16 v[120:123], a[232:235], v[60:63], 0
    v_mfma_f32_16x16x32_bf16 v[124:127], a[236:239], v[60:63], 0
    v_cvt_pk_bf16_f32 v32, v64, v65
    v_cvt_pk_bf16_f32 v33, v66, v67
    v_cvt_pk_bf16_f32 v34, v72, v73
    v_cvt_pk_bf16_f32 v35, v74, v75
    buffer_store_dwordx4 v[32:35], v8, s[24:27], s68 offen offset:0 sc1
    v_cvt_pk_bf16_f32 v36, v68, v69
    v_cvt_pk_bf16_f32 v37, v70, v71
    v_cvt_pk_bf16_f32 v38, v76, v77
    v_cvt_pk_bf16_f32 v39, v78, v79
    buffer_store_dwordx4 v[36:39], v8, s[24:27], s68 offen offset:1024 sc1
    v_cvt_pk_bf16_f32 v40, v80, v81
    v_cvt_pk_bf16_f32 v41, v82, v83
    v_cvt_pk_bf16_f32 v42, v88, v89
    v_cvt_pk_bf16_f32 v43, v90, v91
    buffer_store_dwordx4 v[40:43], v8, s[24:27], s68 offen offset:2048 sc1
    v_cvt_pk_bf16_f32 v44, v84, v85
    v_cvt_pk_bf16_f32 v45, v86, v87
    v_cvt_pk_bf16_f32 v46, v92, v93
    v_cvt_pk_bf16_f32 v47, v94, v95
    buffer_store_dwordx4 v[44:47], v8, s[24:27], s68 offen offset:3072 sc1
    v_cvt_pk_bf16_f32 v48, v96, v97
    v_cvt_pk_bf16_f32 v49, v98, v99
    v_cvt_pk_bf16_f32 v50, v104, v105
    v_cvt_pk_bf16_f32 v51, v106, v107
    buffer_store_dwordx4 v[48:51], v9, s[24:27], s68 offen offset:0 sc1
    v_cvt_pk_bf16_f32 v52, v100, v101
    v_cvt_pk_bf16_f32 v53, v102, v103
    v_cvt_pk_bf16_f32 v54, v108, v109
    v_cvt_pk_bf16_f32 v55, v110, v111
    buffer_store_dwordx4 v[52:55], v9, s[24:27], s68 offen offset:1024 sc1
    v_cvt_pk_bf16_f32 v56, v112, v113
    v_cvt_pk_bf16_f32 v57, v114, v115
    v_cvt_pk_bf16_f32 v58, v120, v121
    v_cvt_pk_bf16_f32 v59, v122, v123
    buffer_store_dwordx4 v[56:59], v9, s[24:27], s68 offen offset:2048 sc1
    v_cvt_pk_bf16_f32 v60, v116, v117
    v_cvt_pk_bf16_f32 v61, v118, v119
    v_cvt_pk_bf16_f32 v62, v124, v125
    v_cvt_pk_bf16_f32 v63, v126, v127
    buffer_store_dwordx4 v[60:63], v9, s[24:27], s68 offen offset:3072 sc1
    s_mov_b32 s64, 0x05040100
    s_mov_b32 s65, 0x07060302
    v_perm_b32 v64, v130, v128, s64
    v_perm_b32 v65, v134, v132, s64
    v_perm_b32 v66, v138, v136, s64
    v_perm_b32 v67, v142, v140, s64
    v_perm_b32 v68, v130, v128, s65
    v_perm_b32 v69, v134, v132, s65
    v_perm_b32 v70, v138, v136, s65
    v_perm_b32 v71, v142, v140, s65
    v_perm_b32 v72, v131, v129, s64
    v_perm_b32 v73, v135, v133, s64
    v_perm_b32 v74, v139, v137, s64
    v_perm_b32 v75, v143, v141, s64
    v_perm_b32 v76, v131, v129, s65
    v_perm_b32 v77, v135, v133, s65
    v_perm_b32 v78, v139, v137, s65
    v_perm_b32 v79, v143, v141, s65
    s_lshl_b32 s44, s40, 4
    v_add_u32 v240, s44, v3
    v_cvt_f32_u32 v240, v240
    v_mul_f32 v240, 0x3a000000, v240
    v_lshlrev_b32 v241, 2, v2
    v_add_u32 v242, s44, v241
    v_cvt_f32_u32 v241, v241
    v_cvt_f32_u32 v242, v242
    v_cvt_f32_u32 v243, v3
    v_mul_f32 v243, 0x3a000000, v243
    v_add_f32 v112, 0x00000000, v241
    v_mul_f32 v112, v112, v240
    v_sin_f32 v116, v112
    v_cos_f32 v112, v112
    v_add_f32 v113, 0x3f800000, v241
    v_mul_f32 v113, v113, v240
    v_sin_f32 v117, v113
    v_cos_f32 v113, v113
    v_add_f32 v114, 0x40000000, v241
    v_mul_f32 v114, v114, v240
    v_sin_f32 v118, v114
    v_cos_f32 v114, v114
    v_add_f32 v115, 0x40400000, v241
    v_mul_f32 v115, v115, v240
    v_sin_f32 v119, v115
    v_cos_f32 v115, v115
    v_add_f32 v120, 0x41800000, v241
    v_mul_f32 v120, v120, v240
    v_sin_f32 v124, v120
    v_cos_f32 v120, v120
    v_add_f32 v121, 0x41880000, v241
    v_mul_f32 v121, v121, v240
    v_sin_f32 v125, v121
    v_cos_f32 v121, v121
    v_add_f32 v122, 0x41900000, v241
    v_mul_f32 v122, v122, v240
    v_sin_f32 v126, v122
    v_cos_f32 v122, v122
    v_add_f32 v123, 0x41980000, v241
    v_mul_f32 v123, v123, v240
    v_sin_f32 v127, v123
    v_cos_f32 v123, v123
    v_add_f32 v128, 0x00000000, v242
    v_mul_f32 v128, v128, v243
    v_sin_f32 v132, v128
    v_cos_f32 v128, v128
    v_add_f32 v129, 0x3f800000, v242
    v_mul_f32 v129, v129, v243
    v_sin_f32 v133, v129
    v_cos_f32 v129, v129
    v_add_f32 v130, 0x40000000, v242
    v_mul_f32 v130, v130, v243
    v_sin_f32 v134, v130
    v_cos_f32 v130, v130
    v_add_f32 v131, 0x40400000, v242
    v_mul_f32 v131, v131, v243
    v_sin_f32 v135, v131
    v_cos_f32 v131, v131
    v_add_f32 v243, 0x3c000000, v243
    v_add_f32 v136, 0x00000000, v242
    v_mul_f32 v136, v136, v243
    v_sin_f32 v140, v136
    v_cos_f32 v136, v136
    v_add_f32 v137, 0x3f800000, v242
    v_mul_f32 v137, v137, v243
    v_sin_f32 v141, v137
    v_cos_f32 v137, v137
    v_add_f32 v138, 0x40000000, v242
    v_mul_f32 v138, v138, v243
    v_sin_f32 v142, v138
    v_cos_f32 v138, v138
    v_add_f32 v139, 0x40400000, v242
    v_mul_f32 v139, v139, v243
    v_sin_f32 v143, v139
    v_cos_f32 v139, v139
    s_waitcnt vmcnt(24)
    v_xor_b32 v144, s63, v148
    v_xor_b32 v145, s63, v149
    s_waitcnt vmcnt(23)
    v_xor_b32 v150, s63, v154
    v_xor_b32 v151, s63, v155
    s_waitcnt vmcnt(22)
    v_xor_b32 v156, s63, v160
    v_xor_b32 v157, s63, v161
    s_waitcnt vmcnt(21)
    v_xor_b32 v162, s63, v166
    v_xor_b32 v163, s63, v167
    s_waitcnt vmcnt(20)
    v_xor_b32 v192, s63, v196
    v_xor_b32 v193, s63, v197
    s_waitcnt vmcnt(19)
    v_xor_b32 v198, s63, v202
    v_xor_b32 v199, s63, v203
    s_waitcnt vmcnt(18)
    v_xor_b32 v204, s63, v208
    v_xor_b32 v205, s63, v209
    s_waitcnt vmcnt(17)
    v_xor_b32 v210, s63, v214
    v_xor_b32 v211, s63, v215
    s_waitcnt vmcnt(16)
    v_xor_b32 v216, s63, v220
    v_xor_b32 v217, s63, v221
    s_waitcnt vmcnt(15)
    v_xor_b32 v222, s63, v226
    v_xor_b32 v223, s63, v227
    s_waitcnt vmcnt(14)
    v_xor_b32 v228, s63, v232
    v_xor_b32 v229, s63, v233
    s_waitcnt vmcnt(13)
    v_xor_b32 v234, s63, v238
    v_xor_b32 v235, s63, v239
    s_waitcnt vmcnt(12)
    v_xor_b32 v168, s63, v172
    v_xor_b32 v169, s63, v173
    s_waitcnt vmcnt(11)
    v_xor_b32 v174, s63, v178
    v_xor_b32 v175, s63, v179
    s_waitcnt vmcnt(10)
    v_xor_b32 v180, s63, v184
    v_xor_b32 v181, s63, v185
    s_waitcnt vmcnt(9)
    v_xor_b32 v186, s63, v190
    v_xor_b32 v187, s63, v191
    s_lshl_b32 s44, s74, 3
    s_add_u32 s44, s44, 4096
    v_and_b32 v252, 7, v1
    v_lshlrev_b32 v252, 8, v252
    s_waitcnt vmcnt(8)
    v_mov_b32 v254, v254
    buffer_load_dword v253, v252, s[24:27], s44 offen sc1
    s_waitcnt vmcnt(1)
    s_cmp_lg_u32 s40, 1
    s_cbranch_scc1 L_ow20
    s_mov_b32 s46, 0
L_go2:
    v_cmp_ne_u32 vcc, 0, v254
    s_add_u32 s46, s46, 1
    s_cbranch_vccnz L_gone2
    global_load_dword v254, v250, s[20:21] sc1
    s_waitcnt vmcnt(0)
    s_cmp_lt_u32 s46, 400000
    s_cbranch_scc1 L_go2
L_gone2:
    s_mov_b64 exec, -1
L_ow20:
    s_barrier
    s_cmp_lg_u32 s40, 1
    s_cbranch_scc1 L_ow21
    s_mov_b64 exec, 1
    buffer_store_dword v251, v250, s[24:27], s71 offen sc1
    s_mov_b64 exec, -1
L_ow21:
    s_sub_u32 s73, s2, 128
    s_lshr_b32 s44, s73, 2
    s_lshl_b32 s44, s44, 11
    s_and_b32 s45, s73, 3
    s_mul_i32 s45, s45, 45056
    s_add_u32 s44, s44, s45
    s_and_b32 s45, s40, 1
    s_mul_i32 s45, s45, 720896
    s_add_u32 s44, s44, s45
    s_lshr_b32 s45, s40, 1
    s_lshl_b32 s45, s45, 9
    s_add_u32 s44, s44, s45
    s_add_u32 s44, s44, 11419648
    v_mul_u32_u24 v30, 180224, v2
    v_bfe_u32 v31, v1, 3, 1
    v_lshl_add_u32 v30, v31, 10, v30
    v_and_b32 v31, 7, v1
    v_lshl_add_u32 v30, v31, 4, v30
    buffer_store_dwordx4 v[64:67], v30, s[24:27], s44 offen offset:0 sc1
    buffer_store_dwordx4 v[68:71], v30, s[24:27], s44 offen offset:128 sc1
    buffer_store_dwordx4 v[72:75], v30, s[24:27], s44 offen offset:256 sc1
    buffer_store_dwordx4 v[76:79], v30, s[24:27], s44 offen offset:384 sc1
    s_cmp_lg_u32 s40, 0
    s_cbranch_scc1 L_b1q
    s_waitcnt vmcnt(4)
    v_min_u32 v253, v253, v254
    v_cmp_eq_u32 vcc, 0, v253
    s_nop 0
    s_cbranch_vccnz L_b1q
    s_branch L_b1x
L_p1c:
    s_cmp_ge_u32 s2, 248
    s_cbranch_scc1 L_p1i
    s_sub_u32 s48, s2, 216
    s_lshl_b32 s48, s48, 2
    s_add_u32 s48, s48, s40
    s_bfe_u32 s44, s48, 0x30002
    s_lshl_b32 s44, s44, 3
    s_lshr_b32 s45, s48, 5
    s_lshl_b32 s45, s45, 8
    s_add_u32 s44, s44, s45
    s_mul_i32 s49, s44, 514
    s_and_b32 s45, s48, 3
    s_lshl_b32 s45, s45, 7
    s_add_u32 s49, s49, s45
    s_add_u32 s49, s49, 2
    v_lshrrev_b32 v12, 3, v1
    v_and_b32 v13, 7, v1
    v_mul_u32_u24 v11, 514, v12
    v_lshl_add_u32 v11, v13, 4, v11
    s_mov_b32 s30, 1052672
    s_mov_b32 s31, 0x20000
    s_mov_b32 s34, 1052672
    s_mov_b32 s35, 0x20000
    s_add_u32 s50, s49, 32896
    s_add_u32 s51, s49, 65792
    s_add_u32 s52, s49, 98688
    s_waitcnt lgkmcnt(0)
    s_mov_b32 s28, s6
    s_and_b32 s29, s7, 0xffff
    s_mov_b32 s32, s8
    s_and_b32 s33, s9, 0xffff
    buffer_load_dwordx4 v[32:35], v11, s[28:31], s49 offen
    buffer_load_dwordx4 v[36:39], v11, s[32:35], s49 offen
    buffer_load_dwordx4 v[40:43], v11, s[28:31], s50 offen
    buffer_load_dwordx4 v[44:47], v11, s[32:35], s50 offen
    buffer_load_dwordx4 v[48:51], v11, s[28:31], s51 offen
    buffer_load_dwordx4 v[52:55], v11, s[32:35], s51 offen
    buffer_load_dwordx4 v[56:59], v11, s[28:31], s52 offen
    buffer_load_dwordx4 v[60:63], v11, s[32:35], s52 offen
    s_mov_b32 s24, s22
    s_and_b32 s25, s23, 0xffff
    s_mov_b32 s26, 22626304
    s_mov_b32 s27, 0x20000
    s_lshl_b32 s56, s48, 13
    s_add_u32 s56, s56, 2752512
    s_mov_b32 s53, 0x05040100
    s_mov_b32 s54, 0x07060302
    v_mov_b32 v11, v4
    v_xor_b32 v12, v12, v13
    v_lshlrev_b32 v12, 4, v12
    v_lshl_add_u32 v12, v13, 10, v12
    s_lshl_b32 s44, s40, 13
    v_add_u32 v12, s44, v12
    v_add_u32 v14, s44, v4
    s_add_u32 s57, s56, 1024
    v_xor_b32 v15, 16, v14
    s_add_u32 s58, s56, 2048
    v_xor_b32 v16, 32, v14
    s_add_u32 s59, s56, 3072
    v_xor_b32 v17, 48, v14
    s_add_u32 s60, s56, 4096
    v_xor_b32 v18, 64, v14
    s_add_u32 s61, s56, 5120
    v_xor_b32 v19, 80, v14
    s_add_u32 s62, s56, 6144
    v_xor_b32 v20, 96, v14
    s_add_u32 s63, s56, 7168
    v_xor_b32 v21, 112, v14
    s_lshl_b32 s44, s40, 13
    s_add_u32 s44, s44, 6144
    s_add_u32 s46, s42, s44
    s_addc_u32 s47, s43, 0
    v_mov_b32 v27, s47
    v_add_co_u32 v26, vcc, s46, v4
    s_nop 1
    v_addc_co_u32 v27, vcc, 0, v27, vcc
    s_add_u32 s46, s42, 38912
    s_addc_u32 s47, s43, 0
    v_mov_b32 v29, s47
    v_add_co_u32 v28, vcc, s46, v4
    s_nop 1
    v_addc_co_u32 v29, vcc, 0, v29, vcc
    s_waitcnt vmcnt(6)
    v_perm_b32 v64, v36, v32, s53
    s_waitcnt vmcnt(4)
    v_perm_b32 v65, v44, v40, s53
    s_waitcnt vmcnt(2)
    v_perm_b32 v66, v52, v48, s53
    s_waitcnt vmcnt(0)
    v_perm_b32 v67, v60, v56, s53
    ds_write_b128 v12, v[64:67] offset:0
    v_perm_b32 v68, v36, v32, s54
    v_perm_b32 v69, v44, v40, s54
    v_perm_b32 v70, v52, v48, s54
    v_perm_b32 v71, v60, v56, s54
    ds_write_b128 v12, v[68:71] offset:128
    v_perm_b32 v72, v37, v33, s53
    v_perm_b32 v73, v45, v41, s53
    v_perm_b32 v74, v53, v49, s53
    v_perm_b32 v75, v61, v57, s53
    ds_write_b128 v12, v[72:75] offset:256
    v_perm_b32 v76, v37, v33, s54
    v_perm_b32 v77, v45, v41, s54
    v_perm_b32 v78, v53, v49, s54
    v_perm_b32 v79, v61, v57, s54
    ds_write_b128 v12, v[76:79] offset:384
    v_perm_b32 v80, v38, v34, s53
    v_perm_b32 v81, v46, v42, s53
    v_perm_b32 v82, v54, v50, s53
    v_perm_b32 v83, v62, v58, s53
    ds_write_b128 v12, v[80:83] offset:512
    v_perm_b32 v84, v38, v34, s54
    v_perm_b32 v85, v46, v42, s54
    v_perm_b32 v86, v54, v50, s54
    v_perm_b32 v87, v62, v58, s54
    ds_write_b128 v12, v[84:87] offset:640
    v_perm_b32 v88, v39, v35, s53
    v_perm_b32 v89, v47, v43, s53
    v_perm_b32 v90, v55, v51, s53
    v_perm_b32 v91, v63, v59, s53
    ds_write_b128 v12, v[88:91] offset:768
    v_perm_b32 v92, v39, v35, s54
    v_perm_b32 v93, v47, v43, s54
    v_perm_b32 v94, v55, v51, s54
    v_perm_b32 v95, v63, v59, s54
    ds_write_b128 v12, v[92:95] offset:896
    s_lshl_b32 s44, s40, 4
    v_add_u32 v240, s44, v3
    v_cvt_f32_u32 v240, v240
    v_mul_f32 v240, 0x3a000000, v240
    v_lshlrev_b32 v241, 2, v2
    v_add_u32 v242, s44, v241
    v_cvt_f32_u32 v241, v241
    v_cvt_f32_u32 v242, v242
    v_cvt_f32_u32 v243, v3
    v_mul_f32 v243, 0x3a000000, v243
    v_add_f32 v112, 0x00000000, v241
    v_mul_f32 v112, v112, v240
    v_sin_f32 v116, v112
    v_cos_f32 v112, v112
    v_add_f32 v113, 0x3f800000, v241
    v_mul_f32 v113, v113, v240
    v_sin_f32 v117, v113
    v_cos_f32 v113, v113
    v_add_f32 v114, 0x40000000, v241
    v_mul_f32 v114, v114, v240
    v_sin_f32 v118, v114
    v_cos_f32 v114, v114
    v_add_f32 v115, 0x40400000, v241
    v_mul_f32 v115, v115, v240
    v_sin_f32 v119, v115
    v_cos_f32 v115, v115
    v_add_f32 v120, 0x41800000, v241
    v_mul_f32 v120, v120, v240
    v_sin_f32 v124, v120
    v_cos_f32 v120, v120
    v_add_f32 v121, 0x41880000, v241
    v_mul_f32 v121, v121, v240
    v_sin_f32 v125, v121
    v_cos_f32 v121, v121
    v_add_f32 v122, 0x41900000, v241
    v_mul_f32 v122, v122, v240
    v_sin_f32 v126, v122
    v_cos_f32 v122, v122
    v_add_f32 v123, 0x41980000, v241
    v_mul_f32 v123, v123, v240
    v_sin_f32 v127, v123
    v_cos_f32 v123, v123
    v_add_f32 v128, 0x00000000, v242
    v_mul_f32 v128, v128, v243
    v_sin_f32 v132, v128
    v_cos_f32 v128, v128
    v_add_f32 v129, 0x3f800000, v242
    v_mul_f32 v129, v129, v243
    v_sin_f32 v133, v129
    v_cos_f32 v129, v129
    v_add_f32 v130, 0x40000000, v242
    v_mul_f32 v130, v130, v243
    v_sin_f32 v134, v130
    v_cos_f32 v130, v130
    v_add_f32 v131, 0x40400000, v242
    v_mul_f32 v131, v131, v243
    v_sin_f32 v135, v131
    v_cos_f32 v131, v131
    v_add_f32 v243, 0x3c000000, v243
    v_add_f32 v136, 0x00000000, v242
    v_mul_f32 v136, v136, v243
    v_sin_f32 v140, v136
    v_cos_f32 v136, v136
    v_add_f32 v137, 0x3f800000, v242
    v_mul_f32 v137, v137, v243
    v_sin_f32 v141, v137
    v_cos_f32 v137, v137
    v_add_f32 v138, 0x40000000, v242
    v_mul_f32 v138, v138, v243
    v_sin_f32 v142, v138
    v_cos_f32 v138, v138
    v_add_f32 v139, 0x40400000, v242
    v_mul_f32 v139, v139, v243
    v_sin_f32 v143, v139
    v_cos_f32 v139, v139
    ds_read_b128 v[32:35], v14 offset:0
    ds_read_b128 v[36:39], v15 offset:1024
    ds_read_b128 v[40:43], v16 offset:2048
    ds_read_b128 v[44:47], v17 offset:3072
    ds_read_b128 v[48:51], v18 offset:4096
    ds_read_b128 v[52:55], v19 offset:5120
    ds_read_b128 v[56:59], v20 offset:6144
    ds_read_b128 v[60:63], v21 offset:7168
    v_mov_b32 v250, 0
    global_load_dword v254, v250, s[20:21] sc1
    s_waitcnt lgkmcnt(7)
    buffer_store_dwordx4 v[32:35], v11, s[24:27], s56 offen sc1
    s_waitcnt lgkmcnt(6)
    buffer_store_dwordx4 v[36:39], v11, s[24:27], s57 offen sc1
    s_waitcnt lgkmcnt(5)
    buffer_store_dwordx4 v[40:43], v11, s[24:27], s58 offen sc1
    s_waitcnt lgkmcnt(4)
    buffer_store_dwordx4 v[44:47], v11, s[24:27], s59 offen sc1
    s_waitcnt lgkmcnt(3)
    buffer_store_dwordx4 v[48:51], v11, s[24:27], s60 offen sc1
    s_waitcnt lgkmcnt(2)
    buffer_store_dwordx4 v[52:55], v11, s[24:27], s61 offen sc1
    s_waitcnt lgkmcnt(1)
    buffer_store_dwordx4 v[56:59], v11, s[24:27], s62 offen sc1
    s_waitcnt lgkmcnt(0)
    buffer_store_dwordx4 v[60:63], v11, s[24:27], s63 offen sc1
    s_branch L_join1
L_p1i:
    s_waitcnt lgkmcnt(0)
    s_mov_b32 s24, s22
    s_and_b32 s25, s23, 0xffff
    s_mov_b32 s26, 22626304
    s_mov_b32 s27, 0x20000
    s_lshl_b32 s44, s2, 2
    s_add_u32 s44, s44, s40
    s_cmp_lg_u32 s44, 1020
    s_cbranch_scc1 L_noinit
    v_lshlrev_b32 v30, 8, v1
    v_lshlrev_b32 v31, 8, v3
    v_mov_b32 v32, 0
    s_mov_b32 s44, 4096
    s_mov_b32 s45, 20480
    buffer_store_dword v32, v30, s[24:27], s44 offen sc1
    v_lshlrev_b32 v33, 7, v1
    buffer_store_dword v32, v33, s[24:27], s45 offen sc1
    s_add_u32 s45, s45, 8192
    buffer_store_dword v32, v33, s[24:27], s45 offen sc1
    buffer_store_dword v32, v31, s[24:27], 0 offen sc1
    v_mov_b32 v33, 1
    s_waitcnt vmcnt(0)
    s_mov_b64 exec, 1
    global_store_dword v32, v33, s[20:21] sc1
    s_mov_b64 exec, -1
L_noinit:
    s_sub_u32 s60, s2, 248
    s_lshl_b32 s61, s60, 1
    s_lshr_b32 s44, s40, 1
    s_add_u32 s61, s61, s44
    s_and_b32 s62, s40, 1
    s_lshl_b32 s62, s62, 2
    s_add_u32 s63, s62, 4
    s_lshl_b32 s44, s61, 5
    s_add_u32 s44, s44, 1
    v_lshl_add_u32 v30, v3, 1, s44
    v_and_b32 v31, 1, v2
    v_lshlrev_b32 v31, 7, v31
    v_cmp_lt_u32 s[64:65], 1, v2
    v_mov_b32 v36, 0x3d800000
    s_mul_i32 s61, s61, 196608
    s_add_u32 s61, s61, 7667712
    s_lshl_b32 s44, s40, 13
    s_add_u32 s44, s44, 6144
    s_add_u32 s46, s42, s44
    s_addc_u32 s47, s43, 0
    v_mov_b32 v27, s47
    v_add_co_u32 v26, vcc, s46, v4
    s_nop 1
    v_addc_co_u32 v27, vcc, 0, v27, vcc
    s_add_u32 s46, s42, 38912
    s_addc_u32 s47, s43, 0
    v_mov_b32 v29, s47
    v_add_co_u32 v28, vcc, s46, v4
    s_nop 1
    v_addc_co_u32 v29, vcc, 0, v29, vcc
    global_load_dwordx4 v[146:149], v[26:27], off offset:-4096
    global_load_dwordx4 v[152:155], v[26:27], off offset:-3072
    global_load_dwordx4 v[158:161], v[26:27], off offset:-2048
    global_load_dwordx4 v[164:167], v[26:27], off offset:-1024
    global_load_dwordx4 v[194:197], v[28:29], off offset:-4096
    global_load_dwordx4 v[200:203], v[28:29], off offset:-3072
    global_load_dwordx4 v[206:209], v[28:29], off offset:-2048
    global_load_dwordx4 v[212:215], v[28:29], off offset:-1024
    global_load_dwordx4 v[218:221], v[28:29], off offset:0
    global_load_dwordx4 v[224:227], v[28:29], off offset:1024
    global_load_dwordx4 v[230:233], v[28:29], off offset:2048
    global_load_dwordx4 v[236:239], v[28:29], off offset:3072
    global_load_dwordx4 v[170:173], v[26:27], off offset:0
    global_load_dwordx4 v[176:179], v[26:27], off offset:1024
    global_load_dwordx4 v[182:185], v[26:27], off offset:2048
    global_load_dwordx4 v[188:191], v[26:27], off offset:3072
    s_lshl_b32 s44, s40, 4
    v_add_u32 v240, s44, v3
    v_cvt_f32_u32 v240, v240
    v_mul_f32 v240, 0x3a000000, v240
    v_lshlrev_b32 v241, 2, v2
    v_add_u32 v242, s44, v241
    v_cvt_f32_u32 v241, v241
    v_cvt_f32_u32 v242, v242
    v_cvt_f32_u32 v243, v3
    v_mul_f32 v243, 0x3a000000, v243
    v_add_f32 v112, 0x00000000, v241
    v_mul_f32 v112, v112, v240
    v_sin_f32 v116, v112
    v_cos_f32 v112, v112
    v_add_f32 v113, 0x3f800000, v241
    v_mul_f32 v113, v113, v240
    v_sin_f32 v117, v113
    v_cos_f32 v113, v113
    v_add_f32 v114, 0x40000000, v241
    v_mul_f32 v114, v114, v240
    v_sin_f32 v118, v114
    v_cos_f32 v114, v114
    v_add_f32 v115, 0x40400000, v241
    v_mul_f32 v115, v115, v240
    v_sin_f32 v119, v115
    v_cos_f32 v115, v115
    v_add_f32 v120, 0x41800000, v241
    v_mul_f32 v120, v120, v240
    v_sin_f32 v124, v120
    v_cos_f32 v120, v120
    v_add_f32 v121, 0x41880000, v241
    v_mul_f32 v121, v121, v240
    v_sin_f32 v125, v121
    v_cos_f32 v121, v121
    v_add_f32 v122, 0x41900000, v241
    v_mul_f32 v122, v122, v240
    v_sin_f32 v126, v122
    v_cos_f32 v122, v122
    v_add_f32 v123, 0x41980000, v241
    v_mul_f32 v123, v123, v240
    v_sin_f32 v127, v123
    v_cos_f32 v123, v123
    v_add_f32 v128, 0x00000000, v242
    v_mul_f32 v128, v128, v243
    v_sin_f32 v132, v128
    v_cos_f32 v128, v128
    v_add_f32 v129, 0x3f800000, v242
    v_mul_f32 v129, v129, v243
    v_sin_f32 v133, v129
    v_cos_f32 v129, v129
    v_add_f32 v130, 0x40000000, v242
    v_mul_f32 v130, v130, v243
    v_sin_f32 v134, v130
    v_cos_f32 v130, v130
    v_add_f32 v131, 0x40400000, v242
    v_mul_f32 v131, v131, v243
    v_sin_f32 v135, v131
    v_cos_f32 v131, v131
    v_add_f32 v243, 0x3c000000, v243
    v_add_f32 v136, 0x00000000, v242
    v_mul_f32 v136, v136, v243
    v_sin_f32 v140, v136
    v_cos_f32 v136, v136
    v_add_f32 v137, 0x3f800000, v242
    v_mul_f32 v137, v137, v243
    v_sin_f32 v141, v137
    v_cos_f32 v137, v137
    v_add_f32 v138, 0x40000000, v242
    v_mul_f32 v138, v138, v243
    v_sin_f32 v142, v138
    v_cos_f32 v138, v138
    v_add_f32 v139, 0x40400000, v242
    v_mul_f32 v139, v139, v243
    v_sin_f32 v143, v139
    v_cos_f32 v139, v139
    s_nop 4
L_inv:
    s_lshl_b32 s44, s62, 1
    s_sub_u32 s45, 32, s44
    s_cmp_eq_u32 s44, 0
    s_cselect_b32 s45, 16, s45
    v_mov_b32 v33, s44
    v_mov_b32 v34, s45
    v_cndmask_b32 v33, v33, v34, s[64:65]
    v_add_u32 v33, v33, v31
    s_add_u32 s44, s44, 1
    s_sub_u32 s45, 32, s44
    v_mov_b32 v34, s44
    v_mov_b32 v35, s45
    v_cndmask_b32 v34, v34, v35, s[64:65]
    v_add_u32 v34, v34, v31
    v_cmp_eq_u32 vcc, 0, v33
    v_mov_b32 v35, 0x100
    v_mov_b32 v37, 0x3d3504f3
    v_cndmask_b32 v35, v33, v35, vcc
    v_cndmask_b32 v37, v36, v37, vcc
    s_lshl_b32 s45, s62, 11
    s_add_u32 s66, s61, s45
    v_mul_u32_u24 v40, v35, v30
    v_and_b32 v40, 0x3ff, v40
    v_cvt_f32_u32 v40, v40
    v_mul_f32 v40, 0x3a800000, v40
    v_add_u32 v41, 32, v33
    v_mul_u32_u24 v41, v41, v30
    v_and_b32 v41, 0x3ff, v41
    v_cvt_f32_u32 v41, v41
    v_mul_f32 v41, 0x3a800000, v41
    v_add_u32 v42, 64, v33
    v_mul_u32_u24 v42, v42, v30
    v_and_b32 v42, 0x3ff, v42
    v_cvt_f32_u32 v42, v42
    v_mul_f32 v42, 0x3a800000, v42
    v_add_u32 v43, 96, v33
    v_mul_u32_u24 v43, v43, v30
    v_and_b32 v43, 0x3ff, v43
    v_cvt_f32_u32 v43, v43
    v_mul_f32 v43, 0x3a800000, v43
    v_add_u32 v44, 0, v34
    v_mul_u32_u24 v44, v44, v30
    v_and_b32 v44, 0x3ff, v44
    v_cvt_f32_u32 v44, v44
    v_mul_f32 v44, 0x3a800000, v44
    v_add_u32 v45, 32, v34
    v_mul_u32_u24 v45, v45, v30
    v_and_b32 v45, 0x3ff, v45
    v_cvt_f32_u32 v45, v45
    v_mul_f32 v45, 0x3a800000, v45
    v_add_u32 v46, 64, v34
    v_mul_u32_u24 v46, v46, v30
    v_and_b32 v46, 0x3ff, v46
    v_cvt_f32_u32 v46, v46
    v_mul_f32 v46, 0x3a800000, v46
    v_add_u32 v47, 96, v34
    v_mul_u32_u24 v47, v47, v30
    v_and_b32 v47, 0x3ff, v47
    v_cvt_f32_u32 v47, v47
    v_mul_f32 v47, 0x3a800000, v47
    v_cos_f32 v48, v40
    v_sin_f32 v56, v40
    v_cos_f32 v49, v41
    v_sin_f32 v57, v41
    v_cos_f32 v50, v42
    v_sin_f32 v58, v42
    v_cos_f32 v51, v43
    v_sin_f32 v59, v43
    v_cos_f32 v52, v44
    v_sin_f32 v60, v44
    v_cos_f32 v53, v45
    v_sin_f32 v61, v45
    v_cos_f32 v54, v46
    v_sin_f32 v62, v46
    v_cos_f32 v55, v47
    v_sin_f32 v63, v47
    v_mul_f32 v48, v37, v48
    v_mul_f32 v56, v37, -v56
    v_mul_f32 v49, v36, v49
    v_mul_f32 v57, v36, -v57
    v_mul_f32 v50, v36, v50
    v_mul_f32 v58, v36, -v58
    v_mul_f32 v51, v36, v51
    v_mul_f32 v59, v36, -v59
    v_mul_f32 v52, v36, v52
    v_mul_f32 v60, v36, -v60
    v_mul_f32 v53, v36, v53
    v_mul_f32 v61, v36, -v61
    v_mul_f32 v54, v36, v54
    v_mul_f32 v62, v36, -v62
    v_mul_f32 v55, v36, v55
    v_mul_f32 v63, v36, -v63
    v_cvt_pk_bf16_f32 v64, v48, v49
    v_cvt_pk_bf16_f32 v65, v50, v51
    v_cvt_pk_bf16_f32 v66, v52, v53
    v_cvt_pk_bf16_f32 v67, v54, v55
    buffer_store_dwordx4 v[64:67], v4, s[24:27], s66 offen offset:0 sc1
    v_cvt_pk_bf16_f32 v68, v56, v57
    v_cvt_pk_bf16_f32 v69, v58, v59
    v_cvt_pk_bf16_f32 v70, v60, v61
    v_cvt_pk_bf16_f32 v71, v62, v63
    buffer_store_dwordx4 v[68:71], v4, s[24:27], s66 offen offset:1024 sc1
    s_add_u32 s62, s62, 1
    s_cmp_lt_u32 s62, s63
    s_cbranch_scc1 L_inv
    v_mov_b32 v250, 0
    global_load_dword v254, v250, s[20:21] sc1
    s_branch L_join1
.p2align 8
.type tables,@object
tables:
.quad 0x3f803f803f803f80,0x3f803f803f803f80,0x3f553f6d3f7b3f80,0xbf55bf6dbf7bbf80,0x3ec43f353f6d3f80,0x3ec43f353f6d3f80,0xbe483ec43f553f80,0x3e48bec4bf55bf80
.quad 0xbf3500003f353f80,0xbf3500003f353f80,0xbf7bbec43f0e3f80,0x3f7b3ec4bf0ebf80,0xbf6dbf353ec43f80,0xbf6dbf353ec43f80,0xbf0ebf6d3e483f80,0x3f0e3f6dbe48bf80
.quad 0xbf8000003f80,0xbf8000003f80,0x3f0ebf6dbe483f80,0xbf0e3f6d3e48bf80,0x3f6dbf35bec43f80,0x3f6dbf35bec43f80,0x3f7bbec4bf0e3f80,0xbf7b3ec43f0ebf80
.quad 0x3f350000bf353f80,0x3f350000bf353f80,0x3e483ec4bf553f80,0xbe48bec43f55bf80,0xbec43f35bf6d3f80,0xbec43f35bf6d3f80,0xbf553f6dbf7b3f80,0x3f55bf6d3f7bbf80
.quad 0x3f803f803f803f80,0x3f803f803f803f80,0x3e483ec43f0e3f35,0xbe48bec4bf0ebf35,0xbf6dbf35bec40000,0xbf6dbf35bec40000,0xbf0ebf6dbf7bbf35,0x3f0e3f6d3f7b3f35
.quad 0x3f350000bf35bf80,0x3f350000bf35bf80,0x3f553f6d3e48bf35,0xbf55bf6dbe483f35,0xbec43f353f6d0000,0xbec43f353f6d0000,0xbf7bbec43f553f35,0x3f7b3ec4bf55bf35
.quad 0xbf8000003f80,0xbf8000003f80,0x3f7bbec4bf553f35,0xbf7b3ec43f55bf35,0x3ec43f35bf6d0000,0x3ec43f35bf6d0000,0xbf553f6dbe48bf35,0x3f55bf6d3e483f35
.quad 0xbf3500003f35bf80,0xbf3500003f35bf80,0x3f0ebf6d3f7bbf35,0xbf0e3f6dbf7b3f35,0x3f6dbf353ec40000,0x3f6dbf353ec40000,0xbe483ec4bf0e3f35,0x3e48bec43f0ebf35
.quad 0x3f803f803f803f80,0x3f803f803f803f80,0xbf0ebec4be480000,0x3f0e3ec43e480000,0xbec4bf35bf6dbf80,0xbec4bf35bf6dbf80,0x3f7b3f6d3f0e0000,0xbf7bbf6dbf0e0000
.quad 0xbf3500003f353f80,0xbf3500003f353f80,0xbe48bf6dbf550000,0x3e483f6d3f550000,0x3f6d3f35bec4bf80,0x3f6d3f35bec4bf80,0xbf553ec43f7b0000,0x3f55bec4bf7b0000
.quad 0xbf8000003f80,0xbf8000003f80,0x3f553ec4bf7b0000,0xbf55bec43f7b0000,0xbf6d3f353ec4bf80,0xbf6d3f353ec4bf80,0x3e48bf6d3f550000,0xbe483f6dbf550000
.quad 0x3f350000bf353f80,0x3f350000bf353f80,0xbf7b3f6dbf0e0000,0x3f7bbf6d3f0e0000,0x3ec4bf353f6dbf80,0x3ec4bf353f6dbf80,0x3f0ebec43e480000,0xbf0e3ec4be480000
.quad 0x3f803f803f803f80,0x3f803f803f803f80,0xbf7bbf6dbf55bf35,0x3f7b3f6d3f553f35,0x3f6d3f353ec40000,0x3f6d3f353ec40000,0xbf55bec43e483f35,0x3f553ec4be48bf35
.quad 0x3f350000bf35bf80,0x3f350000bf35bf80,0xbf0e3ec43f7b3f35,0x3f0ebec4bf7bbf35,0x3ec4bf35bf6d0000,0x3ec4bf35bf6d0000,0xbe483f6d3f0ebf35,0x3e48bf6dbf0e3f35
.quad 0xbf8000003f80,0xbf8000003f80,0x3e483f6dbf0ebf35,0xbe48bf6d3f0e3f35,0xbec4bf353f6d0000,0xbec4bf353f6d0000,0x3f0e3ec4bf7b3f35,0xbf0ebec43f7bbf35
.quad 0xbf3500003f35bf80,0xbf3500003f35bf80,0x3f55bec4be483f35,0xbf553ec43e48bf35,0xbf6d3f35bec40000,0xbf6d3f35bec40000,0x3f7bbf6d3f55bf35,0xbf7b3f6dbf553f35
.quad 0xbf803f80bf803f80,0xbf803f80bf803f80,0xbf0ebec4be480000,0x3f0e3ec43e480000,0xbf6dbf35bec40000,0xbf6dbf35bec40000,0xbf7bbf6dbf0e0000,0x3f7b3f6d3f0e0000
.quad 0xbf35bf80bf350000,0xbf35bf80bf350000,0xbe48bf6dbf550000,0x3e483f6d3f550000,0x3ec4bf35bf6d0000,0x3ec4bf35bf6d0000,0x3f55bec4bf7b0000,0xbf553ec43f7b0000
.quad 0x3f800000bf800000,0x3f800000bf800000,0x3f553ec4bf7b0000,0xbf55bec43f7b0000,0x3ec43f35bf6d0000,0x3ec43f35bf6d0000,0xbe483f6dbf550000,0x3e48bf6d3f550000
.quad 0xbf353f80bf350000,0xbf353f80bf350000,0xbf7b3f6dbf0e0000,0x3f7bbf6d3f0e0000,0xbf6d3f35bec40000,0xbf6d3f35bec40000,0xbf0e3ec4be480000,0x3f0ebec43e480000
.quad 0xbf803f80bf803f80,0xbf803f80bf803f80,0xbf7bbf6dbf55bf35,0x3f7b3f6d3f553f35,0xbec4bf35bf6dbf80,0xbec4bf35bf6dbf80,0x3f553ec4be48bf35,0xbf55bec43e483f35
.quad 0x3f353f803f350000,0x3f353f803f350000,0xbf0e3ec43f7b3f35,0x3f0ebec4bf7bbf35,0xbf6dbf353ec43f80,0xbf6dbf353ec43f80,0x3e48bf6dbf0e3f35,0xbe483f6d3f0ebf35
.quad 0x3f800000bf800000,0x3f800000bf800000,0x3e483f6dbf0ebf35,0xbe48bf6d3f0e3f35,0xbf6d3f353ec4bf80,0xbf6d3f353ec4bf80,0xbf0ebec43f7bbf35,0x3f0e3ec4bf7b3f35
.quad 0x3f35bf803f350000,0x3f35bf803f350000,0x3f55bec4be483f35,0xbf553ec43e48bf35,0xbec43f35bf6d3f80,0xbec43f35bf6d3f80,0xbf7b3f6dbf553f35,0x3f7bbf6d3f55bf35
.quad 0xbf803f80bf803f80,0xbf803f80bf803f80,0xbf55bf6dbf7bbf80,0x3f553f6d3f7b3f80,0x3f6d3f353ec40000,0x3f6d3f353ec40000,0xbe483ec43f553f80,0x3e48bec4bf55bf80
.quad 0xbf35bf80bf350000,0xbf35bf80bf350000,0x3f7b3ec4bf0ebf80,0xbf7bbec43f0e3f80,0xbec43f353f6d0000,0xbec43f353f6d0000,0xbf0ebf6d3e483f80,0x3f0e3f6dbe48bf80
.quad 0x3f800000bf800000,0x3f800000bf800000,0xbf0e3f6d3e48bf80,0x3f0ebf6dbe483f80,0xbec4bf353f6d0000,0xbec4bf353f6d0000,0x3f7bbec4bf0e3f80,0xbf7b3ec43f0ebf80
.quad 0xbf353f80bf350000,0xbf353f80bf350000,0xbe48bec43f55bf80,0x3e483ec4bf553f80,0x3f6dbf353ec40000,0x3f6dbf353ec40000,0xbf553f6dbf7b3f80,0x3f55bf6d3f7bbf80
.quad 0xbf803f80bf803f80,0xbf803f80bf803f80,0xbe48bec4bf0ebf35,0x3e483ec43f0e3f35,0x3ec43f353f6d3f80,0x3ec43f353f6d3f80,0xbf0ebf6dbf7bbf35,0x3f0e3f6d3f7b3f35
.quad 0x3f353f803f350000,0x3f353f803f350000,0xbf55bf6dbe483f35,0x3f553f6d3e48bf35,0x3f6d3f35bec4bf80,0x3f6d3f35bec4bf80,0xbf7bbec43f553f35,0x3f7b3ec4bf55bf35
.quad 0x3f800000bf800000,0x3f800000bf800000,0xbf7b3ec43f55bf35,0x3f7bbec4bf553f35,0x3f6dbf35bec43f80,0x3f6dbf35bec43f80,0xbf553f6dbe48bf35,0x3f55bf6d3e483f35
.quad 0x3f35bf803f350000,0x3f35bf803f350000,0xbf0e3f6dbf7b3f35,0x3f0ebf6d3f7bbf35,0x3ec4bf353f6dbf80,0x3ec4bf353f6dbf80,0xbe483ec4bf0e3f35,0x3e48bec43f0ebf35
.quad 0x3000300030003000,0x0,0x2fa82fd92ff63000,0x28a5263e22460000,0x2ea72f642fd93000,0x2c722a1f263e0000,0x2d132ea72fa83000,0x2e2f2c7228a50000
.quad 0x2a1f2da82f643000,0x2f642da82a1f0000,0x22462c722f0e3000,0x2ff62ea72b8b0000,0xa63e2a1f2ea73000,0x2fd92f642c720000,0xab8b263e2e2f3000,0x2f0e2fd92d130000
.quad 0xada800002da83000,0x2da830002da80000,0xaf0ea63e2d133000,0x2b8b2fd92e2f0000,0xafd9aa1f2c723000,0x263e2f642ea70000,0xaff6ac722b8b3000,0xa2462ea72f0e0000
.quad 0xaf64ada82a1f3000,0xaa1f2da82f640000,0xae2faea728a53000,0xad132c722fa80000,0xac72af64263e3000,0xaea72a1f2fd90000,0xa8a5afd922463000,0xafa8263e2ff60000
.quad 0x3000300030003000,0x0,0x2e2f2ea72f0e2f64,0x2d132c722b8b2a1f,0x263e2a1f2c722da8,0x2fd92f642ea72da8,0xab8ba63e22462a1f,0x2f0e2fd92ff62f64
.quad 0xaf64ada8aa1f0000,0x2a1f2da82f643000,0xafa8afd9ae2faa1f,0xa8a5263e2d132f64,0xac72af64afd9ada8,0xaea7aa1f263e2da8,0x2246ac72afa8af64,0xaff6aea7a8a52a1f
.quad 0x2da80000ada8b000,0xada8b000ada80000,0x2ff62c72a8a5af64,0xa246aea7afa8aa1f,0x2ea72f64263eada8,0x2c72aa1fafd9ada8,0x28a52fd92d13aa1f,0x2fa8263eae2faf64
.quad 0xaa1f2da82f640000,0x2f642da8aa1fb000,0xaf0e263e2ff62a1f,0x2b8b2fd92246af64,0xafd9aa1f2ea72da8,0xa63e2f642c72ada8,0xad13aea72b8b2f64,0xae2f2c722f0eaa1f
.quad 0x3000300030003000,0x0,0x2b8b2c722d132da8,0x2f0e2ea72e2f2da8,0xac72aa1fa63e0000,0x2ea72f642fd93000,0xaff6afd9af0eada8,0xa246263e2b8b2da8
.quad 0xaa1fada8af64b000,0xaf64ada8aa1f0000,0x2d13263ea8a5ada8,0xae2fafd9afa8ada8,0x2fd92f642c720000,0x263eaa1faea7b000,0x28a52ea72ff62da8,0x2fa82c72a246ada8
.quad 0xada800002da83000,0x2da830002da80000,0xafa8aea7a2462da8,0xa8a52c722ff62da8,0xa63eaf64aea70000,0xafd9aa1f2c723000,0x2e2fa63eafa8ada8,0xad13afd9a8a52da8
.quad 0x2f642da8aa1fb000,0x2a1fada8af640000,0x22462fd92b8bada8,0x2ff6263eaf0eada8,0xaea72a1f2fd90000,0x2c722f64a63eb000,0xaf0eac722e2f2da8,0xab8b2ea72d13ada8
.quad 0x3000300030003000,0x0,0x2246263e28a52a1f,0x2ff62fd92fa82f64,0xafd9af64aea7ada8,0x263e2a1f2c722da8,0xa8a5ac72ae2faf64,0xafa8aea7ad13aa1f
.quad 0x2f642da82a1f0000,0xaa1fada8af64b000,0x2b8b2ea72ff62f64,0x2f0e2c722246aa1f,0xaea7aa1f263e2da8,0x2c722f642fd92da8,0xad13afd9af0eaa1f,0xae2fa63e2b8b2f64
.quad 0x2da80000ada8b000,0xada8b000ada80000,0x2e2f2fd92b8baa1f,0x2d13a63eaf0eaf64,0xac722a1f2fd92da8,0x2ea72f64263eada8,0xaf0eaea722462f64,0xab8b2c722ff62a1f
.quad 0x2a1fada8af640000,0xaf64ada82a1f3000,0x2fa82c72ad13af64,0x28a5aea7ae2f2a1f,0xa63e2f642c72ada8,0x2fd92a1faea7ada8,0xaff6a63e2fa82a1f,0xa2462fd928a5af64
.quad 0x3000300030003000,0x0,0xa8a5a63ea2460000,0x2fa82fd92ff63000,0xaea7af64afd9b000,0xac72aa1fa63e0000,0x2e2f2c7228a50000,0xad13aea7afa8b000
.quad 0x2a1f2da82f643000,0x2f642da82a1f0000,0xaff6aea7ab8b0000,0x22462c722f0e3000,0x263eaa1faea7b000,0xafd9af64ac720000,0x2f0e2fd92d130000,0x2b8ba63eae2fb000
.quad 0xada800002da83000,0x2da830002da80000,0xab8bafd9ae2f0000,0xaf0ea63e2d133000,0x2fd92a1fac72b000,0xa63eaf64aea70000,0xa2462ea72f0e0000,0x2ff62c72ab8bb000
.quad 0xaf64ada82a1f3000,0xaa1f2da82f640000,0x2d13ac72afa80000,0xae2faea728a53000,0x2c722f64a63eb000,0x2ea7aa1fafd90000,0xafa8263e2ff60000,0x28a52fd9a246b000
.quad 0x3000300030003000,0x0,0xad13ac72ab8baa1f,0x2e2f2ea72f0e2f64,0xa63eaa1fac72ada8,0xafd9af64aea7ada8,0x2f0e2fd92ff62f64,0x2b8b263ea246aa1f
.quad 0xaf64ada8aa1f0000,0x2a1f2da82f643000,0x28a5a63ead13af64,0xafa8afd9ae2faa1f,0x2c722f642fd92da8,0x2ea72a1fa63eada8,0xaff6aea7a8a52a1f,0xa2462c722fa82f64
.quad 0x2da80000ada8b000,0xada8b000ada80000,0x22462ea72fa82a1f,0x2ff62c72a8a5af64,0xaea7af64a63e2da8,0xac722a1f2fd92da8,0x2fa8263eae2faf64,0xa8a5afd9ad132a1f
.quad 0xaa1f2da82f640000,0x2f642da8aa1fb000,0xab8bafd9a2462f64,0xaf0e263e2ff62a1f,0x2fd92a1faea7ada8,0x263eaf64ac722da8,0xae2f2c722f0eaa1f,0x2d132ea7ab8baf64
.quad 0x3000300030003000,0x0,0xaf0eaea7ae2fada8,0x2b8b2c722d132da8,0x2c722a1f263e0000,0xaea7af64afd9b000,0xa246263e2b8b2da8,0x2ff62fd92f0e2da8
.quad 0xaa1fada8af64b000,0xaf64ada8aa1f0000,0x2e2f2fd92fa82da8,0x2d13263ea8a5ada8,0xafd9af64ac720000,0xa63e2a1f2ea73000,0x2fa82c72a246ada8,0xa8a5aea7aff6ada8
.quad 0xada800002da83000,0x2da830002da80000,0x28a5ac72aff6ada8,0xafa8aea7a2462da8,0x263e2f642ea70000,0x2fd92a1fac72b000,0xad13afd9a8a52da8,0xae2f263e2fa82da8
.quad 0x2f642da8aa1fb000,0x2a1fada8af640000,0xaff6a63e2f0e2da8,0x22462fd92b8bada8,0x2ea7aa1fafd90000,0xac72af64263e3000,0xab8b2ea72d13ada8,0x2f0e2c72ae2fada8
.quad 0x3000300030003000,0x0,0xaff6afd9afa8af64,0x2246263e28a52a1f,0x2fd92f642ea72da8,0xa63eaa1fac72ada8,0xafa8aea7ad13aa1f,0x28a52c722e2f2f64
.quad 0x2f642da82a1f0000,0xaa1fada8af64b000,0xaf0eac72a2462a1f,0x2b8b2ea72ff62f64,0x2ea72a1fa63eada8,0xac72af64afd9ada8,0xae2fa63e2b8b2f64,0x2d132fd92f0e2a1f
.quad 0x2da80000ada8b000,0xada8b000ada80000,0xad13263e2f0e2f64,0x2e2f2fd92b8baa1f,0x2c72aa1fafd9ada8,0xaea7af64a63e2da8,0xab8b2c722ff62a1f,0x2f0e2ea7a246af64
.quad 0x2a1fada8af640000,0xaf64ada82a1f3000,0xa8a52ea72e2faa1f,0x2fa82c72ad13af64,0x263eaf64ac722da8,0xafd9aa1f2ea72da8,0xa2462fd928a5af64,0x2ff6263eafa8aa1f
.quad 0x3000300030003000,0x0,0xafa8afd9aff6b000,0xa8a5a63ea2460000,0x2ea72f642fd93000,0x2c722a1f263e0000,0xad13aea7afa8b000,0xae2fac72a8a50000
.quad 0x2a1f2da82f643000,0x2f642da82a1f0000,0xa246ac72af0eb000,0xaff6aea7ab8b0000,0xa63e2a1f2ea73000,0x2fd92f642c720000,0x2b8ba63eae2fb000,0xaf0eafd9ad130000
.quad 0xada800002da83000,0x2da830002da80000,0x2f0e263ead13b000,0xab8bafd9ae2f0000,0xafd9aa1f2c723000,0x263e2f642ea70000,0x2ff62c72ab8bb000,0x2246aea7af0e0000
.quad 0xaf64ada82a1f3000,0xaa1f2da82f640000,0x2e2f2ea7a8a5b000,0x2d13ac72afa80000,0xac72af64263e3000,0xaea72a1f2fd90000,0x28a52fd9a246b000,0x2fa8a63eaff60000
.quad 0x3000300030003000,0x0,0xae2faea7af0eaf64,0xad13ac72ab8baa1f,0x263e2a1f2c722da8,0x2fd92f642ea72da8,0x2b8b263ea246aa1f,0xaf0eafd9aff6af64
.quad 0xaf64ada8aa1f0000,0x2a1f2da82f643000,0x2fa82fd92e2f2a1f,0x28a5a63ead13af64,0xac72af64afd9ada8,0xaea7aa1f263e2da8,0xa2462c722fa82f64,0x2ff62ea728a5aa1f
.quad 0x2da80000ada8b000,0xada8b000ada80000,0xaff6ac7228a52f64,0x22462ea72fa82a1f,0x2ea72f64263eada8,0x2c72aa1fafd9ada8,0xa8a5afd9ad132a1f,0xafa8a63e2e2f2f64
.quad 0xaa1f2da82f640000,0x2f642da8aa1fb000,0x2f0ea63eaff6aa1f,0xab8bafd9a2462f64,0xafd9aa1f2ea72da8,0xa63e2f642c72ada8,0x2d132ea7ab8baf64,0x2e2fac72af0e2a1f
.quad 0x3000300030003000,0x0,0xab8bac72ad13ada8,0xaf0eaea7ae2fada8,0xac72aa1fa63e0000,0x2ea72f642fd93000,0x2ff62fd92f0e2da8,0x2246a63eab8bada8
.quad 0xaa1fada8af64b000,0xaf64ada8aa1f0000,0xad13a63e28a52da8,0x2e2f2fd92fa82da8,0x2fd92f642c720000,0x263eaa1faea7b000,0xa8a5aea7aff6ada8,0xafa8ac7222462da8
.quad 0xada800002da83000,0x2da830002da80000,0x2fa82ea72246ada8,0x28a5ac72aff6ada8,0xa63eaf64aea70000,0xafd9aa1f2c723000,0xae2f263e2fa82da8,0x2d132fd928a5ada8
.quad 0x2f642da8aa1fb000,0x2a1fada8af640000,0xa246afd9ab8b2da8,0xaff6a63e2f0e2da8,0xaea72a1f2fd90000,0x2c722f64a63eb000,0x2f0e2c72ae2fada8,0x2b8baea7ad132da8
.quad 0x3000300030003000,0x0,0xa246a63ea8a5aa1f,0xaff6afd9afa8af64,0xafd9af64aea7ada8,0x263e2a1f2c722da8,0x28a52c722e2f2f64,0x2fa82ea72d132a1f
.quad 0x2f642da82a1f0000,0xaa1fada8af64b000,0xab8baea7aff6af64,0xaf0eac72a2462a1f,0xaea7aa1f263e2da8,0x2c722f642fd92da8,0x2d132fd92f0e2a1f,0x2e2f263eab8baf64
.quad 0x2da80000ada8b000,0xada8b000ada80000,0xae2fafd9ab8b2a1f,0xad13263e2f0e2f64,0xac722a1f2fd92da8,0x2ea72f64263eada8,0x2f0e2ea7a246af64,0x2b8bac72aff6aa1f
.quad 0x2a1fada8af640000,0xaf64ada82a1f3000,0xafa8ac722d132f64,0xa8a52ea72e2faa1f,0xa63e2f642c72ada8,0x2fd92a1faea7ada8,0x2ff6263eafa8aa1f,0x2246afd9a8a52f64
.quad 0x3000300030003000,0x0,0x28a5263e22460000,0xafa8afd9aff6b000,0xaea7af64afd9b000,0xac72aa1fa63e0000,0xae2fac72a8a50000,0x2d132ea72fa83000
.quad 0x2a1f2da82f643000,0x2f642da82a1f0000,0x2ff62ea72b8b0000,0xa246ac72af0eb000,0x263eaa1faea7b000,0xafd9af64ac720000,0xaf0eafd9ad130000,0xab8b263e2e2f3000
.quad 0xada800002da83000,0x2da830002da80000,0x2b8b2fd92e2f0000,0x2f0e263ead13b000,0x2fd92a1fac72b000,0xa63eaf64aea70000,0x2246aea7af0e0000,0xaff6ac722b8b3000
.quad 0xaf64ada82a1f3000,0xaa1f2da82f640000,0xad132c722fa80000,0x2e2f2ea7a8a5b000,0x2c722f64a63eb000,0x2ea7aa1fafd90000,0x2fa8a63eaff60000,0xa8a5afd922463000
.quad 0x3000300030003000,0x0,0x2d132c722b8b2a1f,0xae2faea7af0eaf64,0xa63eaa1fac72ada8,0xafd9af64aea7ada8,0xaf0eafd9aff6af64,0xab8ba63e22462a1f
.quad 0xaf64ada8aa1f0000,0x2a1f2da82f643000,0xa8a5263e2d132f64,0x2fa82fd92e2f2a1f,0x2c722f642fd92da8,0x2ea72a1fa63eada8,0x2ff62ea728a5aa1f,0x2246ac72afa8af64
.quad 0x2da80000ada8b000,0xada8b000ada80000,0xa246aea7afa8aa1f,0xaff6ac7228a52f64,0xaea7af64a63e2da8,0xac722a1f2fd92da8,0xafa8a63e2e2f2f64,0x28a52fd92d13aa1f
.quad 0xaa1f2da82f640000,0x2f642da8aa1fb000,0x2b8b2fd92246af64,0x2f0ea63eaff6aa1f,0x2fd92a1faea7ada8,0x263eaf64ac722da8,0x2e2fac72af0e2a1f,0xad13aea72b8b2f64
.quad 0x3000300030003000,0x0,0x2f0e2ea72e2f2da8,0xab8bac72ad13ada8,0x2c722a1f263e0000,0xaea7af64afd9b000,0x2246a63eab8bada8,0xaff6afd9af0eada8
.quad 0xaa1fada8af64b000,0xaf64ada8aa1f0000,0xae2fafd9afa8ada8,0xad13a63e28a52da8,0xafd9af64ac720000,0xa63e2a1f2ea73000,0xafa8ac7222462da8,0x28a52ea72ff62da8
.quad 0xada800002da83000,0x2da830002da80000,0xa8a52c722ff62da8,0x2fa82ea72246ada8,0x263e2f642ea70000,0x2fd92a1fac72b000,0x2d132fd928a5ada8,0x2e2fa63eafa8ada8
.quad 0x2f642da8aa1fb000,0x2a1fada8af640000,0x2ff6263eaf0eada8,0xa246afd9ab8b2da8,0x2ea7aa1fafd90000,0xac72af64263e3000,0x2b8baea7ad132da8,0xaf0eac722e2f2da8
.quad 0x3000300030003000,0x0,0x2ff62fd92fa82f64,0xa246a63ea8a5aa1f,0x2fd92f642ea72da8,0xa63eaa1fac72ada8,0x2fa82ea72d132a1f,0xa8a5ac72ae2faf64
.quad 0x2f642da82a1f0000,0xaa1fada8af64b000,0x2f0e2c722246aa1f,0xab8baea7aff6af64,0x2ea72a1fa63eada8,0xac72af64afd9ada8,0x2e2f263eab8baf64,0xad13afd9af0eaa1f
.quad 0x2da80000ada8b000,0xada8b000ada80000,0x2d13a63eaf0eaf64,0xae2fafd9ab8b2a1f,0x2c72aa1fafd9ada8,0xaea7af64a63e2da8,0x2b8bac72aff6aa1f,0xaf0eaea722462f64
.quad 0x2a1fada8af640000,0xaf64ada82a1f3000,0x28a5aea7ae2f2a1f,0xafa8ac722d132f64,0x263eaf64ac722da8,0xafd9aa1f2ea72da8,0x2246afd9a8a52f64,0xaff6a63e2fa82a1f
.quad 0x3e003e003e003e00,0x0,0x3df53dfb3dff3e00,0xbd15bcc8bc490000,0x3dd53ded3dfb3e00,0xbd8ebd44bcc80000,0x3da23dd53df53e00,0xbdc6bd8ebd150000
.quad 0x3d443db53ded3e00,0xbdedbdb5bd440000,0x3c493d8e3de23e00,0xbdffbdd5bd710000,0xbcc83d443dd53e00,0xbdfbbdedbd8e0000,0xbd713cc83dc63e00,0xbde2bdfbbda20000
.quad 0xbdb500003db53e00,0xbdb5be00bdb50000,0xbde2bcc83da23e00,0xbd71bdfbbdc60000,0xbdfbbd443d8e3e00,0xbcc8bdedbdd50000,0xbdffbd8e3d713e00,0x3c49bdd5bde20000
.quad 0xbdedbdb53d443e00,0x3d44bdb5bded0000,0xbdc6bdd53d153e00,0x3da2bd8ebdf50000,0xbd8ebded3cc83e00,0x3dd5bd44bdfb0000,0xbd15bdfb3c493e00,0x3df5bcc8bdff0000
.quad 0x3e003e003e003e00,0x0,0x3dc63dd53de23ded,0xbda2bd8ebd71bd44,0x3cc83d443d8e3db5,0xbdfbbdedbdd5bdb5,0xbd71bcc83c493d44,0xbde2bdfbbdffbded
.quad 0xbdedbdb5bd440000,0xbd44bdb5bdedbe00,0xbdf5bdfbbdc6bd44,0x3d15bcc8bda2bded,0xbd8ebdedbdfbbdb5,0x3dd53d44bcc8bdb5,0x3c49bd8ebdf5bded,0x3dff3dd53d15bd44
.quad 0x3db50000bdb5be00,0x3db53e003db50000,0x3dff3d8ebd15bded,0x3c493dd53df53d44,0x3dd53ded3cc8bdb5,0xbd8e3d443dfb3db5,0x3d153dfb3da2bd44,0xbdf5bcc83dc63ded
.quad 0xbd443db53ded0000,0xbdedbdb53d443e00,0xbde23cc83dff3d44,0xbd71bdfbbc493ded,0xbdfbbd443dd53db5,0x3cc8bdedbd8e3db5,0xbda2bdd53d713ded,0x3dc6bd8ebde23d44
.quad 0x3e003e003e003e00,0x0,0x3d713d8e3da23db5,0xbde2bdd5bdc6bdb5,0xbd8ebd44bcc80000,0xbdd5bdedbdfbbe00,0xbdffbdfbbde2bdb5,0x3c49bcc8bd71bdb5
.quad 0xbd44bdb5bdedbe00,0x3ded3db53d440000,0x3da23cc8bd15bdb5,0x3dc63dfb3df53db5,0x3dfb3ded3d8e0000,0xbcc83d443dd53e00,0x3d153dd53dff3db5,0xbdf5bd8e3c493db5
.quad 0xbdb500003db53e00,0xbdb5be00bdb50000,0xbdf5bdd5bc493db5,0x3d15bd8ebdffbdb5,0xbcc8bdedbdd50000,0x3dfb3d44bd8ebe00,0x3dc6bcc8bdf5bdb5,0x3da23dfb3d15bdb5
.quad 0x3ded3db5bd44be00,0xbd443db53ded0000,0x3c493dfb3d71bdb5,0xbdffbcc83de23db5,0xbdd53d443dfb0000,0xbd8ebded3cc83e00,0xbde2bd8e3dc63db5,0x3d71bdd5bda23db5
.quad 0x3e003e003e003e00,0x0,0x3c493cc83d153d44,0xbdffbdfbbdf5bded,0xbdfbbdedbdd5bdb5,0xbcc8bd44bd8ebdb5,0xbd15bd8ebdc6bded,0x3df53dd53da23d44
.quad 0x3ded3db53d440000,0x3d443db53ded3e00,0x3d713dd53dff3ded,0xbde2bd8ebc493d44,0xbdd5bd443cc83db5,0xbd8ebdedbdfbbdb5,0xbda2bdfbbde2bd44,0x3dc63cc8bd71bded
.quad 0x3db50000bdb5be00,0x3db53e003db50000,0x3dc63dfb3d71bd44,0xbda23cc83de23ded,0xbd8e3d443dfb3db5,0xbdd5bdedbcc83db5,0xbde2bdd53c493ded,0x3d71bd8ebdffbd44
.quad 0x3d44bdb5bded0000,0x3ded3db5bd44be00,0x3df53d8ebda2bded,0xbd153dd53dc6bd44,0xbcc83ded3d8ebdb5,0xbdfbbd443dd53db5,0xbdffbcc83df53d44,0x3c49bdfbbd153ded
.quad 0x3e003e003e003e00,0x0,0xbd15bcc8bc490000,0xbdf5bdfbbdffbe00,0xbdd5bdedbdfbbe00,0x3d8e3d443cc80000,0x3dc63d8e3d150000,0x3da23dd53df53e00
.quad 0x3d443db53ded3e00,0xbdedbdb5bd440000,0xbdffbdd5bd710000,0xbc49bd8ebde2be00,0x3cc8bd44bdd5be00,0x3dfb3ded3d8e0000,0x3de23dfb3da20000,0xbd713cc83dc63e00
.quad 0xbdb500003db53e00,0xbdb5be00bdb50000,0xbd71bdfbbdc60000,0x3de23cc8bda2be00,0x3dfb3d44bd8ebe00,0x3cc83ded3dd50000,0xbc493dd53de20000,0xbdffbd8e3d713e00
.quad 0xbdedbdb53d443e00,0x3d44bdb5bded0000,0x3da2bd8ebdf50000,0x3dc63dd5bd15be00,0x3d8e3dedbcc8be00,0xbdd53d443dfb0000,0xbdf53cc83dff0000,0xbd15bdfb3c493e00
.quad 0x3e003e003e003e00,0x0,0xbda2bd8ebd71bd44,0xbdc6bdd5bde2bded,0xbcc8bd44bd8ebdb5,0x3dfb3ded3dd53db5,0x3de23dfb3dff3ded,0xbd71bcc83c493d44
.quad 0xbdedbdb5bd440000,0xbd44bdb5bdedbe00,0x3d15bcc8bda2bded,0x3df53dfb3dc63d44,0x3d8e3ded3dfb3db5,0xbdd5bd443cc83db5,0xbdffbdd5bd153d44,0x3c49bd8ebdf5bded
.quad 0x3db50000bdb5be00,0x3db53e003db50000,0x3c493dd53df53d44,0xbdffbd8e3d153ded,0xbdd5bdedbcc83db5,0x3d8ebd44bdfbbdb5,0x3df53cc8bdc6bded,0x3d153dfb3da2bd44
.quad 0xbd443db53ded0000,0xbdedbdb53d443e00,0xbd71bdfbbc493ded,0x3de2bcc8bdffbd44,0x3dfb3d44bdd5bdb5,0xbcc83ded3d8ebdb5,0xbdc63d8e3de2bd44,0xbda2bdd53d713ded
.quad 0x3e003e003e003e00,0x0,0xbde2bdd5bdc6bdb5,0xbd71bd8ebda2bdb5,0x3d8e3d443cc80000,0x3dd53ded3dfb3e00,0xbc493cc83d713db5,0xbdffbdfbbde2bdb5
.quad 0xbd44bdb5bdedbe00,0x3ded3db53d440000,0x3dc63dfb3df53db5,0xbda2bcc83d153db5,0xbdfbbdedbd8e0000,0x3cc8bd44bdd5be00,0x3df53d8ebc49bdb5,0x3d153dd53dff3db5
.quad 0xbdb500003db53e00,0xbdb5be00bdb50000,0x3d15bd8ebdffbdb5,0x3df53dd53c49bdb5,0x3cc83ded3dd50000,0xbdfbbd443d8e3e00,0xbda2bdfbbd153db5,0x3dc6bcc8bdf5bdb5
.quad 0x3ded3db5bd44be00,0xbd443db53ded0000,0xbdffbcc83de23db5,0xbc49bdfbbd713db5,0x3dd5bd44bdfb0000,0x3d8e3dedbcc8be00,0xbd713dd53da2bdb5,0xbde2bd8e3dc63db5
.quad 0x3e003e003e003e00,0x0,0xbdffbdfbbdf5bded,0xbc49bcc8bd15bd44,0x3dfb3ded3dd53db5,0x3cc83d443d8e3db5,0xbdf5bdd5bda2bd44,0xbd15bd8ebdc6bded
.quad 0x3ded3db53d440000,0x3d443db53ded3e00,0xbde2bd8ebc493d44,0xbd71bdd5bdffbded,0x3dd53d44bcc8bdb5,0x3d8e3ded3dfb3db5,0xbdc6bcc83d713ded,0xbda2bdfbbde2bd44
.quad 0x3db50000bdb5be00,0x3db53e003db50000,0xbda23cc83de23ded,0xbdc6bdfbbd713d44,0x3d8ebd44bdfbbdb5,0x3dd53ded3cc8bdb5,0xbd713d8e3dff3d44,0xbde2bdd53c493ded
.quad 0x3d44bdb5bded0000,0x3ded3db5bd44be00,0xbd153dd53dc6bd44,0xbdf5bd8e3da23ded,0x3cc8bdedbd8e3db5,0x3dfb3d44bdd5bdb5,0xbc493dfb3d15bded,0xbdffbcc83df53d44
.quad 0x3e003e003e003e00,0x0,0xbdf5bdfbbdffbe00,0x3d153cc83c490000,0x3dd53ded3dfb3e00,0xbd8ebd44bcc80000,0xbda2bdd5bdf5be00,0x3dc63d8e3d150000
.quad 0x3d443db53ded3e00,0xbdedbdb5bd440000,0xbc49bd8ebde2be00,0x3dff3dd53d710000,0xbcc83d443dd53e00,0xbdfbbdedbd8e0000,0x3d71bcc8bdc6be00,0x3de23dfb3da20000
.quad 0xbdb500003db53e00,0xbdb5be00bdb50000,0x3de23cc8bda2be00,0x3d713dfb3dc60000,0xbdfbbd443d8e3e00,0xbcc8bdedbdd50000,0x3dff3d8ebd71be00,0xbc493dd53de20000
.quad 0xbdedbdb53d443e00,0x3d44bdb5bded0000,0x3dc63dd5bd15be00,0xbda23d8e3df50000,0xbd8ebded3cc83e00,0x3dd5bd44bdfb0000,0x3d153dfbbc49be00,0xbdf53cc83dff0000
.quad 0x3e003e003e003e00,0x0,0xbdc6bdd5bde2bded,0x3da23d8e3d713d44,0x3cc83d443d8e3db5,0xbdfbbdedbdd5bdb5,0x3d713cc8bc49bd44,0x3de23dfb3dff3ded
.quad 0xbdedbdb5bd440000,0xbd44bdb5bdedbe00,0x3df53dfb3dc63d44,0xbd153cc83da23ded,0xbd8ebdedbdfbbdb5,0x3dd53d44bcc8bdb5,0xbc493d8e3df53ded,0xbdffbdd5bd153d44
.quad 0x3db50000bdb5be00,0x3db53e003db50000,0xbdffbd8e3d153ded,0xbc49bdd5bdf5bd44,0x3dd53ded3cc8bdb5,0xbd8e3d443dfb3db5,0xbd15bdfbbda23d44,0x3df53cc8bdc6bded
.quad 0xbd443db53ded0000,0xbdedbdb53d443e00,0x3de2bcc8bdffbd44,0x3d713dfb3c49bded,0xbdfbbd443dd53db5,0x3cc8bdedbd8e3db5,0x3da23dd5bd71bded,0xbdc63d8e3de2bd44
.quad 0x3e003e003e003e00,0x0,0xbd71bd8ebda2bdb5,0x3de23dd53dc63db5,0xbd8ebd44bcc80000,0xbdd5bdedbdfbbe00,0x3dff3dfb3de23db5,0xbc493cc83d713db5
.quad 0xbd44bdb5bdedbe00,0x3ded3db53d440000,0xbda2bcc83d153db5,0xbdc6bdfbbdf5bdb5,0x3dfb3ded3d8e0000,0xbcc83d443dd53e00,0xbd15bdd5bdffbdb5,0x3df53d8ebc49bdb5
.quad 0xbdb500003db53e00,0xbdb5be00bdb50000,0x3df53dd53c49bdb5,0xbd153d8e3dff3db5,0xbcc8bdedbdd50000,0x3dfb3d44bd8ebe00,0xbdc63cc83df53db5,0xbda2bdfbbd153db5
.quad 0x3ded3db5bd44be00,0xbd443db53ded0000,0xbc49bdfbbd713db5,0x3dff3cc8bde2bdb5,0xbdd53d443dfb0000,0xbd8ebded3cc83e00,0x3de23d8ebdc6bdb5,0xbd713dd53da2bdb5
.quad 0x3e003e003e003e00,0x0,0xbc49bcc8bd15bd44,0x3dff3dfb3df53ded,0xbdfbbdedbdd5bdb5,0xbcc8bd44bd8ebdb5,0x3d153d8e3dc63ded,0xbdf5bdd5bda2bd44
.quad 0x3ded3db53d440000,0x3d443db53ded3e00,0xbd71bdd5bdffbded,0x3de23d8e3c49bd44,0xbdd5bd443cc83db5,0xbd8ebdedbdfbbdb5,0x3da23dfb3de23d44,0xbdc6bcc83d713ded
.quad 0x3db50000bdb5be00,0x3db53e003db50000,0xbdc6bdfbbd713d44,0x3da2bcc8bde2bded,0xbd8e3d443dfb3db5,0xbdd5bdedbcc83db5,0x3de23dd5bc49bded,0xbd713d8e3dff3d44
.quad 0x3d44bdb5bded0000,0x3ded3db5bd44be00,0xbdf5bd8e3da23ded,0x3d15bdd5bdc63d44,0xbcc83ded3d8ebdb5,0xbdfbbd443dd53db5,0x3dff3cc8bdf5bd44,0xbc493dfb3d15bded
.quad 0x3e003e003e003e00,0x0,0x3d153cc83c490000,0x3df53dfb3dff3e00,0xbdd5bdedbdfbbe00,0x3d8e3d443cc80000,0xbdc6bd8ebd150000,0xbda2bdd5bdf5be00
.quad 0x3d443db53ded3e00,0xbdedbdb5bd440000,0x3dff3dd53d710000,0x3c493d8e3de23e00,0x3cc8bd44bdd5be00,0x3dfb3ded3d8e0000,0xbde2bdfbbda20000,0x3d71bcc8bdc6be00
.quad 0xbdb500003db53e00,0xbdb5be00bdb50000,0x3d713dfb3dc60000,0xbde2bcc83da23e00,0x3dfb3d44bd8ebe00,0x3cc83ded3dd50000,0x3c49bdd5bde20000,0x3dff3d8ebd71be00
.quad 0xbdedbdb53d443e00,0x3d44bdb5bded0000,0xbda23d8e3df50000,0xbdc6bdd53d153e00,0x3d8e3dedbcc8be00,0xbdd53d443dfb0000,0x3df5bcc8bdff0000,0x3d153dfbbc49be00
.quad 0x3e003e003e003e00,0x0,0x3da23d8e3d713d44,0x3dc63dd53de23ded,0xbcc8bd44bd8ebdb5,0x3dfb3ded3dd53db5,0xbde2bdfbbdffbded,0x3d713cc8bc49bd44
.quad 0xbdedbdb5bd440000,0xbd44bdb5bdedbe00,0xbd153cc83da23ded,0xbdf5bdfbbdc6bd44,0x3d8e3ded3dfb3db5,0xbdd5bd443cc83db5,0x3dff3dd53d15bd44,0xbc493d8e3df53ded
.quad 0x3db50000bdb5be00,0x3db53e003db50000,0xbc49bdd5bdf5bd44,0x3dff3d8ebd15bded,0xbdd5bdedbcc83db5,0x3d8ebd44bdfbbdb5,0xbdf5bcc83dc63ded,0xbd15bdfbbda23d44
.quad 0xbd443db53ded0000,0xbdedbdb53d443e00,0x3d713dfb3c49bded,0xbde23cc83dff3d44,0x3dfb3d44bdd5bdb5,0xbcc83ded3d8ebdb5,0x3dc6bd8ebde23d44,0x3da23dd5bd71bded
.quad 0x3e003e003e003e00,0x0,0x3de23dd53dc63db5,0x3d713d8e3da23db5,0x3d8e3d443cc80000,0x3dd53ded3dfb3e00,0x3c49bcc8bd71bdb5,0x3dff3dfb3de23db5
.quad 0xbd44bdb5bdedbe00,0x3ded3db53d440000,0xbdc6bdfbbdf5bdb5,0x3da23cc8bd15bdb5,0xbdfbbdedbd8e0000,0x3cc8bd44bdd5be00,0xbdf5bd8e3c493db5,0xbd15bdd5bdffbdb5
.quad 0xbdb500003db53e00,0xbdb5be00bdb50000,0xbd153d8e3dff3db5,0xbdf5bdd5bc493db5,0x3cc83ded3dd50000,0xbdfbbd443d8e3e00,0x3da23dfb3d15bdb5,0xbdc63cc83df53db5
.quad 0x3ded3db5bd44be00,0xbd443db53ded0000,0x3dff3cc8bde2bdb5,0x3c493dfb3d71bdb5,0x3dd5bd44bdfb0000,0x3d8e3dedbcc8be00,0x3d71bdd5bda23db5,0x3de23d8ebdc6bdb5
.quad 0x3e003e003e003e00,0x0,0x3dff3dfb3df53ded,0x3c493cc83d153d44,0x3dfb3ded3dd53db5,0x3cc83d443d8e3db5,0x3df53dd53da23d44,0x3d153d8e3dc63ded
.quad 0x3ded3db53d440000,0x3d443db53ded3e00,0x3de23d8e3c49bd44,0x3d713dd53dff3ded,0x3dd53d44bcc8bdb5,0x3d8e3ded3dfb3db5,0x3dc63cc8bd71bded,0x3da23dfb3de23d44
.quad 0x3db50000bdb5be00,0x3db53e003db50000,0x3da2bcc8bde2bded,0x3dc63dfb3d71bd44,0x3d8ebd44bdfbbdb5,0x3dd53ded3cc8bdb5,0x3d71bd8ebdffbd44,0x3de23dd5bc49bded
.quad 0x3d44bdb5bded0000,0x3ded3db5bd44be00,0x3d15bdd5bdc63d44,0x3df53d8ebda2bded,0x3cc8bdedbd8e3db5,0x3dfb3d44bdd5bdb5,0x3c49bdfbbd153ded,0x3dff3cc8bdf5bd44
.quad 0xb00000003000,0xb000000030000000,0x2fa8263eaff60000,0x28a5afd9a2463000,0xac722f64263eb000,0x2ea72a1fafd90000,0xad13ac722fa80000,0xae2f2ea728a5b000
.quad 0x2f64ada8aa1f3000,0xaa1fada82f640000,0x22462ea7af0e0000,0x2ff6ac72ab8b3000,0xafd92a1f2c72b000,0xa63e2f64aea70000,0x2b8bafd92e2f0000,0xaf0e263e2d13b000
.quad 0x2da80000ada83000,0x2da8b0002da80000,0xaf0e2fd9ad130000,0x2b8b263eae2f3000,0xa63eaa1f2ea7b000,0xafd92f64ac720000,0x2ff6aea72b8b0000,0x2246ac722f0eb000
.quad 0xaa1f2da8af643000,0x2f64ada82a1f0000,0xae2f2c72a8a50000,0xad132ea7afa83000,0x2ea7af642fd9b000,0xac722a1fa63e0000,0x28a5a63e22460000,0x2fa8afd92ff6b000
.quad 0xb00000003000,0xb000000030000000,0x2e2f2c72af0eaa1f,0x2d13aea7ab8b2f64,0xafd92a1f2ea7ada8,0x263e2f64ac72ada8,0x2b8bafd922462f64,0xaf0ea63e2ff6aa1f
.quad 0x2a1f2da8af640000,0x2f64ada8aa1f3000,0xafa8263e2e2faf64,0xa8a52fd9ad13aa1f,0x2ea7af64263e2da8,0xac72aa1f2fd9ada8,0xa2462ea7afa82a1f,0x2ff6ac72a8a52f64
.quad 0xada800002da8b000,0xada83000ada80000,0x2ff6aea728a52a1f,0xa246ac722fa8af64,0xac722f64afd92da8,0x2ea7aa1fa63e2da8,0xa8a5a63e2d13af64,0xafa82fd9ae2f2a1f
.quad 0x2f64ada82a1f0000,0x2a1fada82f64b000,0xaf0e2fd9aff62f64,0x2b8ba63ea2462a1f,0x263eaa1f2c72ada8,0xafd92f64aea72da8,0x2d13ac722b8baa1f,0x2e2faea72f0eaf64
.quad 0xb00000003000,0xb000000030000000,0x2b8b2ea7ad13ada8,0x2f0eac72ae2f2da8,0xaea7aa1f2fd90000,0xac722f64263eb000,0x2ff6a63eaf0e2da8,0x2246afd92b8b2da8
.quad 0xaf642da82a1fb000,0x2a1f2da8af640000,0x2d13afd928a52da8,0xae2fa63e2fa8ada8,0xa63e2f64aea70000,0x2fd9aa1fac723000,0xa8a5ac722ff6ada8,0xafa82ea7a246ada8
.quad 0x2da80000ada83000,0x2da8b0002da80000,0xafa82c722246ada8,0xa8a52ea7aff62da8,0x2fd9af642c720000,0xa63eaa1f2ea7b000,0xae2f2fd9afa82da8,0x2d13a63ea8a52da8
.quad 0x2a1fada82f64b000,0xaf642da8aa1f0000,0x2246263eab8b2da8,0x2ff6afd92f0eada8,0xac722a1fa63e0000,0xaea72f64afd93000,0x2f0eaea72e2fada8,0x2b8bac722d13ada8
.quad 0xb00000003000,0xb000000030000000,0x22462fd9a8a5af64,0x2ff6a63eafa82a1f,0xa63eaf642c722da8,0xafd92a1f2ea7ada8,0x28a52ea7ae2faa1f,0x2fa8ac72ad132f64
.quad 0xaa1fada82f640000,0xaf642da82a1fb000,0x2b8b2c72aff62a1f,0x2f0eaea7a2462f64,0xac72aa1f2fd9ada8,0xaea72f64a63eada8,0x2d13263eaf0e2f64,0x2e2fafd92b8b2a1f
.quad 0xada800002da8b000,0xada83000ada80000,0x2e2fa63eab8b2f64,0x2d13afd92f0eaa1f,0xaea72a1f263eada8,0xac722f64afd92da8,0x2f0eac7222462a1f,0x2b8baea72ff6af64
.quad 0xaf642da8aa1f0000,0xaa1f2da8af643000,0x2fa8aea72d13aa1f,0x28a5ac722e2faf64,0xafd92f64aea72da8,0xa63e2a1fac722da8,0x2ff6afd92fa8af64,0x2246a63e28a5aa1f
.quad 0xb00000003000,0xb000000030000000,0xa8a52fd92246b000,0x2fa8263eaff60000,0x2c72af64a63e3000,0xaea7aa1f2fd90000,0xae2f2ea728a5b000,0x2d132c72afa80000
.quad 0x2f64ada8aa1f3000,0xaa1fada82f640000,0xaff62c722b8bb000,0x22462ea7af0e0000,0x2fd9aa1fac723000,0x263eaf642ea70000,0xaf0e263e2d13b000,0xab8b2fd9ae2f0000
.quad 0x2da80000ada83000,0x2da8b0002da80000,0xab8ba63e2e2fb000,0xaf0e2fd9ad130000,0x263e2a1faea73000,0x2fd9af642c720000,0x2246ac722f0eb000,0xaff62ea7ab8b0000
.quad 0xaa1f2da8af643000,0x2f64ada82a1f0000,0x2d13aea72fa8b000,0xae2f2c72a8a50000,0xaea72f64afd93000,0x2c72aa1f263e0000,0x2fa8afd92ff6b000,0xa8a5263ea2460000
.quad 0xb00000003000,0xb000000030000000,0xad132ea72b8baf64,0x2e2f2c72af0eaa1f,0x2fd9aa1faea72da8,0xa63eaf642c722da8,0xaf0ea63e2ff6aa1f,0xab8b2fd9a246af64
.quad 0x2a1f2da8af640000,0x2f64ada8aa1f3000,0x28a5afd92d132a1f,0xafa8263e2e2faf64,0xaea72f64a63eada8,0x2c722a1fafd92da8,0x2ff6ac72a8a52f64,0x2246aea72fa8aa1f
.quad 0xada800002da8b000,0xada83000ada80000,0x22462c72afa82f64,0x2ff6aea728a52a1f,0x2c72af642fd9ada8,0xaea72a1f263eada8,0xafa82fd9ae2f2a1f,0x28a5263ead132f64
.quad 0x2f64ada82a1f0000,0x2a1fada82f64b000,0xab8b263e2246aa1f,0xaf0e2fd9aff62f64,0xa63e2a1fac722da8,0x2fd9af642ea7ada8,0x2e2faea72f0eaf64,0xad132c72ab8b2a1f
.quad 0xb00000003000,0xb000000030000000,0xaf0e2c722e2fada8,0x2b8b2ea7ad13ada8,0x2ea72a1fafd90000,0x2c72af64a63e3000,0x2246afd92b8b2da8,0xaff6263e2f0eada8
.quad 0xaf642da82a1fb000,0x2a1f2da8af640000,0x2e2f263eafa82da8,0x2d13afd928a52da8,0x263eaf642ea70000,0xafd92a1f2c72b000,0xafa82ea7a246ada8,0x28a52c72aff62da8
.quad 0x2da80000ada83000,0x2da8b0002da80000,0x28a5aea72ff6ada8,0xafa82c722246ada8,0xafd92f64ac720000,0x263e2a1faea73000,0x2d13a63ea8a52da8,0x2e2fafd92fa8ada8
.quad 0x2a1fada82f64b000,0xaf642da8aa1f0000,0xaff62fd9af0e2da8,0x2246263eab8b2da8,0x2c72aa1f263e0000,0x2ea7af642fd9b000,0x2b8bac722d13ada8,0xaf0e2ea7ae2f2da8
.quad 0xb00000003000,0xb000000030000000,0xaff6263e2fa8aa1f,0x22462fd9a8a5af64,0x263e2f64ac72ada8,0x2fd9aa1faea72da8,0x2fa8ac72ad132f64,0xa8a5aea72e2f2a1f
.quad 0xaa1fada82f640000,0xaf642da82a1fb000,0xaf0e2ea72246af64,0x2b8b2c72aff62a1f,0x2c722a1fafd92da8,0x2ea7af64263e2da8,0x2e2fafd92b8b2a1f,0xad13a63e2f0eaf64
.quad 0xada800002da8b000,0xada83000ada80000,0xad132fd9af0e2a1f,0x2e2fa63eab8b2f64,0x2ea7aa1fa63e2da8,0x2c72af642fd9ada8,0x2b8baea72ff6af64,0xaf0e2c72a246aa1f
.quad 0xaf642da8aa1f0000,0xaa1f2da8af643000,0xa8a52c72ae2f2f64,0x2fa8aea72d13aa1f,0x2fd9af642ea7ada8,0x263eaa1f2c72ada8,0x2246a63e28a5aa1f,0xaff62fd9afa82f64
.quad 0xb00000003000,0xb000000030000000,0xafa8a63e2ff60000,0xa8a52fd92246b000,0xac722f64263eb000,0x2ea72a1fafd90000,0x2d132c72afa80000,0x2e2faea7a8a53000
.quad 0x2f64ada8aa1f3000,0xaa1fada82f640000,0xa246aea72f0e0000,0xaff62c722b8bb000,0xafd92a1f2c72b000,0xa63e2f64aea70000,0xab8b2fd9ae2f0000,0x2f0ea63ead133000
.quad 0x2da80000ada83000,0x2da8b0002da80000,0x2f0eafd92d130000,0xab8ba63e2e2fb000,0xa63eaa1f2ea7b000,0xafd92f64ac720000,0xaff62ea7ab8b0000,0xa2462c72af0e3000
.quad 0xaa1f2da8af643000,0x2f64ada82a1f0000,0x2e2fac7228a50000,0x2d13aea72fa8b000,0x2ea7af642fd9b000,0xac722a1fa63e0000,0xa8a5263ea2460000,0xafa82fd9aff63000
.quad 0xb00000003000,0xb000000030000000,0xae2fac722f0e2a1f,0xad132ea72b8baf64,0xafd92a1f2ea7ada8,0x263e2f64ac72ada8,0xab8b2fd9a246af64,0x2f0e263eaff62a1f
.quad 0x2a1f2da8af640000,0x2f64ada8aa1f3000,0x2fa8a63eae2f2f64,0x28a5afd92d132a1f,0x2ea7af64263e2da8,0xac72aa1f2fd9ada8,0x2246aea72fa8aa1f,0xaff62c7228a5af64
.quad 0xada800002da8b000,0xada83000ada80000,0xaff62ea7a8a5aa1f,0x22462c72afa82f64,0xac722f64afd92da8,0x2ea7aa1fa63e2da8,0x28a5263ead132f64,0x2fa8afd92e2faa1f
.quad 0x2f64ada82a1f0000,0x2a1fada82f64b000,0x2f0eafd92ff6af64,0xab8b263e2246aa1f,0x263eaa1f2c72ada8,0xafd92f64aea72da8,0xad132c72ab8b2a1f,0xae2f2ea7af0e2f64
.quad 0xb00000003000,0xb000000030000000,0xab8baea72d132da8,0xaf0e2c722e2fada8,0xaea7aa1f2fd90000,0xac722f64263eb000,0xaff6263e2f0eada8,0xa2462fd9ab8bada8
.quad 0xaf642da82a1fb000,0x2a1f2da8af640000,0xad132fd9a8a5ada8,0x2e2f263eafa82da8,0xa63e2f64aea70000,0x2fd9aa1fac723000,0x28a52c72aff62da8,0x2fa8aea722462da8
.quad 0x2da80000ada83000,0x2da8b0002da80000,0x2fa8ac72a2462da8,0x28a5aea72ff6ada8,0x2fd9af642c720000,0xa63eaa1f2ea7b000,0x2e2fafd92fa8ada8,0xad13263e28a5ada8
.quad 0x2a1fada82f64b000,0xaf642da8aa1f0000,0xa246a63e2b8bada8,0xaff62fd9af0e2da8,0xac722a1fa63e0000,0xaea72f64afd93000,0xaf0e2ea7ae2f2da8,0xab8b2c72ad132da8
.quad 0xb00000003000,0xb000000030000000,0xa246afd928a52f64,0xaff6263e2fa8aa1f,0xa63eaf642c722da8,0xafd92a1f2ea7ada8,0xa8a5aea72e2f2a1f,0xafa82c722d13af64
.quad 0xaa1fada82f640000,0xaf642da82a1fb000,0xab8bac722ff6aa1f,0xaf0e2ea72246af64,0xac72aa1f2fd9ada8,0xaea72f64a63eada8,0xad13a63e2f0eaf64,0xae2f2fd9ab8baa1f
.quad 0xada800002da8b000,0xada83000ada80000,0xae2f263e2b8baf64,0xad132fd9af0e2a1f,0xaea72a1f263eada8,0xac722f64afd92da8,0xaf0e2c72a246aa1f,0xab8b2ea7aff62f64
.quad 0xaf642da8aa1f0000,0xaa1f2da8af643000,0xafa82ea7ad132a1f,0xa8a52c72ae2f2f64,0xafd92f64aea72da8,0xa63e2a1fac722da8,0xaff62fd9afa82f64,0xa246263ea8a52a1f
.quad 0xb00000003000,0xb000000030000000,0x28a5afd9a2463000,0xafa8a63e2ff60000,0x2c72af64a63e3000,0xaea7aa1f2fd90000,0x2e2faea7a8a53000,0xad13ac722fa80000
.quad 0x2f64ada8aa1f3000,0xaa1fada82f640000,0x2ff6ac72ab8b3000,0xa246aea72f0e0000,0x2fd9aa1fac723000,0x263eaf642ea70000,0x2f0ea63ead133000,0x2b8bafd92e2f0000
.quad 0x2da80000ada83000,0x2da8b0002da80000,0x2b8b263eae2f3000,0x2f0eafd92d130000,0x263e2a1faea73000,0x2fd9af642c720000,0xa2462c72af0e3000,0x2ff6aea72b8b0000
.quad 0xaa1f2da8af643000,0x2f64ada82a1f0000,0xad132ea7afa83000,0x2e2fac7228a50000,0xaea72f64afd93000,0x2c72aa1f263e0000,0xafa82fd9aff63000,0x28a5a63e22460000
.quad 0xb00000003000,0xb000000030000000,0x2d13aea7ab8b2f64,0xae2fac722f0e2a1f,0x2fd9aa1faea72da8,0xa63eaf642c722da8,0x2f0e263eaff62a1f,0x2b8bafd922462f64
.quad 0x2a1f2da8af640000,0x2f64ada8aa1f3000,0xa8a52fd9ad13aa1f,0x2fa8a63eae2f2f64,0xaea72f64a63eada8,0x2c722a1fafd92da8,0xaff62c7228a5af64,0xa2462ea7afa82a1f
.quad 0xada800002da8b000,0xada83000ada80000,0xa246ac722fa8af64,0xaff62ea7a8a5aa1f,0x2c72af642fd9ada8,0xaea72a1f263eada8,0x2fa8afd92e2faa1f,0xa8a5a63e2d13af64
.quad 0x2f64ada82a1f0000,0x2a1fada82f64b000,0x2b8ba63ea2462a1f,0x2f0eafd92ff6af64,0xa63e2a1fac722da8,0x2fd9af642ea7ada8,0xae2f2ea7af0e2f64,0x2d13ac722b8baa1f
.quad 0xb00000003000,0xb000000030000000,0x2f0eac72ae2f2da8,0xab8baea72d132da8,0x2ea72a1fafd90000,0x2c72af64a63e3000,0xa2462fd9ab8bada8,0x2ff6a63eaf0e2da8
.quad 0xaf642da82a1fb000,0x2a1f2da8af640000,0xae2fa63e2fa8ada8,0xad132fd9a8a5ada8,0x263eaf642ea70000,0xafd92a1f2c72b000,0x2fa8aea722462da8,0xa8a5ac722ff6ada8
.quad 0x2da80000ada83000,0x2da8b0002da80000,0xa8a52ea7aff62da8,0x2fa8ac72a2462da8,0xafd92f64ac720000,0x263e2a1faea73000,0xad13263e28a5ada8,0xae2f2fd9afa82da8
.quad 0x2a1fada82f64b000,0xaf642da8aa1f0000,0x2ff6afd92f0eada8,0xa246a63e2b8bada8,0x2c72aa1f263e0000,0x2ea7af642fd9b000,0xab8b2c72ad132da8,0x2f0eaea72e2fada8
.quad 0xb00000003000,0xb000000030000000,0x2ff6a63eafa82a1f,0xa246afd928a52f64,0x263e2f64ac72ada8,0x2fd9aa1faea72da8,0xafa82c722d13af64,0x28a52ea7ae2faa1f
.quad 0xaa1fada82f640000,0xaf642da82a1fb000,0x2f0eaea7a2462f64,0xab8bac722ff6aa1f,0x2c722a1fafd92da8,0x2ea7af64263e2da8,0xae2f2fd9ab8baa1f,0x2d13263eaf0e2f64
.quad 0xada800002da8b000,0xada83000ada80000,0x2d13afd92f0eaa1f,0xae2f263e2b8baf64,0x2ea7aa1fa63e2da8,0x2c72af642fd9ada8,0xab8b2ea7aff62f64,0x2f0eac7222462a1f
.quad 0xaf642da8aa1f0000,0xaa1f2da8af643000,0x28a5ac722e2faf64,0xafa82ea7ad132a1f,0x2fd9af642ea7ada8,0x263eaa1f2c72ada8,0xa246263ea8a52a1f,0x2ff6afd92fa8af64
.quad 0xbe0000003e00,0x3e000000be000000,0x3df53cc8bdff0000,0xbd153dfb3c49be00,0xbd8e3ded3cc8be00,0xbdd5bd443dfb0000,0xbda2bd8e3df50000,0x3dc6bdd5bd153e00
.quad 0x3dedbdb5bd443e00,0x3d443db5bded0000,0x3c493dd5bde20000,0xbdff3d8e3d71be00,0xbdfb3d443d8ebe00,0x3cc8bded3dd50000,0x3d71bdfb3dc60000,0x3de2bcc8bda23e00
.quad 0x3db50000bdb53e00,0xbdb53e00bdb50000,0xbde23dfbbda20000,0xbd71bcc83dc6be00,0xbcc8bd443dd5be00,0x3dfbbded3d8e0000,0x3dffbdd53d710000,0xbc493d8ebde23e00
.quad 0xbd443db5bded3e00,0xbded3db5bd440000,0xbdc63d8ebd150000,0x3da2bdd53df5be00,0x3dd5bded3dfbbe00,0x3d8ebd443cc80000,0x3d15bcc83c490000,0xbdf53dfbbdff3e00
.quad 0xbe0000003e00,0x3e000000be000000,0x3dc63d8ebde2bd44,0xbda23dd53d71bded,0xbdfb3d443dd5bdb5,0xbcc8bded3d8e3db5,0x3d71bdfb3c493ded,0x3de23cc8bdff3d44
.quad 0x3d443db5bded0000,0xbded3db53d44be00,0xbdf53cc83dc6bded,0x3d15bdfb3da23d44,0x3dd5bded3cc83db5,0x3d8e3d44bdfb3db5,0xbc493dd5bdf53d44,0xbdff3d8e3d15bded
.quad 0xbdb500003db5be00,0x3db5be003db50000,0x3dffbdd53d153d44,0x3c493d8ebdf53ded,0xbd8e3dedbdfb3db5,0xbdd53d443cc8bdb5,0xbd15bcc83da2bded,0x3df5bdfb3dc6bd44
.quad 0x3dedbdb53d440000,0xbd443db5bded3e00,0xbde23dfbbdff3ded,0xbd713cc83c49bd44,0x3cc8bd443d8ebdb5,0x3dfbbded3dd5bdb5,0x3da2bd8e3d71bd44,0xbdc63dd5bde23ded
.quad 0xbe0000003e00,0x3e000000be000000,0x3d713dd5bda2bdb5,0xbde23d8e3dc6bdb5,0xbdd5bd443dfb0000,0x3d8ebdedbcc83e00,0x3dffbcc8bde23db5,0xbc493dfbbd71bdb5
.quad 0xbded3db53d44be00,0xbd44bdb53ded0000,0x3da2bdfb3d153db5,0x3dc63cc8bdf53db5,0xbcc83dedbdd50000,0xbdfb3d443d8ebe00,0xbd15bd8e3dffbdb5,0x3df5bdd53c493db5
.quad 0x3db50000bdb53e00,0xbdb53e00bdb50000,0xbdf53d8e3c49bdb5,0x3d15bdd53dffbdb5,0x3dfbbded3d8e0000,0x3cc83d44bdd53e00,0xbdc63dfbbdf53db5,0xbda23cc83d15bdb5
.quad 0x3d44bdb53dedbe00,0x3dedbdb53d440000,0x3c493cc8bd713db5,0xbdff3dfbbde23db5,0xbd8e3d44bcc80000,0x3dd5bded3dfbbe00,0x3de2bdd53dc6bdb5,0xbd713d8ebda23db5
.quad 0xbe0000003e00,0x3e000000be000000,0x3c493dfbbd15bded,0xbdff3cc83df5bd44,0xbcc8bded3d8e3db5,0x3dfbbd44bdd53db5,0x3d153dd5bdc6bd44,0xbdf53d8e3da2bded
.quad 0xbd44bdb53ded0000,0x3dedbdb5bd443e00,0x3d713d8ebdff3d44,0xbde23dd53c49bded,0xbd8ebd443dfbbdb5,0x3dd5bded3cc83db5,0x3da23cc8bde23ded,0xbdc63dfbbd71bd44
.quad 0xbdb500003db5be00,0x3db5be003db50000,0x3dc6bcc8bd713ded,0xbda23dfbbde23d44,0xbdd53d443cc8bdb5,0x3d8ebded3dfbbdb5,0x3de2bd8e3c493d44,0xbd713dd5bdff3ded
.quad 0xbded3db5bd440000,0x3d44bdb53dedbe00,0x3df5bdd53da2bd44,0xbd153d8ebdc63ded,0xbdfb3dedbdd53db5,0x3cc8bd443d8ebdb5,0x3dffbdfb3df5bded,0xbc493cc8bd153d44
.quad 0xbe0000003e00,0x3e000000be000000,0xbd153dfb3c49be00,0xbdf5bcc83dff0000,0x3d8ebdedbcc83e00,0x3dd53d44bdfb0000,0xbdc63dd53d15be00,0xbda2bd8e3df50000
.quad 0x3dedbdb5bd443e00,0x3d443db5bded0000,0xbdff3d8e3d71be00,0xbc49bdd53de20000,0x3dfbbd44bd8e3e00,0xbcc83dedbdd50000,0xbde23cc83da2be00,0x3d71bdfb3dc60000
.quad 0x3db50000bdb53e00,0xbdb53e00bdb50000,0xbd71bcc83dc6be00,0x3de2bdfb3da20000,0x3cc83d44bdd53e00,0xbdfb3dedbd8e0000,0x3c49bd8e3de2be00,0x3dffbdd53d710000
.quad 0xbd443db5bded3e00,0xbded3db5bd440000,0x3da2bdd53df5be00,0x3dc6bd8e3d150000,0xbdd53dedbdfb3e00,0xbd8e3d44bcc80000,0x3df5bdfb3dffbe00,0x3d15bcc83c490000
.quad 0xbe0000003e00,0x3e000000be000000,0xbda23dd53d71bded,0xbdc6bd8e3de23d44,0x3dfbbd44bdd53db5,0x3cc83dedbd8ebdb5,0xbde2bcc83dffbd44,0x3d71bdfb3c493ded
.quad 0x3d443db5bded0000,0xbded3db53d44be00,0x3d15bdfb3da23d44,0x3df5bcc8bdc63ded,0xbdd53dedbcc8bdb5,0xbd8ebd443dfbbdb5,0x3dffbd8ebd153ded,0xbc493dd5bdf53d44
.quad 0xbdb500003db5be00,0x3db5be003db50000,0x3c493d8ebdf53ded,0xbdff3dd5bd15bd44,0x3d8ebded3dfbbdb5,0x3dd5bd44bcc83db5,0xbdf53dfbbdc63d44,0xbd15bcc83da2bded
.quad 0x3dedbdb53d440000,0xbd443db5bded3e00,0xbd713cc83c49bd44,0x3de2bdfb3dffbded,0xbcc83d44bd8e3db5,0xbdfb3dedbdd53db5,0x3dc6bdd53de2bded,0x3da2bd8e3d71bd44
.quad 0xbe0000003e00,0x3e000000be000000,0xbde23d8e3dc6bdb5,0xbd71bdd53da23db5,0x3dd53d44bdfb0000,0xbd8e3ded3cc8be00,0x3c49bdfb3d713db5,0x3dffbcc8bde23db5
.quad 0xbded3db53d44be00,0xbd44bdb53ded0000,0x3dc63cc8bdf53db5,0xbda23dfbbd15bdb5,0x3cc8bded3dd50000,0x3dfbbd44bd8e3e00,0xbdf53dd5bc49bdb5,0xbd15bd8e3dffbdb5
.quad 0x3db50000bdb53e00,0xbdb53e00bdb50000,0x3d15bdd53dffbdb5,0x3df5bd8ebc493db5,0xbdfb3dedbd8e0000,0xbcc8bd443dd5be00,0x3da2bcc8bd153db5,0xbdc63dfbbdf53db5
.quad 0x3d44bdb53dedbe00,0x3dedbdb53d440000,0xbdff3dfbbde23db5,0xbc49bcc83d71bdb5,0x3d8ebd443cc80000,0xbdd53dedbdfb3e00,0x3d71bd8e3da2bdb5,0x3de2bdd53dc6bdb5
.quad 0xbe0000003e00,0x3e000000be000000,0xbdff3cc83df5bd44,0xbc49bdfb3d153ded,0x3cc83dedbd8ebdb5,0xbdfb3d443dd5bdb5,0x3df5bd8ebda23ded,0x3d153dd5bdc6bd44
.quad 0xbd44bdb53ded0000,0x3dedbdb5bd443e00,0xbde23dd53c49bded,0xbd71bd8e3dffbd44,0x3d8e3d44bdfb3db5,0xbdd53dedbcc8bdb5,0x3dc6bdfb3d713d44,0x3da23cc8bde23ded
.quad 0xbdb500003db5be00,0x3db5be003db50000,0xbda23dfbbde23d44,0xbdc63cc83d71bded,0x3dd5bd44bcc83db5,0xbd8e3dedbdfb3db5,0x3d71bdd53dffbded,0x3de2bd8e3c493d44
.quad 0xbded3db5bd440000,0x3d44bdb53dedbe00,0xbd153d8ebdc63ded,0xbdf53dd5bda23d44,0x3dfbbded3dd5bdb5,0xbcc83d44bd8e3db5,0x3c49bcc83d15bd44,0x3dffbdfb3df5bded
.quad 0xbe0000003e00,0x3e000000be000000,0xbdf5bcc83dff0000,0x3d15bdfbbc493e00,0xbd8e3ded3cc8be00,0xbdd5bd443dfb0000,0x3da23d8ebdf50000,0xbdc63dd53d15be00
.quad 0x3dedbdb5bd443e00,0x3d443db5bded0000,0xbc49bdd53de20000,0x3dffbd8ebd713e00,0xbdfb3d443d8ebe00,0x3cc8bded3dd50000,0xbd713dfbbdc60000,0xbde23cc83da2be00
.quad 0x3db50000bdb53e00,0xbdb53e00bdb50000,0x3de2bdfb3da20000,0x3d713cc8bdc63e00,0xbcc8bd443dd5be00,0x3dfbbded3d8e0000,0xbdff3dd5bd710000,0x3c49bd8e3de2be00
.quad 0xbd443db5bded3e00,0xbded3db5bd440000,0x3dc6bd8e3d150000,0xbda23dd5bdf53e00,0x3dd5bded3dfbbe00,0x3d8ebd443cc80000,0xbd153cc8bc490000,0x3df5bdfb3dffbe00
.quad 0xbe0000003e00,0x3e000000be000000,0xbdc6bd8e3de23d44,0x3da2bdd5bd713ded,0xbdfb3d443dd5bdb5,0xbcc8bded3d8e3db5,0xbd713dfbbc49bded,0xbde2bcc83dffbd44
.quad 0x3d443db5bded0000,0xbded3db53d44be00,0x3df5bcc8bdc63ded,0xbd153dfbbda2bd44,0x3dd5bded3cc83db5,0x3d8e3d44bdfb3db5,0x3c49bdd53df5bd44,0x3dffbd8ebd153ded
.quad 0xbdb500003db5be00,0x3db5be003db50000,0xbdff3dd5bd15bd44,0xbc49bd8e3df5bded,0xbd8e3dedbdfb3db5,0xbdd53d443cc8bdb5,0x3d153cc8bda23ded,0xbdf53dfbbdc63d44
.quad 0x3dedbdb53d440000,0xbd443db5bded3e00,0x3de2bdfb3dffbded,0x3d71bcc8bc493d44,0x3cc8bd443d8ebdb5,0x3dfbbded3dd5bdb5,0xbda23d8ebd713d44,0x3dc6bdd53de2bded
.quad 0xbe0000003e00,0x3e000000be000000,0xbd71bdd53da23db5,0x3de2bd8ebdc63db5,0xbdd5bd443dfb0000,0x3d8ebdedbcc83e00,0xbdff3cc83de2bdb5,0x3c49bdfb3d713db5
.quad 0xbded3db53d44be00,0xbd44bdb53ded0000,0xbda23dfbbd15bdb5,0xbdc6bcc83df5bdb5,0xbcc83dedbdd50000,0xbdfb3d443d8ebe00,0x3d153d8ebdff3db5,0xbdf53dd5bc49bdb5
.quad 0x3db50000bdb53e00,0xbdb53e00bdb50000,0x3df5bd8ebc493db5,0xbd153dd5bdff3db5,0x3dfbbded3d8e0000,0x3cc83d44bdd53e00,0x3dc6bdfb3df5bdb5,0x3da2bcc8bd153db5
.quad 0x3d44bdb53dedbe00,0x3dedbdb53d440000,0xbc49bcc83d71bdb5,0x3dffbdfb3de2bdb5,0xbd8e3d44bcc80000,0x3dd5bded3dfbbe00,0xbde23dd5bdc63db5,0x3d71bd8e3da2bdb5
.quad 0xbe0000003e00,0x3e000000be000000,0xbc49bdfb3d153ded,0x3dffbcc8bdf53d44,0xbcc8bded3d8e3db5,0x3dfbbd44bdd53db5,0xbd15bdd53dc63d44,0x3df5bd8ebda23ded
.quad 0xbd44bdb53ded0000,0x3dedbdb5bd443e00,0xbd71bd8e3dffbd44,0x3de2bdd5bc493ded,0xbd8ebd443dfbbdb5,0x3dd5bded3cc83db5,0xbda2bcc83de2bded,0x3dc6bdfb3d713d44
.quad 0xbdb500003db5be00,0x3db5be003db50000,0xbdc63cc83d71bded,0x3da2bdfb3de2bd44,0xbdd53d443cc8bdb5,0x3d8ebded3dfbbdb5,0xbde23d8ebc49bd44,0x3d71bdd53dffbded
.quad 0xbded3db5bd440000,0x3d44bdb53dedbe00,0xbdf53dd5bda23d44,0x3d15bd8e3dc6bded,0xbdfb3dedbdd53db5,0x3cc8bd443d8ebdb5,0xbdff3dfbbdf53ded,0x3c49bcc83d15bd44
.quad 0xbe0000003e00,0x3e000000be000000,0x3d15bdfbbc493e00,0x3df53cc8bdff0000,0x3d8ebdedbcc83e00,0x3dd53d44bdfb0000,0x3dc6bdd5bd153e00,0x3da23d8ebdf50000
.quad 0x3dedbdb5bd443e00,0x3d443db5bded0000,0x3dffbd8ebd713e00,0x3c493dd5bde20000,0x3dfbbd44bd8e3e00,0xbcc83dedbdd50000,0x3de2bcc8bda23e00,0xbd713dfbbdc60000
.quad 0x3db50000bdb53e00,0xbdb53e00bdb50000,0x3d713cc8bdc63e00,0xbde23dfbbda20000,0x3cc83d44bdd53e00,0xbdfb3dedbd8e0000,0xbc493d8ebde23e00,0xbdff3dd5bd710000
.quad 0xbd443db5bded3e00,0xbded3db5bd440000,0xbda23dd5bdf53e00,0xbdc63d8ebd150000,0xbdd53dedbdfb3e00,0xbd8e3d44bcc80000,0xbdf53dfbbdff3e00,0xbd153cc8bc490000
.quad 0xbe0000003e00,0x3e000000be000000,0x3da2bdd5bd713ded,0x3dc63d8ebde2bd44,0x3dfbbd44bdd53db5,0x3cc83dedbd8ebdb5,0x3de23cc8bdff3d44,0xbd713dfbbc49bded
.quad 0x3d443db5bded0000,0xbded3db53d44be00,0xbd153dfbbda2bd44,0xbdf53cc83dc6bded,0xbdd53dedbcc8bdb5,0xbd8ebd443dfbbdb5,0xbdff3d8e3d15bded,0x3c49bdd53df5bd44
.quad 0xbdb500003db5be00,0x3db5be003db50000,0xbc49bd8e3df5bded,0x3dffbdd53d153d44,0x3d8ebded3dfbbdb5,0x3dd5bd44bcc83db5,0x3df5bdfb3dc6bd44,0x3d153cc8bda23ded
.quad 0x3dedbdb53d440000,0xbd443db5bded3e00,0x3d71bcc8bc493d44,0xbde23dfbbdff3ded,0xbcc83d44bd8e3db5,0xbdfb3dedbdd53db5,0xbdc63dd5bde23ded,0xbda23d8ebd713d44
.quad 0xbe0000003e00,0x3e000000be000000,0x3de2bd8ebdc63db5,0x3d713dd5bda2bdb5,0x3dd53d44bdfb0000,0xbd8e3ded3cc8be00,0xbc493dfbbd71bdb5,0xbdff3cc83de2bdb5
.quad 0xbded3db53d44be00,0xbd44bdb53ded0000,0xbdc6bcc83df5bdb5,0x3da2bdfb3d153db5,0x3cc8bded3dd50000,0x3dfbbd44bd8e3e00,0x3df5bdd53c493db5,0x3d153d8ebdff3db5
.quad 0x3db50000bdb53e00,0xbdb53e00bdb50000,0xbd153dd5bdff3db5,0xbdf53d8e3c49bdb5,0xbdfb3dedbd8e0000,0xbcc8bd443dd5be00,0xbda23cc83d15bdb5,0x3dc6bdfb3df5bdb5
.quad 0x3d44bdb53dedbe00,0x3dedbdb53d440000,0x3dffbdfb3de2bdb5,0x3c493cc8bd713db5,0x3d8ebd443cc80000,0xbdd53dedbdfb3e00,0xbd713d8ebda23db5,0xbde23dd5bdc63db5
.quad 0xbe0000003e00,0x3e000000be000000,0x3dffbcc8bdf53d44,0x3c493dfbbd15bded,0x3cc83dedbd8ebdb5,0xbdfb3d443dd5bdb5,0xbdf53d8e3da2bded,0xbd15bdd53dc63d44
.quad 0xbd44bdb53ded0000,0x3dedbdb5bd443e00,0x3de2bdd5bc493ded,0x3d713d8ebdff3d44,0x3d8e3d44bdfb3db5,0xbdd53dedbcc8bdb5,0xbdc63dfbbd71bd44,0xbda2bcc83de2bded
.quad 0xbdb500003db5be00,0x3db5be003db50000,0x3da2bdfb3de2bd44,0x3dc6bcc8bd713ded,0x3dd5bd44bcc83db5,0xbd8e3dedbdfb3db5,0xbd713dd5bdff3ded,0xbde23d8ebc49bd44
.quad 0xbded3db5bd440000,0x3d44bdb53dedbe00,0x3d15bd8e3dc6bded,0x3df5bdd53da2bd44,0x3dfbbded3dd5bdb5,0xbcc83d44bd8e3db5,0xbc493cc8bd153d44,0xbdff3dfbbdf53ded
.quad 0xb0003000b0003000,0x0,0x2fa8afd92ff6b000,0x28a5a63e22460000,0xaea72f64afd93000,0xac722a1fa63e0000,0x2d13aea72fa8b000,0x2e2fac7228a50000
.quad 0xaa1f2da8af643000,0xaf642da8aa1f0000,0x2246ac722f0eb000,0x2ff6aea72b8b0000,0x263e2a1faea73000,0xafd92f64ac720000,0xab8ba63e2e2fb000,0x2f0eafd92d130000
.quad 0x2da80000ada83000,0xada83000ada80000,0xaf0e263e2d13b000,0x2b8bafd92e2f0000,0x2fd9aa1fac723000,0xa63e2f64aea70000,0xaff62c722b8bb000,0xa246aea72f0e0000
.quad 0x2f64ada8aa1f3000,0x2a1f2da8af640000,0xae2f2ea728a5b000,0xad13ac722fa80000,0x2c72af64a63e3000,0x2ea72a1fafd90000,0xa8a52fd92246b000,0xafa8a63e2ff60000
.quad 0xb0003000b0003000,0x0,0x2e2faea72f0eaf64,0x2d13ac722b8baa1f,0xa63e2a1fac722da8,0xafd92f64aea72da8,0xab8b263e2246aa1f,0x2f0eafd92ff6af64
.quad 0x2f64ada82a1f0000,0xaa1f2da8af643000,0xafa82fd9ae2f2a1f,0xa8a5a63e2d13af64,0x2c72af642fd9ada8,0x2ea7aa1fa63e2da8,0x22462c72afa82f64,0xaff62ea7a8a5aa1f
.quad 0xada800002da8b000,0x2da8b0002da80000,0x2ff6ac72a8a52f64,0xa2462ea7afa82a1f,0xaea72f64a63eada8,0xac72aa1f2fd9ada8,0x28a5afd92d132a1f,0x2fa8a63eae2f2f64
.quad 0x2a1f2da8af640000,0xaf642da82a1fb000,0xaf0ea63e2ff6aa1f,0x2b8bafd922462f64,0x2fd9aa1faea72da8,0x263e2f64ac72ada8,0xad132ea72b8baf64,0xae2fac722f0e2a1f
.quad 0xb0003000b0003000,0x0,0x2b8bac722d13ada8,0x2f0eaea72e2fada8,0x2c72aa1f263e0000,0xaea72f64afd93000,0xaff62fd9af0e2da8,0xa246a63e2b8bada8
.quad 0x2a1fada82f64b000,0x2f64ada82a1f0000,0x2d13a63ea8a52da8,0xae2f2fd9afa82da8,0xafd92f64ac720000,0xa63eaa1f2ea7b000,0x28a5aea72ff6ada8,0x2fa8ac72a2462da8
.quad 0x2da80000ada83000,0xada83000ada80000,0xafa82ea7a246ada8,0xa8a5ac722ff6ada8,0x263eaf642ea70000,0x2fd9aa1fac723000,0x2e2f263eafa82da8,0xad132fd9a8a5ada8
.quad 0xaf642da82a1fb000,0xaa1fada82f640000,0x2246afd92b8b2da8,0x2ff6a63eaf0e2da8,0x2ea72a1fafd90000,0xac722f64263eb000,0xaf0e2c722e2fada8,0xab8baea72d132da8
.quad 0xb0003000b0003000,0x0,0x2246a63e28a5aa1f,0x2ff6afd92fa8af64,0x2fd9af642ea7ada8,0xa63e2a1fac722da8,0xa8a52c72ae2f2f64,0xafa82ea7ad132a1f
.quad 0xaf642da8aa1f0000,0x2a1fada82f64b000,0x2b8baea72ff6af64,0x2f0eac7222462a1f,0x2ea7aa1fa63e2da8,0xac722f64afd92da8,0xad132fd9af0e2a1f,0xae2f263e2b8baf64
.quad 0xada800002da8b000,0x2da8b0002da80000,0x2e2fafd92b8b2a1f,0x2d13263eaf0e2f64,0x2c722a1fafd92da8,0xaea72f64a63eada8,0xaf0e2ea72246af64,0xab8bac722ff6aa1f
.quad 0xaa1fada82f640000,0x2f64ada8aa1f3000,0x2fa8ac72ad132f64,0x28a52ea7ae2faa1f,0x263e2f64ac72ada8,0xafd92a1f2ea7ada8,0xaff6263e2fa8aa1f,0xa246afd928a52f64
.quad 0xb0003000b0003000,0x0,0xa8a5263ea2460000,0x2fa8afd92ff6b000,0x2ea7af642fd9b000,0x2c72aa1f263e0000,0x2e2fac7228a50000,0xad132ea7afa83000
.quad 0xaa1f2da8af643000,0xaf642da8aa1f0000,0xaff62ea7ab8b0000,0x2246ac722f0eb000,0xa63eaa1f2ea7b000,0x2fd9af642c720000,0x2f0eafd92d130000,0x2b8b263eae2f3000
.quad 0x2da80000ada83000,0xada83000ada80000,0xab8b2fd9ae2f0000,0xaf0e263e2d13b000,0xafd92a1f2c72b000,0x263eaf642ea70000,0xa246aea72f0e0000,0x2ff6ac72ab8b3000
.quad 0x2f64ada8aa1f3000,0x2a1f2da8af640000,0x2d132c72afa80000,0xae2f2ea728a5b000,0xac722f64263eb000,0xaea7aa1f2fd90000,0xafa8a63e2ff60000,0x28a5afd9a2463000
.quad 0xb0003000b0003000,0x0,0xad132c72ab8b2a1f,0x2e2faea72f0eaf64,0x263eaa1f2c72ada8,0x2fd9af642ea7ada8,0x2f0eafd92ff6af64,0x2b8ba63ea2462a1f
.quad 0x2f64ada82a1f0000,0xaa1f2da8af643000,0x28a5263ead132f64,0xafa82fd9ae2f2a1f,0xac722f64afd92da8,0xaea72a1f263eada8,0xaff62ea7a8a5aa1f,0xa246ac722fa8af64
.quad 0xada800002da8b000,0x2da8b0002da80000,0x2246aea72fa8aa1f,0x2ff6ac72a8a52f64,0x2ea7af64263e2da8,0x2c722a1fafd92da8,0x2fa8a63eae2f2f64,0xa8a52fd9ad13aa1f
.quad 0x2a1f2da8af640000,0xaf642da82a1fb000,0xab8b2fd9a246af64,0xaf0ea63e2ff6aa1f,0xafd92a1f2ea7ada8,0xa63eaf642c722da8,0xae2fac722f0e2a1f,0x2d13aea7ab8b2f64
.quad 0xb0003000b0003000,0x0,0xaf0e2ea7ae2f2da8,0x2b8bac722d13ada8,0xac722a1fa63e0000,0x2ea7af642fd9b000,0xa246a63e2b8bada8,0x2ff6afd92f0eada8
.quad 0x2a1fada82f64b000,0x2f64ada82a1f0000,0x2e2fafd92fa8ada8,0x2d13a63ea8a52da8,0x2fd9af642c720000,0x263e2a1faea73000,0x2fa8ac72a2462da8,0xa8a52ea7aff62da8
.quad 0x2da80000ada83000,0xada83000ada80000,0x28a52c72aff62da8,0xafa82ea7a246ada8,0xa63e2f64aea70000,0xafd92a1f2c72b000,0xad132fd9a8a5ada8,0xae2fa63e2fa8ada8
.quad 0xaf642da82a1fb000,0xaa1fada82f640000,0xaff6263e2f0eada8,0x2246afd92b8b2da8,0xaea7aa1f2fd90000,0x2c72af64a63e3000,0xab8baea72d132da8,0x2f0eac72ae2f2da8
.quad 0xb0003000b0003000,0x0,0xaff62fd9afa82f64,0x2246a63e28a5aa1f,0xafd92f64aea72da8,0x263eaa1f2c72ada8,0xafa82ea7ad132a1f,0x28a5ac722e2faf64
.quad 0xaf642da8aa1f0000,0x2a1fada82f64b000,0xaf0e2c72a246aa1f,0x2b8baea72ff6af64,0xaea72a1f263eada8,0x2c72af642fd9ada8,0xae2f263e2b8baf64,0x2d13afd92f0eaa1f
.quad 0xada800002da8b000,0x2da8b0002da80000,0xad13a63e2f0eaf64,0x2e2fafd92b8b2a1f,0xac72aa1f2fd9ada8,0x2ea7af64263e2da8,0xab8bac722ff6aa1f,0x2f0eaea7a2462f64
.quad 0xaa1fada82f640000,0x2f64ada8aa1f3000,0xa8a5aea72e2f2a1f,0x2fa8ac72ad132f64,0xa63eaf642c722da8,0x2fd9aa1faea72da8,0xa246afd928a52f64,0x2ff6a63eafa82a1f
.quad 0xb0003000b0003000,0x0,0xafa82fd9aff63000,0xa8a5263ea2460000,0xaea72f64afd93000,0xac722a1fa63e0000,0xad132ea7afa83000,0xae2f2c72a8a50000
.quad 0xaa1f2da8af643000,0xaf642da8aa1f0000,0xa2462c72af0e3000,0xaff62ea7ab8b0000,0x263e2a1faea73000,0xafd92f64ac720000,0x2b8b263eae2f3000,0xaf0e2fd9ad130000
.quad 0x2da80000ada83000,0xada83000ada80000,0x2f0ea63ead133000,0xab8b2fd9ae2f0000,0x2fd9aa1fac723000,0xa63e2f64aea70000,0x2ff6ac72ab8b3000,0x22462ea7af0e0000
.quad 0x2f64ada8aa1f3000,0x2a1f2da8af640000,0x2e2faea7a8a53000,0x2d132c72afa80000,0x2c72af64a63e3000,0x2ea72a1fafd90000,0x28a5afd9a2463000,0x2fa8263eaff60000
.quad 0xb0003000b0003000,0x0,0xae2f2ea7af0e2f64,0xad132c72ab8b2a1f,0xa63e2a1fac722da8,0xafd92f64aea72da8,0x2b8ba63ea2462a1f,0xaf0e2fd9aff62f64
.quad 0x2f64ada82a1f0000,0xaa1f2da8af643000,0x2fa8afd92e2faa1f,0x28a5263ead132f64,0x2c72af642fd9ada8,0x2ea7aa1fa63e2da8,0xa246ac722fa8af64,0x2ff6aea728a52a1f
.quad 0xada800002da8b000,0x2da8b0002da80000,0xaff62c7228a5af64,0x2246aea72fa8aa1f,0xaea72f64a63eada8,0xac72aa1f2fd9ada8,0xa8a52fd9ad13aa1f,0xafa8263e2e2faf64
.quad 0x2a1f2da8af640000,0xaf642da82a1fb000,0x2f0e263eaff62a1f,0xab8b2fd9a246af64,0x2fd9aa1faea72da8,0x263e2f64ac72ada8,0x2d13aea7ab8b2f64,0x2e2f2c72af0eaa1f
.quad 0xb0003000b0003000,0x0,0xab8b2c72ad132da8,0xaf0e2ea7ae2f2da8,0x2c72aa1f263e0000,0xaea72f64afd93000,0x2ff6afd92f0eada8,0x2246263eab8b2da8
.quad 0x2a1fada82f64b000,0x2f64ada82a1f0000,0xad13263e28a5ada8,0x2e2fafd92fa8ada8,0xafd92f64ac720000,0xa63eaa1f2ea7b000,0xa8a52ea7aff62da8,0xafa82c722246ada8
.quad 0x2da80000ada83000,0xada83000ada80000,0x2fa8aea722462da8,0x28a52c72aff62da8,0x263eaf642ea70000,0x2fd9aa1fac723000,0xae2fa63e2fa8ada8,0x2d13afd928a52da8
.quad 0xaf642da82a1fb000,0xaa1fada82f640000,0xa2462fd9ab8bada8,0xaff6263e2f0eada8,0x2ea72a1fafd90000,0xac722f64263eb000,0x2f0eac72ae2f2da8,0x2b8b2ea7ad13ada8
.quad 0xb0003000b0003000,0x0,0xa246263ea8a52a1f,0xaff62fd9afa82f64,0x2fd9af642ea7ada8,0xa63e2a1fac722da8,0x28a5ac722e2faf64,0x2fa8aea72d13aa1f
.quad 0xaf642da8aa1f0000,0x2a1fada82f64b000,0xab8b2ea7aff62f64,0xaf0e2c72a246aa1f,0x2ea7aa1fa63e2da8,0xac722f64afd92da8,0x2d13afd92f0eaa1f,0x2e2fa63eab8b2f64
.quad 0xada800002da8b000,0x2da8b0002da80000,0xae2f2fd9ab8baa1f,0xad13a63e2f0eaf64,0x2c722a1fafd92da8,0xaea72f64a63eada8,0x2f0eaea7a2462f64,0x2b8b2c72aff62a1f
.quad 0xaa1fada82f640000,0x2f64ada8aa1f3000,0xafa82c722d13af64,0xa8a5aea72e2f2a1f,0x263e2f64ac72ada8,0xafd92a1f2ea7ada8,0x2ff6a63eafa82a1f,0x22462fd9a8a5af64
.quad 0xb0003000b0003000,0x0,0x28a5a63e22460000,0xafa82fd9aff63000,0x2ea7af642fd9b000,0x2c72aa1f263e0000,0xae2f2c72a8a50000,0x2d13aea72fa8b000
.quad 0xaa1f2da8af643000,0xaf642da8aa1f0000,0x2ff6aea72b8b0000,0xa2462c72af0e3000,0xa63eaa1f2ea7b000,0x2fd9af642c720000,0xaf0e2fd9ad130000,0xab8ba63e2e2fb000
.quad 0x2da80000ada83000,0xada83000ada80000,0x2b8bafd92e2f0000,0x2f0ea63ead133000,0xafd92a1f2c72b000,0x263eaf642ea70000,0x22462ea7af0e0000,0xaff62c722b8bb000
.quad 0x2f64ada8aa1f3000,0x2a1f2da8af640000,0xad13ac722fa80000,0x2e2faea7a8a53000,0xac722f64263eb000,0xaea7aa1f2fd90000,0x2fa8263eaff60000,0xa8a52fd92246b000
.quad 0xb0003000b0003000,0x0,0x2d13ac722b8baa1f,0xae2f2ea7af0e2f64,0x263eaa1f2c72ada8,0x2fd9af642ea7ada8,0xaf0e2fd9aff62f64,0xab8b263e2246aa1f
.quad 0x2f64ada82a1f0000,0xaa1f2da8af643000,0xa8a5a63e2d13af64,0x2fa8afd92e2faa1f,0xac722f64afd92da8,0xaea72a1f263eada8,0x2ff6aea728a52a1f,0x22462c72afa82f64
.quad 0xada800002da8b000,0x2da8b0002da80000,0xa2462ea7afa82a1f,0xaff62c7228a5af64,0x2ea7af64263e2da8,0x2c722a1fafd92da8,0xafa8263e2e2faf64,0x28a5afd92d132a1f
.quad 0x2a1f2da8af640000,0xaf642da82a1fb000,0x2b8bafd922462f64,0x2f0e263eaff62a1f,0xafd92a1f2ea7ada8,0xa63eaf642c722da8,0x2e2f2c72af0eaa1f,0xad132ea72b8baf64
.quad 0xb0003000b0003000,0x0,0x2f0eaea72e2fada8,0xab8b2c72ad132da8,0xac722a1fa63e0000,0x2ea7af642fd9b000,0x2246263eab8b2da8,0xaff62fd9af0e2da8
.quad 0x2a1fada82f64b000,0x2f64ada82a1f0000,0xae2f2fd9afa82da8,0xad13263e28a5ada8,0x2fd9af642c720000,0x263e2a1faea73000,0xafa82c722246ada8,0x28a5aea72ff6ada8
.quad 0x2da80000ada83000,0xada83000ada80000,0xa8a5ac722ff6ada8,0x2fa8aea722462da8,0xa63e2f64aea70000,0xafd92a1f2c72b000,0x2d13afd928a52da8,0x2e2f263eafa82da8
.quad 0xaf642da82a1fb000,0xaa1fada82f640000,0x2ff6a63eaf0e2da8,0xa2462fd9ab8bada8,0xaea7aa1f2fd90000,0x2c72af64a63e3000,0x2b8b2ea7ad13ada8,0xaf0e2c722e2fada8
.quad 0xb0003000b0003000,0x0,0x2ff6afd92fa8af64,0xa246263ea8a52a1f,0xafd92f64aea72da8,0x263eaa1f2c72ada8,0x2fa8aea72d13aa1f,0xa8a52c72ae2f2f64
.quad 0xaf642da8aa1f0000,0x2a1fada82f64b000,0x2f0eac7222462a1f,0xab8b2ea7aff62f64,0xaea72a1f263eada8,0x2c72af642fd9ada8,0x2e2fa63eab8b2f64,0xad132fd9af0e2a1f
.quad 0xada800002da8b000,0x2da8b0002da80000,0x2d13263eaf0e2f64,0xae2f2fd9ab8baa1f,0xac72aa1f2fd9ada8,0x2ea7af64263e2da8,0x2b8b2c72aff62a1f,0xaf0e2ea72246af64
.quad 0xaa1fada82f640000,0x2f64ada8aa1f3000,0x28a52ea7ae2faa1f,0xafa82c722d13af64,0xa63eaf642c722da8,0x2fd9aa1faea72da8,0x22462fd9a8a5af64,0xaff6263e2fa8aa1f
.quad 0xbe003e00be003e00,0x0,0x3df5bdfb3dffbe00,0xbd153cc8bc490000,0xbdd53dedbdfb3e00,0x3d8ebd443cc80000,0x3da2bdd53df5be00,0xbdc63d8ebd150000
.quad 0xbd443db5bded3e00,0x3dedbdb53d440000,0x3c49bd8e3de2be00,0xbdff3dd5bd710000,0x3cc83d44bdd53e00,0x3dfbbded3d8e0000,0xbd71bcc83dc6be00,0xbde23dfbbda20000
.quad 0x3db50000bdb53e00,0x3db5be003db50000,0xbde23cc83da2be00,0xbd713dfbbdc60000,0x3dfbbd44bd8e3e00,0x3cc8bded3dd50000,0xbdff3d8e3d71be00,0x3c493dd5bde20000
.quad 0x3dedbdb5bd443e00,0xbd44bdb53ded0000,0xbdc63dd53d15be00,0x3da23d8ebdf50000,0x3d8ebdedbcc83e00,0xbdd5bd443dfb0000,0xbd153dfb3c49be00,0x3df53cc8bdff0000
.quad 0xbe003e00be003e00,0x0,0x3dc6bdd53de2bded,0xbda23d8ebd713d44,0xbcc83d44bd8e3db5,0x3dfbbded3dd5bdb5,0xbd713cc83c49bd44,0xbde23dfbbdff3ded
.quad 0x3dedbdb53d440000,0x3d44bdb53dedbe00,0xbdf53dfbbdc63d44,0x3d153cc8bda23ded,0x3d8ebded3dfbbdb5,0xbdd53d443cc8bdb5,0x3c493d8ebdf53ded,0x3dffbdd53d153d44
.quad 0xbdb500003db5be00,0xbdb53e00bdb50000,0x3dffbd8ebd153ded,0x3c49bdd53df5bd44,0xbdd53dedbcc8bdb5,0x3d8e3d44bdfb3db5,0x3d15bdfb3da23d44,0xbdf53cc83dc6bded
.quad 0x3d443db5bded0000,0x3dedbdb5bd443e00,0xbde2bcc83dffbd44,0xbd713dfbbc49bded,0x3dfbbd44bdd53db5,0xbcc8bded3d8e3db5,0xbda23dd53d71bded,0x3dc63d8ebde2bd44
.quad 0xbe003e00be003e00,0x0,0x3d71bd8e3da2bdb5,0xbde23dd5bdc63db5,0x3d8ebd443cc80000,0x3dd5bded3dfbbe00,0xbdff3dfbbde23db5,0x3c493cc8bd713db5
.quad 0x3d44bdb53dedbe00,0xbded3db5bd440000,0x3da2bcc8bd153db5,0x3dc6bdfb3df5bdb5,0xbdfb3dedbd8e0000,0x3cc83d44bdd53e00,0x3d15bdd53dffbdb5,0xbdf53d8e3c49bdb5
.quad 0x3db50000bdb53e00,0x3db5be003db50000,0xbdf53dd5bc49bdb5,0x3d153d8ebdff3db5,0x3cc8bded3dd50000,0xbdfb3d443d8ebe00,0x3dc63cc8bdf53db5,0x3da2bdfb3d153db5
.quad 0xbded3db53d44be00,0x3d443db5bded0000,0x3c49bdfb3d713db5,0xbdff3cc83de2bdb5,0x3dd53d44bdfb0000,0x3d8ebdedbcc83e00,0xbde23d8e3dc6bdb5,0x3d713dd5bda2bdb5
.quad 0xbe003e00be003e00,0x0,0x3c49bcc83d15bd44,0xbdff3dfbbdf53ded,0x3dfbbded3dd5bdb5,0x3cc8bd443d8ebdb5,0xbd153d8ebdc63ded,0x3df5bdd53da2bd44
.quad 0xbded3db5bd440000,0xbd443db5bded3e00,0x3d71bdd53dffbded,0xbde23d8ebc49bd44,0x3dd5bd44bcc83db5,0x3d8ebded3dfbbdb5,0xbda23dfbbde23d44,0x3dc6bcc8bd713ded
.quad 0xbdb500003db5be00,0xbdb53e00bdb50000,0x3dc6bdfb3d713d44,0xbda2bcc83de2bded,0x3d8e3d44bdfb3db5,0x3dd5bded3cc83db5,0xbde23dd53c49bded,0x3d713d8ebdff3d44
.quad 0xbd44bdb53ded0000,0xbded3db53d44be00,0x3df5bd8ebda23ded,0xbd15bdd53dc63d44,0x3cc83dedbd8ebdb5,0x3dfbbd44bdd53db5,0xbdff3cc83df5bd44,0x3c493dfbbd15bded
.quad 0xbe003e00be003e00,0x0,0xbd153cc8bc490000,0xbdf53dfbbdff3e00,0x3dd5bded3dfbbe00,0xbd8e3d44bcc80000,0x3dc6bd8e3d150000,0x3da2bdd53df5be00
.quad 0xbd443db5bded3e00,0x3dedbdb53d440000,0xbdff3dd5bd710000,0xbc493d8ebde23e00,0xbcc8bd443dd5be00,0xbdfb3dedbd8e0000,0x3de2bdfb3da20000,0xbd71bcc83dc6be00
.quad 0x3db50000bdb53e00,0x3db5be003db50000,0xbd713dfbbdc60000,0x3de2bcc8bda23e00,0xbdfb3d443d8ebe00,0xbcc83dedbdd50000,0xbc49bdd53de20000,0xbdff3d8e3d71be00
.quad 0x3dedbdb5bd443e00,0xbd44bdb53ded0000,0x3da23d8ebdf50000,0x3dc6bdd5bd153e00,0xbd8e3ded3cc8be00,0x3dd53d44bdfb0000,0xbdf5bcc83dff0000,0xbd153dfb3c49be00
.quad 0xbe003e00be003e00,0x0,0xbda23d8ebd713d44,0xbdc63dd5bde23ded,0x3cc8bd443d8ebdb5,0xbdfb3dedbdd53db5,0x3de2bdfb3dffbded,0xbd713cc83c49bd44
.quad 0x3dedbdb53d440000,0x3d44bdb53dedbe00,0x3d153cc8bda23ded,0x3df5bdfb3dc6bd44,0xbd8e3dedbdfb3db5,0x3dd5bd44bcc83db5,0xbdff3dd5bd15bd44,0x3c493d8ebdf53ded
.quad 0xbdb500003db5be00,0xbdb53e00bdb50000,0x3c49bdd53df5bd44,0xbdff3d8e3d15bded,0x3dd5bded3cc83db5,0xbd8ebd443dfbbdb5,0x3df5bcc8bdc63ded,0x3d15bdfb3da23d44
.quad 0x3d443db5bded0000,0x3dedbdb5bd443e00,0xbd713dfbbc49bded,0x3de23cc8bdff3d44,0xbdfb3d443dd5bdb5,0x3cc83dedbd8ebdb5,0xbdc6bd8e3de23d44,0xbda23dd53d71bded
.quad 0xbe003e00be003e00,0x0,0xbde23dd5bdc63db5,0xbd713d8ebda23db5,0xbd8e3d44bcc80000,0xbdd53dedbdfb3e00,0xbc49bcc83d71bdb5,0xbdff3dfbbde23db5
.quad 0x3d44bdb53dedbe00,0xbded3db5bd440000,0x3dc6bdfb3df5bdb5,0xbda23cc83d15bdb5,0x3dfbbded3d8e0000,0xbcc8bd443dd5be00,0x3df5bd8ebc493db5,0x3d15bdd53dffbdb5
.quad 0x3db50000bdb53e00,0x3db5be003db50000,0x3d153d8ebdff3db5,0x3df5bdd53c493db5,0xbcc83dedbdd50000,0x3dfbbd44bd8e3e00,0xbda23dfbbd15bdb5,0x3dc63cc8bdf53db5
.quad 0xbded3db53d44be00,0x3d443db5bded0000,0xbdff3cc83de2bdb5,0xbc493dfbbd71bdb5,0xbdd5bd443dfb0000,0xbd8e3ded3cc8be00,0xbd71bdd53da23db5,0xbde23d8e3dc6bdb5
.quad 0xbe003e00be003e00,0x0,0xbdff3dfbbdf53ded,0xbc493cc8bd153d44,0xbdfb3dedbdd53db5,0xbcc83d44bd8e3db5,0xbdf53dd5bda23d44,0xbd153d8ebdc63ded
.quad 0xbded3db5bd440000,0xbd443db5bded3e00,0xbde23d8ebc49bd44,0xbd713dd5bdff3ded,0xbdd53d443cc8bdb5,0xbd8e3dedbdfb3db5,0xbdc63cc83d71bded,0xbda23dfbbde23d44
.quad 0xbdb500003db5be00,0xbdb53e00bdb50000,0xbda2bcc83de2bded,0xbdc63dfbbd71bd44,0xbd8ebd443dfbbdb5,0xbdd53dedbcc8bdb5,0xbd71bd8e3dffbd44,0xbde23dd53c49bded
.quad 0xbd44bdb53ded0000,0xbded3db53d44be00,0xbd15bdd53dc63d44,0xbdf53d8e3da2bded,0xbcc8bded3d8e3db5,0xbdfb3d443dd5bdb5,0xbc49bdfb3d153ded,0xbdff3cc83df5bd44
.quad 0xbe003e00be003e00,0x0,0xbdf53dfbbdff3e00,0x3d15bcc83c490000,0xbdd53dedbdfb3e00,0x3d8ebd443cc80000,0xbda23dd5bdf53e00,0x3dc6bd8e3d150000
.quad 0xbd443db5bded3e00,0x3dedbdb53d440000,0xbc493d8ebde23e00,0x3dffbdd53d710000,0x3cc83d44bdd53e00,0x3dfbbded3d8e0000,0x3d713cc8bdc63e00,0x3de2bdfb3da20000
.quad 0x3db50000bdb53e00,0x3db5be003db50000,0x3de2bcc8bda23e00,0x3d71bdfb3dc60000,0x3dfbbd44bd8e3e00,0x3cc8bded3dd50000,0x3dffbd8ebd713e00,0xbc49bdd53de20000
.quad 0x3dedbdb5bd443e00,0xbd44bdb53ded0000,0x3dc6bdd5bd153e00,0xbda2bd8e3df50000,0x3d8ebdedbcc83e00,0xbdd5bd443dfb0000,0x3d15bdfbbc493e00,0xbdf5bcc83dff0000
.quad 0xbe003e00be003e00,0x0,0xbdc63dd5bde23ded,0x3da2bd8e3d71bd44,0xbcc83d44bd8e3db5,0x3dfbbded3dd5bdb5,0x3d71bcc8bc493d44,0x3de2bdfb3dffbded
.quad 0x3dedbdb53d440000,0x3d44bdb53dedbe00,0x3df5bdfb3dc6bd44,0xbd15bcc83da2bded,0x3d8ebded3dfbbdb5,0xbdd53d443cc8bdb5,0xbc49bd8e3df5bded,0xbdff3dd5bd15bd44
.quad 0xbdb500003db5be00,0xbdb53e00bdb50000,0xbdff3d8e3d15bded,0xbc493dd5bdf53d44,0xbdd53dedbcc8bdb5,0x3d8e3d44bdfb3db5,0xbd153dfbbda2bd44,0x3df5bcc8bdc63ded
.quad 0x3d443db5bded0000,0x3dedbdb5bd443e00,0x3de23cc8bdff3d44,0x3d71bdfb3c493ded,0x3dfbbd44bdd53db5,0xbcc8bded3d8e3db5,0x3da2bdd5bd713ded,0xbdc6bd8e3de23d44
.quad 0xbe003e00be003e00,0x0,0xbd713d8ebda23db5,0x3de2bdd53dc6bdb5,0x3d8ebd443cc80000,0x3dd5bded3dfbbe00,0x3dffbdfb3de2bdb5,0xbc49bcc83d71bdb5
.quad 0x3d44bdb53dedbe00,0xbded3db5bd440000,0xbda23cc83d15bdb5,0xbdc63dfbbdf53db5,0xbdfb3dedbd8e0000,0x3cc83d44bdd53e00,0xbd153dd5bdff3db5,0x3df5bd8ebc493db5
.quad 0x3db50000bdb53e00,0x3db5be003db50000,0x3df5bdd53c493db5,0xbd15bd8e3dffbdb5,0x3cc8bded3dd50000,0xbdfb3d443d8ebe00,0xbdc6bcc83df5bdb5,0xbda23dfbbd15bdb5
.quad 0xbded3db53d44be00,0x3d443db5bded0000,0xbc493dfbbd71bdb5,0x3dffbcc8bde23db5,0x3dd53d44bdfb0000,0x3d8ebdedbcc83e00,0x3de2bd8ebdc63db5,0xbd71bdd53da23db5
.quad 0xbe003e00be003e00,0x0,0xbc493cc8bd153d44,0x3dffbdfb3df5bded,0x3dfbbded3dd5bdb5,0x3cc8bd443d8ebdb5,0x3d15bd8e3dc6bded,0xbdf53dd5bda23d44
.quad 0xbded3db5bd440000,0xbd443db5bded3e00,0xbd713dd5bdff3ded,0x3de2bd8e3c493d44,0x3dd5bd44bcc83db5,0x3d8ebded3dfbbdb5,0x3da2bdfb3de2bd44,0xbdc63cc83d71bded
.quad 0xbdb500003db5be00,0xbdb53e00bdb50000,0xbdc63dfbbd71bd44,0x3da23cc8bde23ded,0x3d8e3d44bdfb3db5,0x3dd5bded3cc83db5,0x3de2bdd5bc493ded,0xbd71bd8e3dffbd44
.quad 0xbd44bdb53ded0000,0xbded3db53d44be00,0xbdf53d8e3da2bded,0x3d153dd5bdc6bd44,0x3cc83dedbd8ebdb5,0x3dfbbd44bdd53db5,0x3dffbcc8bdf53d44,0xbc49bdfb3d153ded
.quad 0xbe003e00be003e00,0x0,0x3d15bcc83c490000,0x3df5bdfb3dffbe00,0x3dd5bded3dfbbe00,0xbd8e3d44bcc80000,0xbdc63d8ebd150000,0xbda23dd5bdf53e00
.quad 0xbd443db5bded3e00,0x3dedbdb53d440000,0x3dffbdd53d710000,0x3c49bd8e3de2be00,0xbcc8bd443dd5be00,0xbdfb3dedbd8e0000,0xbde23dfbbda20000,0x3d713cc8bdc63e00
.quad 0x3db50000bdb53e00,0x3db5be003db50000,0x3d71bdfb3dc60000,0xbde23cc83da2be00,0xbdfb3d443d8ebe00,0xbcc83dedbdd50000,0x3c493dd5bde20000,0x3dffbd8ebd713e00
.quad 0x3dedbdb5bd443e00,0xbd44bdb53ded0000,0xbda2bd8e3df50000,0xbdc63dd53d15be00,0xbd8e3ded3cc8be00,0x3dd53d44bdfb0000,0x3df53cc8bdff0000,0x3d15bdfbbc493e00
.quad 0xbe003e00be003e00,0x0,0x3da2bd8e3d71bd44,0x3dc6bdd53de2bded,0x3cc8bd443d8ebdb5,0xbdfb3dedbdd53db5,0xbde23dfbbdff3ded,0x3d71bcc8bc493d44
.quad 0x3dedbdb53d440000,0x3d44bdb53dedbe00,0xbd15bcc83da2bded,0xbdf53dfbbdc63d44,0xbd8e3dedbdfb3db5,0x3dd5bd44bcc83db5,0x3dffbdd53d153d44,0xbc49bd8e3df5bded
.quad 0xbdb500003db5be00,0xbdb53e00bdb50000,0xbc493dd5bdf53d44,0x3dffbd8ebd153ded,0x3dd5bded3cc83db5,0xbd8ebd443dfbbdb5,0xbdf53cc83dc6bded,0xbd153dfbbda2bd44
.quad 0x3d443db5bded0000,0x3dedbdb5bd443e00,0x3d71bdfb3c493ded,0xbde2bcc83dffbd44,0xbdfb3d443dd5bdb5,0x3cc83dedbd8ebdb5,0x3dc63d8ebde2bd44,0x3da2bdd5bd713ded
.quad 0xbe003e00be003e00,0x0,0x3de2bdd53dc6bdb5,0x3d71bd8e3da2bdb5,0xbd8e3d44bcc80000,0xbdd53dedbdfb3e00,0x3c493cc8bd713db5,0x3dffbdfb3de2bdb5
.quad 0x3d44bdb53dedbe00,0xbded3db5bd440000,0xbdc63dfbbdf53db5,0x3da2bcc8bd153db5,0x3dfbbded3d8e0000,0xbcc8bd443dd5be00,0xbdf53d8e3c49bdb5,0xbd153dd5bdff3db5
.quad 0x3db50000bdb53e00,0x3db5be003db50000,0xbd15bd8e3dffbdb5,0xbdf53dd5bc49bdb5,0xbcc83dedbdd50000,0x3dfbbd44bd8e3e00,0x3da2bdfb3d153db5,0xbdc6bcc83df5bdb5
.quad 0xbded3db53d44be00,0x3d443db5bded0000,0x3dffbcc8bde23db5,0x3c49bdfb3d713db5,0xbdd5bd443dfb0000,0xbd8e3ded3cc8be00,0x3d713dd5bda2bdb5,0x3de2bd8ebdc63db5
.quad 0xbe003e00be003e00,0x0,0x3dffbdfb3df5bded,0x3c49bcc83d15bd44,0xbdfb3dedbdd53db5,0xbcc83d44bd8e3db5,0x3df5bdd53da2bd44,0x3d15bd8e3dc6bded
.quad 0xbded3db5bd440000,0xbd443db5bded3e00,0x3de2bd8e3c493d44,0x3d71bdd53dffbded,0xbdd53d443cc8bdb5,0xbd8e3dedbdfb3db5,0x3dc6bcc8bd713ded,0x3da2bdfb3de2bd44
.quad 0xbdb500003db5be00,0xbdb53e00bdb50000,0x3da23cc8bde23ded,0x3dc6bdfb3d713d44,0xbd8ebd443dfbbdb5,0xbdd53dedbcc8bdb5,0x3d713d8ebdff3d44,0x3de2bdd5bc493ded
.quad 0xbd44bdb53ded0000,0xbded3db53d44be00,0x3d153dd5bdc6bd44,0x3df5bd8ebda23ded,0xbcc8bded3d8e3db5,0xbdfb3d443dd5bdb5,0x3c493dfbbd15bded,0x3dffbcc8bdf53d44
.quad 0xb00000003000,0x30000000b0000000,0x2fa8a63eaff60000,0x28a52fd9a246b000,0x2c722f64a63eb000,0xaea72a1f2fd90000,0xad132c722fa80000,0xae2faea728a53000
.quad 0xaf64ada82a1f3000,0x2a1fada8af640000,0x2246aea7af0e0000,0x2ff62c72ab8bb000,0x2fd92a1fac72b000,0x263e2f642ea70000,0x2b8b2fd92e2f0000,0xaf0ea63e2d133000
.quad 0xada800002da83000,0xada8b000ada80000,0xaf0eafd9ad130000,0x2b8ba63eae2fb000,0x263eaa1faea7b000,0x2fd92f642c720000,0x2ff62ea72b8b0000,0x22462c722f0e3000
.quad 0x2a1f2da82f643000,0xaf64ada8aa1f0000,0xae2fac72a8a50000,0xad13aea7afa8b000,0xaea7af64afd9b000,0x2c722a1f263e0000,0x28a5263e22460000,0x2fa82fd92ff63000
.quad 0xb00000003000,0x30000000b0000000,0x2e2fac72af0e2a1f,0x2d132ea7ab8baf64,0x2fd92a1faea7ada8,0xa63e2f642c72ada8,0x2b8b2fd92246af64,0xaf0e263e2ff62a1f
.quad 0xaa1f2da82f640000,0xaf64ada82a1f3000,0xafa8a63e2e2f2f64,0xa8a5afd9ad132a1f,0xaea7af64a63e2da8,0x2c72aa1fafd9ada8,0xa246aea7afa8aa1f,0x2ff62c72a8a5af64
.quad 0x2da80000ada8b000,0x2da830002da80000,0x2ff62ea728a5aa1f,0xa2462c722fa82f64,0x2c722f642fd92da8,0xaea7aa1f263e2da8,0xa8a5263e2d132f64,0xafa8afd9ae2faa1f
.quad 0xaf64ada8aa1f0000,0xaa1fada8af64b000,0xaf0eafd9aff6af64,0x2b8b263ea246aa1f,0xa63eaa1fac72ada8,0x2fd92f642ea72da8,0x2d132c722b8b2a1f,0x2e2f2ea72f0e2f64
.quad 0xb00000003000,0x30000000b0000000,0x2b8baea7ad132da8,0x2f0e2c72ae2fada8,0x2ea7aa1fafd90000,0x2c722f64a63eb000,0x2ff6263eaf0eada8,0x22462fd92b8bada8
.quad 0x2f642da8aa1fb000,0xaa1f2da82f640000,0x2d132fd928a5ada8,0xae2f263e2fa82da8,0x263e2f642ea70000,0xafd9aa1f2c723000,0xa8a52c722ff62da8,0xafa8aea7a2462da8
.quad 0xada800002da83000,0xada8b000ada80000,0xafa8ac7222462da8,0xa8a5aea7aff6ada8,0xafd9af64ac720000,0x263eaa1faea7b000,0xae2fafd9afa8ada8,0x2d13263ea8a5ada8
.quad 0xaa1fada8af64b000,0x2f642da82a1f0000,0x2246a63eab8bada8,0x2ff62fd92f0e2da8,0x2c722a1f263e0000,0x2ea72f642fd93000,0x2f0e2ea72e2f2da8,0x2b8b2c722d132da8
.quad 0xb00000003000,0x30000000b0000000,0x2246afd9a8a52f64,0x2ff6263eafa8aa1f,0x263eaf64ac722da8,0x2fd92a1faea7ada8,0x28a5aea7ae2f2a1f,0x2fa82c72ad13af64
.quad 0x2a1fada8af640000,0x2f642da8aa1fb000,0x2b8bac72aff6aa1f,0x2f0e2ea7a246af64,0x2c72aa1fafd9ada8,0x2ea72f64263eada8,0x2d13a63eaf0eaf64,0x2e2f2fd92b8baa1f
.quad 0x2da80000ada8b000,0x2da830002da80000,0x2e2f263eab8baf64,0x2d132fd92f0e2a1f,0x2ea72a1fa63eada8,0x2c722f642fd92da8,0x2f0e2c722246aa1f,0x2b8b2ea72ff62f64
.quad 0x2f642da82a1f0000,0x2a1f2da82f643000,0x2fa82ea72d132a1f,0x28a52c722e2f2f64,0x2fd92f642ea72da8,0x263e2a1f2c722da8,0x2ff62fd92fa82f64,0x2246263e28a52a1f
.quad 0xb00000003000,0x30000000b0000000,0xa8a5afd922463000,0x2fa8a63eaff60000,0xac72af64263e3000,0x2ea7aa1fafd90000,0xae2faea728a53000,0x2d13ac72afa80000
.quad 0xaf64ada82a1f3000,0x2a1fada8af640000,0xaff6ac722b8b3000,0x2246aea7af0e0000,0xafd9aa1f2c723000,0xa63eaf64aea70000,0xaf0ea63e2d133000,0xab8bafd9ae2f0000
.quad 0xada800002da83000,0xada8b000ada80000,0xab8b263e2e2f3000,0xaf0eafd9ad130000,0xa63e2a1f2ea73000,0xafd9af64ac720000,0x22462c722f0e3000,0xaff6aea7ab8b0000
.quad 0x2a1f2da82f643000,0xaf64ada8aa1f0000,0x2d132ea72fa83000,0xae2fac72a8a50000,0x2ea72f642fd93000,0xac72aa1fa63e0000,0x2fa82fd92ff63000,0xa8a5a63ea2460000
.quad 0xb00000003000,0x30000000b0000000,0xad13aea72b8b2f64,0x2e2fac72af0e2a1f,0xafd9aa1f2ea72da8,0x263eaf64ac722da8,0xaf0e263e2ff62a1f,0xab8bafd9a2462f64
.quad 0xaa1f2da82f640000,0xaf64ada82a1f3000,0x28a52fd92d13aa1f,0xafa8a63e2e2f2f64,0x2ea72f64263eada8,0xac722a1f2fd92da8,0x2ff62c72a8a5af64,0x22462ea72fa82a1f
.quad 0x2da80000ada8b000,0x2da830002da80000,0x2246ac72afa8af64,0x2ff62ea728a5aa1f,0xac72af64afd9ada8,0x2ea72a1fa63eada8,0xafa8afd9ae2faa1f,0x28a5a63ead13af64
.quad 0xaf64ada8aa1f0000,0xaa1fada8af64b000,0xab8ba63e22462a1f,0xaf0eafd9aff6af64,0x263e2a1f2c722da8,0xafd9af64aea7ada8,0x2e2f2ea72f0e2f64,0xad13ac72ab8baa1f
.quad 0xb00000003000,0x30000000b0000000,0xaf0eac722e2f2da8,0x2b8baea7ad132da8,0xaea72a1f2fd90000,0xac72af64263e3000,0x22462fd92b8bada8,0xaff6a63e2f0e2da8
.quad 0x2f642da8aa1fb000,0xaa1f2da82f640000,0x2e2fa63eafa8ada8,0x2d132fd928a5ada8,0xa63eaf64aea70000,0x2fd92a1fac72b000,0xafa8aea7a2462da8,0x28a5ac72aff6ada8
.quad 0xada800002da83000,0xada8b000ada80000,0x28a52ea72ff62da8,0xafa8ac7222462da8,0x2fd92f642c720000,0xa63e2a1f2ea73000,0x2d13263ea8a5ada8,0x2e2f2fd92fa82da8
.quad 0xaa1fada8af64b000,0x2f642da82a1f0000,0xaff6afd9af0eada8,0x2246a63eab8bada8,0xac72aa1fa63e0000,0xaea7af64afd9b000,0x2b8b2c722d132da8,0xaf0eaea7ae2fada8
.quad 0xb00000003000,0x30000000b0000000,0xaff6a63e2fa82a1f,0x2246afd9a8a52f64,0xa63e2f642c72ada8,0xafd9aa1f2ea72da8,0x2fa82c72ad13af64,0xa8a52ea72e2faa1f
.quad 0x2a1fada8af640000,0x2f642da8aa1fb000,0xaf0eaea722462f64,0x2b8bac72aff6aa1f,0xac722a1f2fd92da8,0xaea7af64a63e2da8,0x2e2f2fd92b8baa1f,0xad13263e2f0e2f64
.quad 0x2da80000ada8b000,0x2da830002da80000,0xad13afd9af0eaa1f,0x2e2f263eab8baf64,0xaea7aa1f263e2da8,0xac72af64afd9ada8,0x2b8b2ea72ff62f64,0xaf0eac72a2462a1f
.quad 0x2f642da82a1f0000,0x2a1f2da82f643000,0xa8a5ac72ae2faf64,0x2fa82ea72d132a1f,0xafd9af64aea7ada8,0xa63eaa1fac72ada8,0x2246263e28a52a1f,0xaff6afd9afa8af64
.quad 0xb00000003000,0x30000000b0000000,0xafa8263e2ff60000,0xa8a5afd922463000,0x2c722f64a63eb000,0xaea72a1f2fd90000,0x2d13ac72afa80000,0x2e2f2ea7a8a5b000
.quad 0xaf64ada82a1f3000,0x2a1fada8af640000,0xa2462ea72f0e0000,0xaff6ac722b8b3000,0x2fd92a1fac72b000,0x263e2f642ea70000,0xab8bafd9ae2f0000,0x2f0e263ead13b000
.quad 0xada800002da83000,0xada8b000ada80000,0x2f0e2fd92d130000,0xab8b263e2e2f3000,0x263eaa1faea7b000,0x2fd92f642c720000,0xaff6aea7ab8b0000,0xa246ac72af0eb000
.quad 0x2a1f2da82f643000,0xaf64ada8aa1f0000,0x2e2f2c7228a50000,0x2d132ea72fa83000,0xaea7af64afd9b000,0x2c722a1f263e0000,0xa8a5a63ea2460000,0xafa8afd9aff6b000
.quad 0xb00000003000,0x30000000b0000000,0xae2f2c722f0eaa1f,0xad13aea72b8b2f64,0x2fd92a1faea7ada8,0xa63e2f642c72ada8,0xab8bafd9a2462f64,0x2f0ea63eaff6aa1f
.quad 0xaa1f2da82f640000,0xaf64ada82a1f3000,0x2fa8263eae2faf64,0x28a52fd92d13aa1f,0xaea7af64a63e2da8,0x2c72aa1fafd9ada8,0x22462ea72fa82a1f,0xaff6ac7228a52f64
.quad 0x2da80000ada8b000,0x2da830002da80000,0xaff6aea7a8a52a1f,0x2246ac72afa8af64,0x2c722f642fd92da8,0xaea7aa1f263e2da8,0x28a5a63ead13af64,0x2fa82fd92e2f2a1f
.quad 0xaf64ada8aa1f0000,0xaa1fada8af64b000,0x2f0e2fd92ff62f64,0xab8ba63e22462a1f,0xa63eaa1fac72ada8,0x2fd92f642ea72da8,0xad13ac72ab8baa1f,0xae2faea7af0eaf64
.quad 0xb00000003000,0x30000000b0000000,0xab8b2ea72d13ada8,0xaf0eac722e2f2da8,0x2ea7aa1fafd90000,0x2c722f64a63eb000,0xaff6a63e2f0e2da8,0xa246afd9ab8b2da8
.quad 0x2f642da8aa1fb000,0xaa1f2da82f640000,0xad13afd9a8a52da8,0x2e2fa63eafa8ada8,0x263e2f642ea70000,0xafd9aa1f2c723000,0x28a5ac72aff6ada8,0x2fa82ea72246ada8
.quad 0xada800002da83000,0xada8b000ada80000,0x2fa82c72a246ada8,0x28a52ea72ff62da8,0xafd9af64ac720000,0x263eaa1faea7b000,0x2e2f2fd92fa82da8,0xad13a63e28a52da8
.quad 0xaa1fada8af64b000,0x2f642da82a1f0000,0xa246263e2b8b2da8,0xaff6afd9af0eada8,0x2c722a1f263e0000,0x2ea72f642fd93000,0xaf0eaea7ae2fada8,0xab8bac72ad13ada8
.quad 0xb00000003000,0x30000000b0000000,0xa2462fd928a5af64,0xaff6a63e2fa82a1f,0x263eaf64ac722da8,0x2fd92a1faea7ada8,0xa8a52ea72e2faa1f,0xafa8ac722d132f64
.quad 0x2a1fada8af640000,0x2f642da8aa1fb000,0xab8b2c722ff62a1f,0xaf0eaea722462f64,0x2c72aa1fafd9ada8,0x2ea72f64263eada8,0xad13263e2f0e2f64,0xae2fafd9ab8b2a1f
.quad 0x2da80000ada8b000,0x2da830002da80000,0xae2fa63e2b8b2f64,0xad13afd9af0eaa1f,0x2ea72a1fa63eada8,0x2c722f642fd92da8,0xaf0eac72a2462a1f,0xab8baea7aff6af64
.quad 0x2f642da82a1f0000,0x2a1f2da82f643000,0xafa8aea7ad13aa1f,0xa8a5ac72ae2faf64,0x2fd92f642ea72da8,0x263e2a1f2c722da8,0xaff6afd9afa8af64,0xa246a63ea8a5aa1f
.quad 0xb00000003000,0x30000000b0000000,0x28a52fd9a246b000,0xafa8263e2ff60000,0xac72af64263e3000,0x2ea7aa1fafd90000,0x2e2f2ea7a8a5b000,0xad132c722fa80000
.quad 0xaf64ada82a1f3000,0x2a1fada8af640000,0x2ff62c72ab8bb000,0xa2462ea72f0e0000,0xafd9aa1f2c723000,0xa63eaf64aea70000,0x2f0e263ead13b000,0x2b8b2fd92e2f0000
.quad 0xada800002da83000,0xada8b000ada80000,0x2b8ba63eae2fb000,0x2f0e2fd92d130000,0xa63e2a1f2ea73000,0xafd9af64ac720000,0xa246ac72af0eb000,0x2ff62ea72b8b0000
.quad 0x2a1f2da82f643000,0xaf64ada8aa1f0000,0xad13aea7afa8b000,0x2e2f2c7228a50000,0x2ea72f642fd93000,0xac72aa1fa63e0000,0xafa8afd9aff6b000,0x28a5263e22460000
.quad 0xb00000003000,0x30000000b0000000,0x2d132ea7ab8baf64,0xae2f2c722f0eaa1f,0xafd9aa1f2ea72da8,0x263eaf64ac722da8,0x2f0ea63eaff6aa1f,0x2b8b2fd92246af64
.quad 0xaa1f2da82f640000,0xaf64ada82a1f3000,0xa8a5afd9ad132a1f,0x2fa8263eae2faf64,0x2ea72f64263eada8,0xac722a1f2fd92da8,0xaff6ac7228a52f64,0xa246aea7afa8aa1f
.quad 0x2da80000ada8b000,0x2da830002da80000,0xa2462c722fa82f64,0xaff6aea7a8a52a1f,0xac72af64afd9ada8,0x2ea72a1fa63eada8,0x2fa82fd92e2f2a1f,0xa8a5263e2d132f64
.quad 0xaf64ada8aa1f0000,0xaa1fada8af64b000,0x2b8b263ea246aa1f,0x2f0e2fd92ff62f64,0x263e2a1f2c722da8,0xafd9af64aea7ada8,0xae2faea7af0eaf64,0x2d132c722b8b2a1f
.quad 0xb00000003000,0x30000000b0000000,0x2f0e2c72ae2fada8,0xab8b2ea72d13ada8,0xaea72a1f2fd90000,0xac72af64263e3000,0xa246afd9ab8b2da8,0x2ff6263eaf0eada8
.quad 0x2f642da8aa1fb000,0xaa1f2da82f640000,0xae2f263e2fa82da8,0xad13afd9a8a52da8,0xa63eaf64aea70000,0x2fd92a1fac72b000,0x2fa82ea72246ada8,0xa8a52c722ff62da8
.quad 0xada800002da83000,0xada8b000ada80000,0xa8a5aea7aff6ada8,0x2fa82c72a246ada8,0x2fd92f642c720000,0xa63e2a1f2ea73000,0xad13a63e28a52da8,0xae2fafd9afa8ada8
.quad 0xaa1fada8af64b000,0x2f642da82a1f0000,0x2ff62fd92f0e2da8,0xa246263e2b8b2da8,0xac72aa1fa63e0000,0xaea7af64afd9b000,0xab8bac72ad13ada8,0x2f0e2ea72e2f2da8
.quad 0xb00000003000,0x30000000b0000000,0x2ff6263eafa8aa1f,0xa2462fd928a5af64,0xa63e2f642c72ada8,0xafd9aa1f2ea72da8,0xafa8ac722d132f64,0x28a5aea7ae2f2a1f
.quad 0x2a1fada8af640000,0x2f642da8aa1fb000,0x2f0e2ea7a246af64,0xab8b2c722ff62a1f,0xac722a1f2fd92da8,0xaea7af64a63e2da8,0xae2fafd9ab8b2a1f,0x2d13a63eaf0eaf64
.quad 0x2da80000ada8b000,0x2da830002da80000,0x2d132fd92f0e2a1f,0xae2fa63e2b8b2f64,0xaea7aa1f263e2da8,0xac72af64afd9ada8,0xab8baea7aff6af64,0x2f0e2c722246aa1f
.quad 0x2f642da82a1f0000,0x2a1f2da82f643000,0x28a52c722e2f2f64,0xafa8aea7ad13aa1f,0xafd9af64aea7ada8,0xa63eaa1fac72ada8,0xa246a63ea8a5aa1f,0x2ff62fd92fa82f64
.quad 0xbe0000003e00,0xbe0000003e000000,0x3df5bcc8bdff0000,0xbd15bdfb3c493e00,0x3d8e3dedbcc8be00,0x3dd5bd44bdfb0000,0xbda23d8e3df50000,0x3dc63dd5bd15be00
.quad 0xbdedbdb53d443e00,0xbd443db53ded0000,0x3c49bdd5bde20000,0xbdffbd8e3d713e00,0x3dfb3d44bd8ebe00,0xbcc8bdedbdd50000,0x3d713dfb3dc60000,0x3de23cc8bda2be00
.quad 0xbdb500003db53e00,0x3db53e003db50000,0xbde2bdfbbda20000,0xbd713cc83dc63e00,0x3cc8bd44bdd5be00,0xbdfbbdedbd8e0000,0x3dff3dd53d710000,0xbc49bd8ebde2be00
.quad 0x3d443db53ded3e00,0x3ded3db53d440000,0xbdc6bd8ebd150000,0x3da23dd53df53e00,0xbdd5bdedbdfbbe00,0xbd8ebd44bcc80000,0x3d153cc83c490000,0xbdf5bdfbbdffbe00
.quad 0xbe0000003e00,0xbe0000003e000000,0x3dc6bd8ebde23d44,0xbda2bdd53d713ded,0x3dfb3d44bdd5bdb5,0x3cc8bdedbd8e3db5,0x3d713dfb3c49bded,0x3de2bcc8bdffbd44
.quad 0xbd443db53ded0000,0x3ded3db5bd44be00,0xbdf5bcc83dc63ded,0x3d153dfb3da2bd44,0xbdd5bdedbcc83db5,0xbd8e3d443dfb3db5,0xbc49bdd5bdf5bd44,0xbdffbd8e3d153ded
.quad 0x3db50000bdb5be00,0xbdb5be00bdb50000,0x3dff3dd53d15bd44,0x3c49bd8ebdf5bded,0x3d8e3ded3dfb3db5,0x3dd53d44bcc8bdb5,0xbd153cc83da23ded,0x3df53dfb3dc63d44
.quad 0xbdedbdb5bd440000,0x3d443db53ded3e00,0xbde2bdfbbdffbded,0xbd71bcc83c493d44,0xbcc8bd44bd8ebdb5,0xbdfbbdedbdd5bdb5,0x3da23d8e3d713d44,0xbdc6bdd5bde2bded
.quad 0xbe0000003e00,0xbe0000003e000000,0x3d71bdd5bda23db5,0xbde2bd8e3dc63db5,0x3dd5bd44bdfb0000,0xbd8ebded3cc83e00,0x3dff3cc8bde2bdb5,0xbc49bdfbbd713db5
.quad 0x3ded3db5bd44be00,0x3d44bdb5bded0000,0x3da23dfb3d15bdb5,0x3dc6bcc8bdf5bdb5,0x3cc83ded3dd50000,0x3dfb3d44bd8ebe00,0xbd153d8e3dff3db5,0x3df53dd53c49bdb5
.quad 0xbdb500003db53e00,0x3db53e003db50000,0xbdf5bd8e3c493db5,0x3d153dd53dff3db5,0xbdfbbdedbd8e0000,0xbcc83d443dd53e00,0xbdc6bdfbbdf5bdb5,0xbda2bcc83d153db5
.quad 0xbd44bdb5bdedbe00,0xbdedbdb5bd440000,0x3c49bcc8bd71bdb5,0xbdffbdfbbde2bdb5,0x3d8e3d443cc80000,0xbdd5bdedbdfbbe00,0x3de23dd53dc63db5,0xbd71bd8ebda2bdb5
.quad 0xbe0000003e00,0xbe0000003e000000,0x3c49bdfbbd153ded,0xbdffbcc83df53d44,0x3cc8bdedbd8e3db5,0xbdfbbd443dd53db5,0x3d15bdd5bdc63d44,0xbdf5bd8e3da23ded
.quad 0x3d44bdb5bded0000,0xbdedbdb53d443e00,0x3d71bd8ebdffbd44,0xbde2bdd53c493ded,0x3d8ebd44bdfbbdb5,0xbdd5bdedbcc83db5,0x3da2bcc8bde2bded,0xbdc6bdfbbd713d44
.quad 0x3db50000bdb5be00,0xbdb5be00bdb50000,0x3dc63cc8bd71bded,0xbda2bdfbbde2bd44,0x3dd53d44bcc8bdb5,0xbd8ebdedbdfbbdb5,0x3de23d8e3c49bd44,0xbd71bdd5bdffbded
.quad 0x3ded3db53d440000,0xbd44bdb5bdedbe00,0x3df53dd53da23d44,0xbd15bd8ebdc6bded,0x3dfb3ded3dd53db5,0xbcc8bd44bd8ebdb5,0x3dff3dfb3df53ded,0xbc49bcc8bd15bd44
.quad 0xbe0000003e00,0xbe0000003e000000,0xbd15bdfb3c493e00,0xbdf53cc83dff0000,0xbd8ebded3cc83e00,0xbdd53d443dfb0000,0xbdc6bdd53d153e00,0xbda23d8e3df50000
.quad 0xbdedbdb53d443e00,0xbd443db53ded0000,0xbdffbd8e3d713e00,0xbc493dd53de20000,0xbdfbbd443d8e3e00,0x3cc83ded3dd50000,0xbde2bcc83da23e00,0x3d713dfb3dc60000
.quad 0xbdb500003db53e00,0x3db53e003db50000,0xbd713cc83dc63e00,0x3de23dfb3da20000,0xbcc83d443dd53e00,0x3dfb3ded3d8e0000,0x3c493d8e3de23e00,0x3dff3dd53d710000
.quad 0x3d443db53ded3e00,0x3ded3db53d440000,0x3da23dd53df53e00,0x3dc63d8e3d150000,0x3dd53ded3dfb3e00,0x3d8e3d443cc80000,0x3df53dfb3dff3e00,0x3d153cc83c490000
.quad 0xbe0000003e00,0xbe0000003e000000,0xbda2bdd53d713ded,0xbdc63d8e3de2bd44,0xbdfbbd443dd53db5,0xbcc83ded3d8ebdb5,0xbde23cc83dff3d44,0x3d713dfb3c49bded
.quad 0xbd443db53ded0000,0x3ded3db5bd44be00,0x3d153dfb3da2bd44,0x3df53cc8bdc6bded,0x3dd53ded3cc8bdb5,0x3d8ebd44bdfbbdb5,0x3dff3d8ebd15bded,0xbc49bdd5bdf5bd44
.quad 0x3db50000bdb5be00,0xbdb5be00bdb50000,0x3c49bd8ebdf5bded,0xbdffbdd5bd153d44,0xbd8ebdedbdfbbdb5,0xbdd5bd443cc83db5,0xbdf5bdfbbdc6bd44,0xbd153cc83da23ded
.quad 0xbdedbdb5bd440000,0x3d443db53ded3e00,0xbd71bcc83c493d44,0x3de23dfb3dff3ded,0x3cc83d443d8e3db5,0x3dfb3ded3dd53db5,0x3dc63dd53de23ded,0x3da23d8e3d713d44
.quad 0xbe0000003e00,0xbe0000003e000000,0xbde2bd8e3dc63db5,0xbd713dd53da2bdb5,0xbdd53d443dfb0000,0x3d8e3dedbcc8be00,0x3c493dfb3d71bdb5,0x3dff3cc8bde2bdb5
.quad 0x3ded3db5bd44be00,0x3d44bdb5bded0000,0x3dc6bcc8bdf5bdb5,0xbda2bdfbbd153db5,0xbcc8bdedbdd50000,0xbdfbbd443d8e3e00,0xbdf5bdd5bc493db5,0xbd153d8e3dff3db5
.quad 0xbdb500003db53e00,0x3db53e003db50000,0x3d153dd53dff3db5,0x3df53d8ebc49bdb5,0x3dfb3ded3d8e0000,0x3cc8bd44bdd5be00,0x3da23cc8bd15bdb5,0xbdc6bdfbbdf5bdb5
.quad 0xbd44bdb5bdedbe00,0xbdedbdb5bd440000,0xbdffbdfbbde2bdb5,0xbc493cc83d713db5,0xbd8ebd44bcc80000,0x3dd53ded3dfb3e00,0x3d713d8e3da23db5,0x3de23dd53dc63db5
.quad 0xbe0000003e00,0xbe0000003e000000,0xbdffbcc83df53d44,0xbc493dfb3d15bded,0xbcc83ded3d8ebdb5,0x3dfb3d44bdd5bdb5,0x3df53d8ebda2bded,0x3d15bdd5bdc63d44
.quad 0x3d44bdb5bded0000,0xbdedbdb53d443e00,0xbde2bdd53c493ded,0xbd713d8e3dff3d44,0xbd8e3d443dfb3db5,0x3dd53ded3cc8bdb5,0x3dc63dfb3d71bd44,0x3da2bcc8bde2bded
.quad 0x3db50000bdb5be00,0xbdb5be00bdb50000,0xbda2bdfbbde2bd44,0xbdc6bcc83d713ded,0xbdd5bd443cc83db5,0x3d8e3ded3dfb3db5,0x3d713dd53dff3ded,0x3de23d8e3c49bd44
.quad 0x3ded3db53d440000,0xbd44bdb5bdedbe00,0xbd15bd8ebdc6bded,0xbdf5bdd5bda2bd44,0xbdfbbdedbdd5bdb5,0x3cc83d443d8e3db5,0x3c493cc83d153d44,0x3dff3dfb3df53ded
.quad 0xbe0000003e00,0xbe0000003e000000,0xbdf53cc83dff0000,0x3d153dfbbc49be00,0x3d8e3dedbcc8be00,0x3dd5bd44bdfb0000,0x3da2bd8ebdf50000,0xbdc6bdd53d153e00
.quad 0xbdedbdb53d443e00,0xbd443db53ded0000,0xbc493dd53de20000,0x3dff3d8ebd71be00,0x3dfb3d44bd8ebe00,0xbcc8bdedbdd50000,0xbd71bdfbbdc60000,0xbde2bcc83da23e00
.quad 0xbdb500003db53e00,0x3db53e003db50000,0x3de23dfb3da20000,0x3d71bcc8bdc6be00,0x3cc8bd44bdd5be00,0xbdfbbdedbd8e0000,0xbdffbdd5bd710000,0x3c493d8e3de23e00
.quad 0x3d443db53ded3e00,0x3ded3db53d440000,0x3dc63d8e3d150000,0xbda2bdd5bdf5be00,0xbdd5bdedbdfbbe00,0xbd8ebd44bcc80000,0xbd15bcc8bc490000,0x3df53dfb3dff3e00
.quad 0xbe0000003e00,0xbe0000003e000000,0xbdc63d8e3de2bd44,0x3da23dd5bd71bded,0x3dfb3d44bdd5bdb5,0x3cc8bdedbd8e3db5,0xbd71bdfbbc493ded,0xbde23cc83dff3d44
.quad 0xbd443db53ded0000,0x3ded3db5bd44be00,0x3df53cc8bdc6bded,0xbd15bdfbbda23d44,0xbdd5bdedbcc83db5,0xbd8e3d443dfb3db5,0x3c493dd53df53d44,0x3dff3d8ebd15bded
.quad 0x3db50000bdb5be00,0xbdb5be00bdb50000,0xbdffbdd5bd153d44,0xbc493d8e3df53ded,0x3d8e3ded3dfb3db5,0x3dd53d44bcc8bdb5,0x3d15bcc8bda2bded,0xbdf5bdfbbdc6bd44
.quad 0xbdedbdb5bd440000,0x3d443db53ded3e00,0x3de23dfb3dff3ded,0x3d713cc8bc49bd44,0xbcc8bd44bd8ebdb5,0xbdfbbdedbdd5bdb5,0xbda2bd8ebd71bd44,0x3dc63dd53de23ded
.quad 0xbe0000003e00,0xbe0000003e000000,0xbd713dd53da2bdb5,0x3de23d8ebdc6bdb5,0x3dd5bd44bdfb0000,0xbd8ebded3cc83e00,0xbdffbcc83de23db5,0x3c493dfb3d71bdb5
.quad 0x3ded3db5bd44be00,0x3d44bdb5bded0000,0xbda2bdfbbd153db5,0xbdc63cc83df53db5,0x3cc83ded3dd50000,0x3dfb3d44bd8ebe00,0x3d15bd8ebdffbdb5,0xbdf5bdd5bc493db5
.quad 0xbdb500003db53e00,0x3db53e003db50000,0x3df53d8ebc49bdb5,0xbd15bdd5bdffbdb5,0xbdfbbdedbd8e0000,0xbcc83d443dd53e00,0x3dc63dfb3df53db5,0x3da23cc8bd15bdb5
.quad 0xbd44bdb5bdedbe00,0xbdedbdb5bd440000,0xbc493cc83d713db5,0x3dff3dfb3de23db5,0x3d8e3d443cc80000,0xbdd5bdedbdfbbe00,0xbde2bdd5bdc6bdb5,0x3d713d8e3da23db5
.quad 0xbe0000003e00,0xbe0000003e000000,0xbc493dfb3d15bded,0x3dff3cc8bdf5bd44,0x3cc8bdedbd8e3db5,0xbdfbbd443dd53db5,0xbd153dd53dc6bd44,0x3df53d8ebda2bded
.quad 0x3d44bdb5bded0000,0xbdedbdb53d443e00,0xbd713d8e3dff3d44,0x3de23dd5bc49bded,0x3d8ebd44bdfbbdb5,0xbdd5bdedbcc83db5,0xbda23cc83de23ded,0x3dc63dfb3d71bd44
.quad 0x3db50000bdb5be00,0xbdb5be00bdb50000,0xbdc6bcc83d713ded,0x3da23dfb3de23d44,0x3dd53d44bcc8bdb5,0xbd8ebdedbdfbbdb5,0xbde2bd8ebc493d44,0x3d713dd53dff3ded
.quad 0x3ded3db53d440000,0xbd44bdb5bdedbe00,0xbdf5bdd5bda2bd44,0x3d153d8e3dc63ded,0x3dfb3ded3dd53db5,0xbcc8bd44bd8ebdb5,0xbdffbdfbbdf5bded,0x3c493cc83d153d44
.quad 0xbe0000003e00,0xbe0000003e000000,0x3d153dfbbc49be00,0x3df5bcc8bdff0000,0xbd8ebded3cc83e00,0xbdd53d443dfb0000,0x3dc63dd5bd15be00,0x3da2bd8ebdf50000
.quad 0xbdedbdb53d443e00,0xbd443db53ded0000,0x3dff3d8ebd71be00,0x3c49bdd5bde20000,0xbdfbbd443d8e3e00,0x3cc83ded3dd50000,0x3de23cc8bda2be00,0xbd71bdfbbdc60000
.quad 0xbdb500003db53e00,0x3db53e003db50000,0x3d71bcc8bdc6be00,0xbde2bdfbbda20000,0xbcc83d443dd53e00,0x3dfb3ded3d8e0000,0xbc49bd8ebde2be00,0xbdffbdd5bd710000
.quad 0x3d443db53ded3e00,0x3ded3db53d440000,0xbda2bdd5bdf5be00,0xbdc6bd8ebd150000,0x3dd53ded3dfb3e00,0x3d8e3d443cc80000,0xbdf5bdfbbdffbe00,0xbd15bcc8bc490000
.quad 0xbe0000003e00,0xbe0000003e000000,0x3da23dd5bd71bded,0x3dc6bd8ebde23d44,0xbdfbbd443dd53db5,0xbcc83ded3d8ebdb5,0x3de2bcc8bdffbd44,0xbd71bdfbbc493ded
.quad 0xbd443db53ded0000,0x3ded3db5bd44be00,0xbd15bdfbbda23d44,0xbdf5bcc83dc63ded,0x3dd53ded3cc8bdb5,0x3d8ebd44bdfbbdb5,0xbdffbd8e3d153ded,0x3c493dd53df53d44
.quad 0x3db50000bdb5be00,0xbdb5be00bdb50000,0xbc493d8e3df53ded,0x3dff3dd53d15bd44,0xbd8ebdedbdfbbdb5,0xbdd5bd443cc83db5,0x3df53dfb3dc63d44,0x3d15bcc8bda2bded
.quad 0xbdedbdb5bd440000,0x3d443db53ded3e00,0x3d713cc8bc49bd44,0xbde2bdfbbdffbded,0x3cc83d443d8e3db5,0x3dfb3ded3dd53db5,0xbdc6bdd5bde2bded,0xbda2bd8ebd71bd44
.quad 0xbe0000003e00,0xbe0000003e000000,0x3de23d8ebdc6bdb5,0x3d71bdd5bda23db5,0xbdd53d443dfb0000,0x3d8e3dedbcc8be00,0xbc49bdfbbd713db5,0xbdffbcc83de23db5
.quad 0x3ded3db5bd44be00,0x3d44bdb5bded0000,0xbdc63cc83df53db5,0x3da23dfb3d15bdb5,0xbcc8bdedbdd50000,0xbdfbbd443d8e3e00,0x3df53dd53c49bdb5,0x3d15bd8ebdffbdb5
.quad 0xbdb500003db53e00,0x3db53e003db50000,0xbd15bdd5bdffbdb5,0xbdf5bd8e3c493db5,0x3dfb3ded3d8e0000,0x3cc8bd44bdd5be00,0xbda2bcc83d153db5,0x3dc63dfb3df53db5
.quad 0xbd44bdb5bdedbe00,0xbdedbdb5bd440000,0x3dff3dfb3de23db5,0x3c49bcc8bd71bdb5,0xbd8ebd44bcc80000,0x3dd53ded3dfb3e00,0xbd71bd8ebda2bdb5,0xbde2bdd5bdc6bdb5
.quad 0xbe0000003e00,0xbe0000003e000000,0x3dff3cc8bdf5bd44,0x3c49bdfbbd153ded,0xbcc83ded3d8ebdb5,0x3dfb3d44bdd5bdb5,0xbdf5bd8e3da23ded,0xbd153dd53dc6bd44
.quad 0x3d44bdb5bded0000,0xbdedbdb53d443e00,0x3de23dd5bc49bded,0x3d71bd8ebdffbd44,0xbd8e3d443dfb3db5,0x3dd53ded3cc8bdb5,0xbdc6bdfbbd713d44,0xbda23cc83de23ded
.quad 0x3db50000bdb5be00,0xbdb5be00bdb50000,0x3da23dfb3de23d44,0x3dc63cc8bd71bded,0xbdd5bd443cc83db5,0x3d8e3ded3dfb3db5,0xbd71bdd5bdffbded,0xbde2bd8ebc493d44
.quad 0x3ded3db53d440000,0xbd44bdb5bdedbe00,0x3d153d8e3dc63ded,0x3df53dd53da23d44,0xbdfbbdedbdd5bdb5,0x3cc83d443d8e3db5,0xbc49bcc8bd15bd44,0xbdffbdfbbdf5bded
.quad 0x3000300030003000,0x0,0x2ea72f642fd93000,0x2c722a1f263e0000,0x2a1f2da82f643000,0x2f642da82a1f0000,0xa63e2a1f2ea73000,0x2fd92f642c720000
.quad 0xada800002da83000,0x2da830002da80000,0xafd9aa1f2c723000,0x263e2f642ea70000,0xaf64ada82a1f3000,0xaa1f2da82f640000,0xac72af64263e3000,0xaea72a1f2fd90000
.quad 0xb00000003000,0xb000000030000000,0x2c72af64a63e3000,0xaea7aa1f2fd90000,0x2f64ada8aa1f3000,0xaa1fada82f640000,0x2fd9aa1fac723000,0x263eaf642ea70000
.quad 0x2da80000ada83000,0x2da8b0002da80000,0x263e2a1faea73000,0x2fd9af642c720000,0xaa1f2da8af643000,0x2f64ada82a1f0000,0xaea72f64afd93000,0x2c72aa1f263e0000
.quad 0x3000300030003000,0x0,0x263e2a1f2c722da8,0x2fd92f642ea72da8,0xaf64ada8aa1f0000,0x2a1f2da82f643000,0xac72af64afd9ada8,0xaea7aa1f263e2da8
.quad 0x2da80000ada8b000,0xada8b000ada80000,0x2ea72f64263eada8,0x2c72aa1fafd9ada8,0xaa1f2da82f640000,0x2f642da8aa1fb000,0xafd9aa1f2ea72da8,0xa63e2f642c72ada8
.quad 0xb00000003000,0xb000000030000000,0x2fd9aa1faea72da8,0xa63eaf642c722da8,0x2a1f2da8af640000,0x2f64ada8aa1f3000,0xaea72f64a63eada8,0x2c722a1fafd92da8
.quad 0xada800002da8b000,0xada83000ada80000,0x2c72af642fd9ada8,0xaea72a1f263eada8,0x2f64ada82a1f0000,0x2a1fada82f64b000,0xa63e2a1fac722da8,0x2fd9af642ea7ada8
.quad 0x3000300030003000,0x0,0xac72aa1fa63e0000,0x2ea72f642fd93000,0xaa1fada8af64b000,0xaf64ada8aa1f0000,0x2fd92f642c720000,0x263eaa1faea7b000
.quad 0xada800002da83000,0x2da830002da80000,0xa63eaf64aea70000,0xafd9aa1f2c723000,0x2f642da8aa1fb000,0x2a1fada8af640000,0xaea72a1f2fd90000,0x2c722f64a63eb000
.quad 0xb00000003000,0xb000000030000000,0x2ea72a1fafd90000,0x2c72af64a63e3000,0xaf642da82a1fb000,0x2a1f2da8af640000,0x263eaf642ea70000,0xafd92a1f2c72b000
.quad 0x2da80000ada83000,0x2da8b0002da80000,0xafd92f64ac720000,0x263e2a1faea73000,0x2a1fada82f64b000,0xaf642da8aa1f0000,0x2c72aa1f263e0000,0x2ea7af642fd9b000
.quad 0x3000300030003000,0x0,0xafd9af64aea7ada8,0x263e2a1f2c722da8,0x2f642da82a1f0000,0xaa1fada8af64b000,0xaea7aa1f263e2da8,0x2c722f642fd92da8
.quad 0x2da80000ada8b000,0xada8b000ada80000,0xac722a1f2fd92da8,0x2ea72f64263eada8,0x2a1fada8af640000,0xaf64ada82a1f3000,0xa63e2f642c72ada8,0x2fd92a1faea7ada8
.quad 0xb00000003000,0xb000000030000000,0x263e2f64ac72ada8,0x2fd9aa1faea72da8,0xaa1fada82f640000,0xaf642da82a1fb000,0x2c722a1fafd92da8,0x2ea7af64263e2da8
.quad 0xada800002da8b000,0xada83000ada80000,0x2ea7aa1fa63e2da8,0x2c72af642fd9ada8,0xaf642da8aa1f0000,0xaa1f2da8af643000,0x2fd9af642ea7ada8,0x263eaa1f2c72ada8
.quad 0x3000300030003000,0x0,0xaea7af64afd9b000,0xac72aa1fa63e0000,0x2a1f2da82f643000,0x2f642da82a1f0000,0x263eaa1faea7b000,0xafd9af64ac720000
.quad 0xada800002da83000,0x2da830002da80000,0x2fd92a1fac72b000,0xa63eaf64aea70000,0xaf64ada82a1f3000,0xaa1f2da82f640000,0x2c722f64a63eb000,0x2ea7aa1fafd90000
.quad 0xb00000003000,0xb000000030000000,0xac722f64263eb000,0x2ea72a1fafd90000,0x2f64ada8aa1f3000,0xaa1fada82f640000,0xafd92a1f2c72b000,0xa63e2f64aea70000
.quad 0x2da80000ada83000,0x2da8b0002da80000,0xa63eaa1f2ea7b000,0xafd92f64ac720000,0xaa1f2da8af643000,0x2f64ada82a1f0000,0x2ea7af642fd9b000,0xac722a1fa63e0000
.quad 0x3000300030003000,0x0,0xa63eaa1fac72ada8,0xafd9af64aea7ada8,0xaf64ada8aa1f0000,0x2a1f2da82f643000,0x2c722f642fd92da8,0x2ea72a1fa63eada8
.quad 0x2da80000ada8b000,0xada8b000ada80000,0xaea7af64a63e2da8,0xac722a1f2fd92da8,0xaa1f2da82f640000,0x2f642da8aa1fb000,0x2fd92a1faea7ada8,0x263eaf64ac722da8
.quad 0xb00000003000,0xb000000030000000,0xafd92a1f2ea7ada8,0x263e2f64ac72ada8,0x2a1f2da8af640000,0x2f64ada8aa1f3000,0x2ea7af64263e2da8,0xac72aa1f2fd9ada8
.quad 0xada800002da8b000,0xada83000ada80000,0xac722f64afd92da8,0x2ea7aa1fa63e2da8,0x2f64ada82a1f0000,0x2a1fada82f64b000,0x263eaa1f2c72ada8,0xafd92f64aea72da8
.quad 0x3000300030003000,0x0,0x2c722a1f263e0000,0xaea7af64afd9b000,0xaa1fada8af64b000,0xaf64ada8aa1f0000,0xafd9af64ac720000,0xa63e2a1f2ea73000
.quad 0xada800002da83000,0x2da830002da80000,0x263e2f642ea70000,0x2fd92a1fac72b000,0x2f642da8aa1fb000,0x2a1fada8af640000,0x2ea7aa1fafd90000,0xac72af64263e3000
.quad 0xb00000003000,0xb000000030000000,0xaea7aa1f2fd90000,0xac722f64263eb000,0xaf642da82a1fb000,0x2a1f2da8af640000,0xa63e2f64aea70000,0x2fd9aa1fac723000
.quad 0x2da80000ada83000,0x2da8b0002da80000,0x2fd9af642c720000,0xa63eaa1f2ea7b000,0x2a1fada82f64b000,0xaf642da8aa1f0000,0xac722a1fa63e0000,0xaea72f64afd93000
.quad 0x3000300030003000,0x0,0x2fd92f642ea72da8,0xa63eaa1fac72ada8,0x2f642da82a1f0000,0xaa1fada8af64b000,0x2ea72a1fa63eada8,0xac72af64afd9ada8
.quad 0x2da80000ada8b000,0xada8b000ada80000,0x2c72aa1fafd9ada8,0xaea7af64a63e2da8,0x2a1fada8af640000,0xaf64ada82a1f3000,0x263eaf64ac722da8,0xafd9aa1f2ea72da8
.quad 0xb00000003000,0xb000000030000000,0xa63eaf642c722da8,0xafd92a1f2ea7ada8,0xaa1fada82f640000,0xaf642da82a1fb000,0xac72aa1f2fd9ada8,0xaea72f64a63eada8
.quad 0xada800002da8b000,0xada83000ada80000,0xaea72a1f263eada8,0xac722f64afd92da8,0xaf642da8aa1f0000,0xaa1f2da8af643000,0xafd92f64aea72da8,0xa63e2a1fac722da8
.quad 0xb0003000b0003000,0x0,0xaea72f64afd93000,0xac722a1fa63e0000,0xaa1f2da8af643000,0xaf642da8aa1f0000,0x263e2a1faea73000,0xafd92f64ac720000
.quad 0x2da80000ada83000,0xada83000ada80000,0x2fd9aa1fac723000,0xa63e2f64aea70000,0x2f64ada8aa1f3000,0x2a1f2da8af640000,0x2c72af64a63e3000,0x2ea72a1fafd90000
.quad 0xb00000003000,0x30000000b0000000,0xac72af64263e3000,0x2ea7aa1fafd90000,0xaf64ada82a1f3000,0x2a1fada8af640000,0xafd9aa1f2c723000,0xa63eaf64aea70000
.quad 0xada800002da83000,0xada8b000ada80000,0xa63e2a1f2ea73000,0xafd9af64ac720000,0x2a1f2da82f643000,0xaf64ada8aa1f0000,0x2ea72f642fd93000,0xac72aa1fa63e0000
.quad 0xb0003000b0003000,0x0,0xa63e2a1fac722da8,0xafd92f64aea72da8,0x2f64ada82a1f0000,0xaa1f2da8af643000,0x2c72af642fd9ada8,0x2ea7aa1fa63e2da8
.quad 0xada800002da8b000,0x2da8b0002da80000,0xaea72f64a63eada8,0xac72aa1f2fd9ada8,0x2a1f2da8af640000,0xaf642da82a1fb000,0x2fd9aa1faea72da8,0x263e2f64ac72ada8
.quad 0xb00000003000,0x30000000b0000000,0xafd9aa1f2ea72da8,0x263eaf64ac722da8,0xaa1f2da82f640000,0xaf64ada82a1f3000,0x2ea72f64263eada8,0xac722a1f2fd92da8
.quad 0x2da80000ada8b000,0x2da830002da80000,0xac72af64afd9ada8,0x2ea72a1fa63eada8,0xaf64ada8aa1f0000,0xaa1fada8af64b000,0x263e2a1f2c722da8,0xafd9af64aea7ada8
.quad 0xb0003000b0003000,0x0,0x2c72aa1f263e0000,0xaea72f64afd93000,0x2a1fada82f64b000,0x2f64ada82a1f0000,0xafd92f64ac720000,0xa63eaa1f2ea7b000
.quad 0x2da80000ada83000,0xada83000ada80000,0x263eaf642ea70000,0x2fd9aa1fac723000,0xaf642da82a1fb000,0xaa1fada82f640000,0x2ea72a1fafd90000,0xac722f64263eb000
.quad 0xb00000003000,0x30000000b0000000,0xaea72a1f2fd90000,0xac72af64263e3000,0x2f642da8aa1fb000,0xaa1f2da82f640000,0xa63eaf64aea70000,0x2fd92a1fac72b000
.quad 0xada800002da83000,0xada8b000ada80000,0x2fd92f642c720000,0xa63e2a1f2ea73000,0xaa1fada8af64b000,0x2f642da82a1f0000,0xac72aa1fa63e0000,0xaea7af64afd9b000
.quad 0xb0003000b0003000,0x0,0x2fd9af642ea7ada8,0xa63e2a1fac722da8,0xaf642da8aa1f0000,0x2a1fada82f64b000,0x2ea7aa1fa63e2da8,0xac722f64afd92da8
.quad 0xada800002da8b000,0x2da8b0002da80000,0x2c722a1fafd92da8,0xaea72f64a63eada8,0xaa1fada82f640000,0x2f64ada8aa1f3000,0x263e2f64ac72ada8,0xafd92a1f2ea7ada8
.quad 0xb00000003000,0x30000000b0000000,0xa63e2f642c72ada8,0xafd9aa1f2ea72da8,0x2a1fada8af640000,0x2f642da8aa1fb000,0xac722a1f2fd92da8,0xaea7af64a63e2da8
.quad 0x2da80000ada8b000,0x2da830002da80000,0xaea7aa1f263e2da8,0xac72af64afd9ada8,0x2f642da82a1f0000,0x2a1f2da82f643000,0xafd9af64aea7ada8,0xa63eaa1fac72ada8
.quad 0xb0003000b0003000,0x0,0x2ea7af642fd9b000,0x2c72aa1f263e0000,0xaa1f2da8af643000,0xaf642da8aa1f0000,0xa63eaa1f2ea7b000,0x2fd9af642c720000
.quad 0x2da80000ada83000,0xada83000ada80000,0xafd92a1f2c72b000,0x263eaf642ea70000,0x2f64ada8aa1f3000,0x2a1f2da8af640000,0xac722f64263eb000,0xaea7aa1f2fd90000
.quad 0xb00000003000,0x30000000b0000000,0x2c722f64a63eb000,0xaea72a1f2fd90000,0xaf64ada82a1f3000,0x2a1fada8af640000,0x2fd92a1fac72b000,0x263e2f642ea70000
.quad 0xada800002da83000,0xada8b000ada80000,0x263eaa1faea7b000,0x2fd92f642c720000,0x2a1f2da82f643000,0xaf64ada8aa1f0000,0xaea7af64afd9b000,0x2c722a1f263e0000
.quad 0xb0003000b0003000,0x0,0x263eaa1f2c72ada8,0x2fd9af642ea7ada8,0x2f64ada82a1f0000,0xaa1f2da8af643000,0xac722f64afd92da8,0xaea72a1f263eada8
.quad 0xada800002da8b000,0x2da8b0002da80000,0x2ea7af64263e2da8,0x2c722a1fafd92da8,0x2a1f2da8af640000,0xaf642da82a1fb000,0xafd92a1f2ea7ada8,0xa63eaf642c722da8
.quad 0xb00000003000,0x30000000b0000000,0x2fd92a1faea7ada8,0xa63e2f642c72ada8,0xaa1f2da82f640000,0xaf64ada82a1f3000,0xaea7af64a63e2da8,0x2c72aa1fafd9ada8
.quad 0x2da80000ada8b000,0x2da830002da80000,0x2c722f642fd92da8,0xaea7aa1f263e2da8,0xaf64ada8aa1f0000,0xaa1fada8af64b000,0xa63eaa1fac72ada8,0x2fd92f642ea72da8
.quad 0xb0003000b0003000,0x0,0xac722a1fa63e0000,0x2ea7af642fd9b000,0x2a1fada82f64b000,0x2f64ada82a1f0000,0x2fd9af642c720000,0x263e2a1faea73000
.quad 0x2da80000ada83000,0xada83000ada80000,0xa63e2f64aea70000,0xafd92a1f2c72b000,0xaf642da82a1fb000,0xaa1fada82f640000,0xaea7aa1f2fd90000,0x2c72af64a63e3000
.quad 0xb00000003000,0x30000000b0000000,0x2ea7aa1fafd90000,0x2c722f64a63eb000,0x2f642da8aa1fb000,0xaa1f2da82f640000,0x263e2f642ea70000,0xafd9aa1f2c723000
.quad 0xada800002da83000,0xada8b000ada80000,0xafd9af64ac720000,0x263eaa1faea7b000,0xaa1fada8af64b000,0x2f642da82a1f0000,0x2c722a1f263e0000,0x2ea72f642fd93000
.quad 0xb0003000b0003000,0x0,0xafd92f64aea72da8,0x263eaa1f2c72ada8,0xaf642da8aa1f0000,0x2a1fada82f64b000,0xaea72a1f263eada8,0x2c72af642fd9ada8
.quad 0xada800002da8b000,0x2da8b0002da80000,0xac72aa1f2fd9ada8,0x2ea7af64263e2da8,0xaa1fada82f640000,0x2f64ada8aa1f3000,0xa63eaf642c722da8,0x2fd9aa1faea72da8
.quad 0xb00000003000,0x30000000b0000000,0x263eaf64ac722da8,0x2fd92a1faea7ada8,0x2a1fada8af640000,0x2f642da8aa1fb000,0x2c72aa1fafd9ada8,0x2ea72f64263eada8
.quad 0x2da80000ada8b000,0x2da830002da80000,0x2ea72a1fa63eada8,0x2c722f642fd92da8,0x2f642da82a1f0000,0x2a1f2da82f643000,0x2fd92f642ea72da8,0x263e2a1f2c722da8
.quad 0x3e803e803e803e80,0x0,0x3e553e6d3e7b3e80,0xbe0ebdc4bd480000,0x3dc43e353e6d3e80,0xbe6dbe35bdc40000,0xbd483dc43e553e80,0xbe7bbe6dbe0e0000
.quad 0xbe3500003e353e80,0xbe35be80be350000,0xbe7bbdc43e0e3e80,0xbd48be6dbe550000,0xbe6dbe353dc43e80,0x3dc4be35be6d0000,0xbe0ebe6d3d483e80,0x3e55bdc4be7b0000
.quad 0xbe8000003e80,0x3e800000be800000,0x3e0ebe6dbd483e80,0x3e553dc4be7b0000,0x3e6dbe35bdc43e80,0x3dc43e35be6d0000,0x3e7bbdc4be0e3e80,0xbd483e6dbe550000
.quad 0x3e350000be353e80,0xbe353e80be350000,0x3d483dc4be553e80,0xbe7b3e6dbe0e0000,0xbdc43e35be6d3e80,0xbe6d3e35bdc40000,0xbe553e6dbe7b3e80,0xbe0e3dc4bd480000
.quad 0x3e803e803e803e80,0x0,0x3d483dc43e0e3e35,0xbe7bbe6dbe55be35,0xbe6dbe35bdc40000,0xbdc4be35be6dbe80,0xbe0ebe6dbe7bbe35,0x3e553dc4bd48be35
.quad 0x3e350000be35be80,0x3e353e803e350000,0x3e553e6d3d48be35,0xbe0e3dc43e7b3e35,0xbdc43e353e6d0000,0xbe6dbe353dc43e80,0xbe7bbdc43e553e35,0x3d48be6dbe0e3e35
.quad 0xbe8000003e80,0x3e800000be800000,0x3e7bbdc4be553e35,0x3d483e6dbe0ebe35,0x3dc43e35be6d0000,0xbe6d3e353dc4be80,0xbe553e6dbd48be35,0xbe0ebdc43e7bbe35
.quad 0xbe3500003e35be80,0x3e35be803e350000,0x3e0ebe6d3e7bbe35,0x3e55bdc4bd483e35,0x3e6dbe353dc40000,0xbdc43e35be6d3e80,0xbd483dc4be0e3e35,0xbe7b3e6dbe553e35
.quad 0x3e803e803e803e80,0x0,0xbe0ebdc4bd480000,0xbe55be6dbe7bbe80,0xbdc4be35be6dbe80,0x3e6d3e353dc40000,0x3e7b3e6d3e0e0000,0xbd483dc43e553e80
.quad 0xbe3500003e353e80,0xbe35be80be350000,0xbd48be6dbe550000,0x3e7b3dc4be0ebe80,0x3e6d3e35bdc4be80,0xbdc43e353e6d0000,0xbe553dc43e7b0000,0xbe0ebe6d3d483e80
.quad 0xbe8000003e80,0x3e800000be800000,0x3e553dc4be7b0000,0xbe0e3e6d3d48be80,0xbe6d3e353dc4be80,0xbdc4be353e6d0000,0x3d48be6d3e550000,0x3e7bbdc4be0e3e80
.quad 0x3e350000be353e80,0xbe353e80be350000,0xbe7b3e6dbe0e0000,0xbd48bdc43e55be80,0x3dc4be353e6dbe80,0x3e6dbe353dc40000,0x3e0ebdc43d480000,0xbe553e6dbe7b3e80
.quad 0x3e803e803e803e80,0x0,0xbe7bbe6dbe55be35,0xbd48bdc4be0ebe35,0x3e6d3e353dc40000,0x3dc43e353e6d3e80,0xbe55bdc43d483e35,0xbe0ebe6dbe7bbe35
.quad 0x3e350000be35be80,0x3e353e803e350000,0xbe0e3dc43e7b3e35,0xbe55be6dbd483e35,0x3dc4be35be6d0000,0x3e6d3e35bdc4be80,0xbd483e6d3e0ebe35,0xbe7bbdc43e553e35
.quad 0xbe8000003e80,0x3e800000be800000,0x3d483e6dbe0ebe35,0xbe7b3dc43e55be35,0xbdc4be353e6d0000,0x3e6dbe35bdc43e80,0x3e0e3dc4be7b3e35,0xbe553e6dbd48be35
.quad 0xbe3500003e35be80,0x3e35be803e350000,0x3e55bdc4bd483e35,0xbe0e3e6dbe7b3e35,0xbe6d3e35bdc40000,0x3dc4be353e6dbe80,0x3e7bbe6d3e55be35,0xbd483dc4be0e3e35
.quad 0x3e803e803e803e80,0x0,0xbe55be6dbe7bbe80,0x3e0e3dc43d480000,0x3dc43e353e6d3e80,0xbe6dbe35bdc40000,0x3d48bdc4be55be80,0x3e7b3e6d3e0e0000
.quad 0xbe3500003e353e80,0xbe35be80be350000,0x3e7b3dc4be0ebe80,0x3d483e6d3e550000,0xbe6dbe353dc43e80,0x3dc4be35be6d0000,0x3e0e3e6dbd48be80,0xbe553dc43e7b0000
.quad 0xbe8000003e80,0x3e800000be800000,0xbe0e3e6d3d48be80,0xbe55bdc43e7b0000,0x3e6dbe35bdc43e80,0x3dc43e35be6d0000,0xbe7b3dc43e0ebe80,0x3d48be6d3e550000
.quad 0x3e350000be353e80,0xbe353e80be350000,0xbd48bdc43e55be80,0x3e7bbe6d3e0e0000,0xbdc43e35be6d3e80,0xbe6d3e35bdc40000,0x3e55be6d3e7bbe80,0x3e0ebdc43d480000
.quad 0x3e803e803e803e80,0x0,0xbd48bdc4be0ebe35,0x3e7b3e6d3e553e35,0xbe6dbe35bdc40000,0xbdc4be35be6dbe80,0x3e0e3e6d3e7b3e35,0xbe55bdc43d483e35
.quad 0x3e350000be35be80,0x3e353e803e350000,0xbe55be6dbd483e35,0x3e0ebdc4be7bbe35,0xbdc43e353e6d0000,0xbe6dbe353dc43e80,0x3e7b3dc4be55be35,0xbd483e6d3e0ebe35
.quad 0xbe8000003e80,0x3e800000be800000,0xbe7b3dc43e55be35,0xbd48be6d3e0e3e35,0x3dc43e35be6d0000,0xbe6d3e353dc4be80,0x3e55be6d3d483e35,0x3e0e3dc4be7b3e35
.quad 0xbe3500003e35be80,0x3e35be803e350000,0xbe0e3e6dbe7b3e35,0xbe553dc43d48be35,0x3e6dbe353dc40000,0xbdc43e35be6d3e80,0x3d48bdc43e0ebe35,0x3e7bbe6d3e55be35
.quad 0x3e803e803e803e80,0x0,0x3e0e3dc43d480000,0x3e553e6d3e7b3e80,0xbdc4be35be6dbe80,0x3e6d3e353dc40000,0xbe7bbe6dbe0e0000,0x3d48bdc4be55be80
.quad 0xbe3500003e353e80,0xbe35be80be350000,0x3d483e6d3e550000,0xbe7bbdc43e0e3e80,0x3e6d3e35bdc4be80,0xbdc43e353e6d0000,0x3e55bdc4be7b0000,0x3e0e3e6dbd48be80
.quad 0xbe8000003e80,0x3e800000be800000,0xbe55bdc43e7b0000,0x3e0ebe6dbd483e80,0xbe6d3e353dc4be80,0xbdc4be353e6d0000,0xbd483e6dbe550000,0xbe7b3dc43e0ebe80
.quad 0x3e350000be353e80,0xbe353e80be350000,0x3e7bbe6d3e0e0000,0x3d483dc4be553e80,0x3dc4be353e6dbe80,0x3e6dbe353dc40000,0xbe0e3dc4bd480000,0x3e55be6d3e7bbe80
.quad 0x3e803e803e803e80,0x0,0x3e7b3e6d3e553e35,0x3d483dc43e0e3e35,0x3e6d3e353dc40000,0x3dc43e353e6d3e80,0x3e553dc4bd48be35,0x3e0e3e6d3e7b3e35
.quad 0x3e350000be35be80,0x3e353e803e350000,0x3e0ebdc4be7bbe35,0x3e553e6d3d48be35,0x3dc4be35be6d0000,0x3e6d3e35bdc4be80,0x3d48be6dbe0e3e35,0x3e7b3dc4be55be35
.quad 0xbe8000003e80,0x3e800000be800000,0xbd48be6d3e0e3e35,0x3e7bbdc4be553e35,0xbdc4be353e6d0000,0x3e6dbe35bdc43e80,0xbe0ebdc43e7bbe35,0x3e55be6d3d483e35
.quad 0xbe3500003e35be80,0x3e35be803e350000,0xbe553dc43d48be35,0x3e0ebe6d3e7bbe35,0xbe6d3e35bdc40000,0x3dc4be353e6dbe80,0xbe7b3e6dbe553e35,0x3d48bdc43e0ebe35
.quad 0xbe803e80be803e80,0x0,0xbe553e6dbe7b3e80,0x3e0ebdc43d480000,0xbdc43e35be6d3e80,0x3e6dbe353dc40000,0x3d483dc4be553e80,0x3e7bbe6d3e0e0000
.quad 0x3e350000be353e80,0x3e35be803e350000,0x3e7bbdc4be0e3e80,0x3d48be6d3e550000,0x3e6dbe35bdc43e80,0xbdc4be353e6d0000,0x3e0ebe6dbd483e80,0xbe55bdc43e7b0000
.quad 0xbe8000003e80,0xbe8000003e800000,0xbe0ebe6d3d483e80,0xbe553dc43e7b0000,0xbe6dbe353dc43e80,0xbdc43e353e6d0000,0xbe7bbdc43e0e3e80,0x3d483e6d3e550000
.quad 0xbe3500003e353e80,0x3e353e803e350000,0xbd483dc43e553e80,0x3e7b3e6d3e0e0000,0x3dc43e353e6d3e80,0x3e6d3e353dc40000,0x3e553e6d3e7b3e80,0x3e0e3dc43d480000
.quad 0xbe803e80be803e80,0x0,0xbd483dc4be0e3e35,0x3e7bbe6d3e55be35,0x3e6dbe353dc40000,0x3dc4be353e6dbe80,0x3e0ebe6d3e7bbe35,0xbe553dc43d48be35
.quad 0xbe3500003e35be80,0xbe353e80be350000,0xbe553e6dbd48be35,0x3e0e3dc4be7b3e35,0x3dc43e35be6d0000,0x3e6dbe35bdc43e80,0x3e7bbdc4be553e35,0xbd48be6d3e0e3e35
.quad 0xbe8000003e80,0xbe8000003e800000,0xbe7bbdc43e553e35,0xbd483e6d3e0ebe35,0xbdc43e353e6d0000,0x3e6d3e35bdc4be80,0x3e553e6d3d48be35,0x3e0ebdc4be7bbe35
.quad 0x3e350000be35be80,0xbe35be80be350000,0xbe0ebe6dbe7bbe35,0xbe55bdc43d483e35,0xbe6dbe35bdc40000,0x3dc43e353e6d3e80,0x3d483dc43e0e3e35,0x3e7b3e6d3e553e35
.quad 0xbe803e80be803e80,0x0,0x3e0ebdc43d480000,0x3e55be6d3e7bbe80,0x3dc4be353e6dbe80,0xbe6d3e35bdc40000,0xbe7b3e6dbe0e0000,0x3d483dc4be553e80
.quad 0x3e350000be353e80,0x3e35be803e350000,0x3d48be6d3e550000,0xbe7b3dc43e0ebe80,0xbe6d3e353dc4be80,0x3dc43e35be6d0000,0x3e553dc4be7b0000,0x3e0ebe6dbd483e80
.quad 0xbe8000003e80,0xbe8000003e800000,0xbe553dc43e7b0000,0x3e0e3e6dbd48be80,0x3e6d3e35bdc4be80,0x3dc4be35be6d0000,0xbd48be6dbe550000,0xbe7bbdc43e0e3e80
.quad 0xbe3500003e353e80,0x3e353e803e350000,0x3e7b3e6d3e0e0000,0x3d48bdc4be55be80,0xbdc4be35be6dbe80,0xbe6dbe35bdc40000,0xbe0ebdc4bd480000,0x3e553e6d3e7b3e80
.quad 0xbe803e80be803e80,0x0,0x3e7bbe6d3e55be35,0x3d48bdc43e0ebe35,0xbe6d3e35bdc40000,0xbdc43e35be6d3e80,0x3e55bdc4bd483e35,0x3e0ebe6d3e7bbe35
.quad 0xbe3500003e35be80,0xbe353e80be350000,0x3e0e3dc4be7b3e35,0x3e55be6d3d483e35,0xbdc4be353e6d0000,0xbe6d3e353dc4be80,0x3d483e6dbe0ebe35,0x3e7bbdc4be553e35
.quad 0xbe8000003e80,0xbe8000003e800000,0xbd483e6d3e0ebe35,0x3e7b3dc4be55be35,0x3dc4be35be6d0000,0xbe6dbe353dc43e80,0xbe0e3dc43e7b3e35,0x3e553e6d3d48be35
.quad 0x3e350000be35be80,0xbe35be80be350000,0xbe55bdc43d483e35,0x3e0e3e6d3e7b3e35,0x3e6d3e353dc40000,0xbdc4be35be6dbe80,0xbe7bbe6dbe55be35,0x3d483dc43e0e3e35
.quad 0xbe803e80be803e80,0x0,0x3e55be6d3e7bbe80,0xbe0e3dc4bd480000,0xbdc43e35be6d3e80,0x3e6dbe353dc40000,0xbd48bdc43e55be80,0xbe7b3e6dbe0e0000
.quad 0x3e350000be353e80,0x3e35be803e350000,0xbe7b3dc43e0ebe80,0xbd483e6dbe550000,0x3e6dbe35bdc43e80,0xbdc4be353e6d0000,0xbe0e3e6d3d48be80,0x3e553dc4be7b0000
.quad 0xbe8000003e80,0xbe8000003e800000,0x3e0e3e6dbd48be80,0x3e55bdc4be7b0000,0xbe6dbe353dc43e80,0xbdc43e353e6d0000,0x3e7b3dc4be0ebe80,0xbd48be6dbe550000
.quad 0xbe3500003e353e80,0x3e353e803e350000,0x3d48bdc4be55be80,0xbe7bbe6dbe0e0000,0x3dc43e353e6d3e80,0x3e6d3e353dc40000,0xbe55be6dbe7bbe80,0xbe0ebdc4bd480000
.quad 0xbe803e80be803e80,0x0,0x3d48bdc43e0ebe35,0xbe7b3e6dbe553e35,0x3e6dbe353dc40000,0x3dc4be353e6dbe80,0xbe0e3e6dbe7b3e35,0x3e55bdc4bd483e35
.quad 0xbe3500003e35be80,0xbe353e80be350000,0x3e55be6d3d483e35,0xbe0ebdc43e7bbe35,0x3dc43e35be6d0000,0x3e6dbe35bdc43e80,0xbe7b3dc43e55be35,0x3d483e6dbe0ebe35
.quad 0xbe8000003e80,0xbe8000003e800000,0x3e7b3dc4be55be35,0x3d48be6dbe0e3e35,0xbdc43e353e6d0000,0x3e6d3e35bdc4be80,0xbe55be6dbd483e35,0xbe0e3dc43e7b3e35
.quad 0x3e350000be35be80,0xbe35be80be350000,0x3e0e3e6d3e7b3e35,0x3e553dc4bd48be35,0xbe6dbe35bdc40000,0x3dc43e353e6d3e80,0xbd48bdc4be0ebe35,0xbe7bbe6dbe55be35
.quad 0xbe803e80be803e80,0x0,0xbe0e3dc4bd480000,0xbe553e6dbe7b3e80,0x3dc4be353e6dbe80,0xbe6d3e35bdc40000,0x3e7bbe6d3e0e0000,0xbd48bdc43e55be80
.quad 0x3e350000be353e80,0x3e35be803e350000,0xbd483e6dbe550000,0x3e7bbdc4be0e3e80,0xbe6d3e353dc4be80,0x3dc43e35be6d0000,0xbe55bdc43e7b0000,0xbe0e3e6d3d48be80
.quad 0xbe8000003e80,0xbe8000003e800000,0x3e55bdc4be7b0000,0xbe0ebe6d3d483e80,0x3e6d3e35bdc4be80,0x3dc4be35be6d0000,0x3d483e6d3e550000,0x3e7b3dc4be0ebe80
.quad 0xbe3500003e353e80,0x3e353e803e350000,0xbe7bbe6dbe0e0000,0xbd483dc43e553e80,0xbdc4be35be6dbe80,0xbe6dbe35bdc40000,0x3e0e3dc43d480000,0xbe55be6dbe7bbe80
.quad 0xbe803e80be803e80,0x0,0xbe7b3e6dbe553e35,0xbd483dc4be0e3e35,0xbe6d3e35bdc40000,0xbdc43e35be6d3e80,0xbe553dc43d48be35,0xbe0e3e6dbe7b3e35
.quad 0xbe3500003e35be80,0xbe353e80be350000,0xbe0ebdc43e7bbe35,0xbe553e6dbd48be35,0xbdc4be353e6d0000,0xbe6d3e353dc4be80,0xbd48be6d3e0e3e35,0xbe7b3dc43e55be35
.quad 0xbe8000003e80,0xbe8000003e800000,0x3d48be6dbe0e3e35,0xbe7bbdc43e553e35,0x3dc4be35be6d0000,0xbe6dbe353dc43e80,0x3e0ebdc4be7bbe35,0xbe55be6dbd483e35
.quad 0x3e350000be35be80,0xbe35be80be350000,0x3e553dc4bd48be35,0xbe0ebe6dbe7bbe35,0x3e6d3e353dc40000,0xbdc4be35be6dbe80,0x3e7b3e6d3e553e35,0xbd48bdc4be0ebe35
L_image_end:
.section .rodata,"a"
.p2align 6
.amdhsa_kernel sequential_preLN__spectral_gfnet__glu_gated_geglu__prompt_kernel
  .amdhsa_next_free_vgpr 512
  .amdhsa_next_free_sgpr 76
  .amdhsa_accum_offset 256
  .amdhsa_group_segment_fixed_size 0
  .amdhsa_kernarg_size 80
  .amdhsa_user_sgpr_count 2
  .amdhsa_user_sgpr_kernarg_segment_ptr 1
  .amdhsa_system_sgpr_workgroup_id_x 1
.end_amdhsa_kernel
```
